```python
import torch

def _softmax(x, axis=-1):
    return torch.softmax(x, dim=axis)

def _gelu(x):
    return torch.nn.functional.gelu(x, approximate='tanh')

def _silu(x):
    return torch.nn.functional.silu(x)

def _sigmoid(x):
    return torch.sigmoid(x)

def _layernorm(x, axis=-1, eps=1e-05):
    m = x.mean(dim=axis, keepdim=True)
    v = x.var(dim=axis, keepdim=True, unbiased=False)
    return (x - m) / torch.sqrt(v + eps)

def _scatter_add(tgt, idx, src, axis=0):
    return tgt.clone().index_add_(axis, idx, src)

def _segment_sum(src, seg, n):
    out = torch.zeros((n,) + src.shape[1:], dtype=src.dtype)
    return out.index_add_(0, seg, src)

def _pad(x, pw):
    flat = tuple((v for pair in reversed(pw) for v in pair))
    return torch.nn.functional.pad(x, flat)
kernel_name = 'adaLN_cond__mha_block_cached__glu_gated_bilinear__prompt'

def setup_inputs():

    _w = lambda a: (lambda t: t.to(torch.bfloat16) if t.is_floating_point() else t)(torch.as_tensor(a))

    def _A_setup():
        B, Sq, D = (1, 2048, 512)
        H, Sk, Dh = (32, 2048, 128)
        return {'x': _w((lambda *s: torch.randn(*s, dtype=torch.bfloat16) * 0.1)(B, Sq, D)), 'k_cache': _w((lambda *s: torch.randn(*s, dtype=torch.bfloat16) * 0.8)(B, H, Sk, Dh)), 'v_cache': _w((lambda *s: torch.randn(*s, dtype=torch.bfloat16) * 3.2)(B, H, Sk, Dh)), 'wq': _w((lambda *s: torch.randn(*s, dtype=torch.bfloat16) * 0.8)(D, H * Dh) * D ** (-0.5)), 'wo': _w((lambda *s: torch.randn(*s, dtype=torch.bfloat16) * 3.2)(H * Dh, D) * (H * Dh) ** (-0.5))}
    _A_in = _A_setup()

    def _B_setup():
        B, S, D, F = (1, 2048, 512, 1792)
        return {'x': _w((lambda *s: torch.randn(*s, dtype=torch.bfloat16) * 0.1)(B, S, D)), 'w_gate': _w((lambda *s: torch.randn(*s, dtype=torch.bfloat16) * 3.2)(D, F) * D ** (-0.5)), 'w_up': _w((lambda *s: torch.randn(*s, dtype=torch.bfloat16) * 3.2)(D, F) * D ** (-0.5)), 'w_down': _w((lambda *s: torch.randn(*s, dtype=torch.bfloat16) * 3.2)(F, D) * F ** (-0.5))}
    _B_in = _B_setup()
    return {'A_x': _A_in['x'], 'A_k_cache': _A_in['k_cache'], 'A_v_cache': _A_in['v_cache'], 'A_wq': _A_in['wq'], 'A_wo': _A_in['wo'], 'B_x': _B_in['x'], 'B_w_gate': _B_in['w_gate'], 'B_w_up': _B_in['w_up'], 'B_w_down': _B_in['w_down'], 'c': _w((lambda *s: torch.randn(*s, dtype=torch.bfloat16) * 0.8)(1, 512) * 8.0), 'w_mod': _w((lambda *s: torch.randn(*s, dtype=torch.bfloat16) * 0.8)(512, 6 * 512) * 512 ** (-0.5) * 8.0)}

def reference(A_x, A_k_cache, A_v_cache, A_wq, A_wo, B_x, B_w_gate, B_w_up, B_w_down, c, w_mod):

    def _A_ref(x, k_cache, v_cache, wq, wo):
        B, Sq, D = x.shape
        H, Dh = (32, 128)
        q = (lambda x, *d: x.permute(*d))((x @ wq).reshape(B, Sq, H, Dh), 0, 2, 1, 3)
        scores = torch.einsum('bhqd,bhkd->bhqk', q, k_cache) * Dh ** (-0.5)
        p = _softmax(scores, axis=-1)
        o = torch.einsum('bhqk,bhkd->bhqd', p, v_cache)
        return (lambda x, *d: x.permute(*d))(o, 0, 2, 1, 3).reshape(B, Sq, H * Dh) @ wo

    def _B_ref(x, w_gate, w_up, w_down):
        g = torch.einsum('bsd,df->bsf', x, w_gate)
        u = torch.einsum('bsd,df->bsf', x, w_up)
        h = g * u
        return torch.einsum('bsf,fd->bsd', h, w_down)
    x = A_x
    mod = (_silu(c) @ w_mod).reshape(c.shape[0], 6, 1, -1)
    sa, ca, ga, sb, cb, gb = (mod[:, 0].clone(), mod[:, 1].clone(), mod[:, 2].clone(), mod[:, 3].clone(), mod[:, 4].clone(), mod[:, 5].clone())
    h = _layernorm(x, axis=-1) * (1 + ca) + sa
    x = x + ga * _A_ref(h, A_k_cache, A_v_cache, A_wq, A_wo)
    h = _layernorm(x, axis=-1) * (1 + cb) + sb
    x = x + gb * _B_ref(h, B_w_gate, B_w_up, B_w_down)
    return x
```

```asm
; @launch grid=(256,1,1) block=(256,1,1) lds=163840
.amdgcn_target "amdgcn-amd-amdhsa--gfx950"
.text
.globl adaLN_cond__mha_block_cached__glu_gated_bilinear__prompt_kernel
.p2align 8
.type adaLN_cond__mha_block_cached__glu_gated_bilinear__prompt_kernel,@function
adaLN_cond__mha_block_cached__glu_gated_bilinear__prompt_kernel:
    s_cmp_ge_u32 s2, 256
    s_cbranch_scc1 L_big_end
    s_load_dwordx4 s[4:7], s[0:1], 0
    s_load_dwordx4 s[8:11], s[0:1], 16
    s_load_dwordx2 s[40:41], s[0:1], 32
    s_load_dwordx4 s[16:19], s[0:1], 48
    s_load_dwordx2 s[98:99], s[0:1], 64
    s_load_dwordx2 s[100:101], s[0:1], 88
    s_load_dwordx2 s[56:57], s[0:1], 104
    s_load_dwordx4 s[20:23], s[0:1], 72
    s_load_dwordx2 s[36:37], s[0:1], 96
    v_lshrrev_b32 v200, 1, v0
    v_and_b32 v201, 1, v0
    v_mul_u32_u24 v202, 6144, v200
    v_lshl_add_u32 v202, v201, 4, v202
    s_lshr_b32 s28, s2, 6
    s_lshr_b32 s32, s2, 3
    s_lshr_b32 s33, s32, 2
    s_lshl_b32 s33, s33, 3
    s_and_b32 s34, s2, 7
    s_add_u32 s33, s33, s34
    s_lshl_b32 s33, s33, 2
    s_and_b32 s32, s32, 3
    s_add_u32 s27, s32, s33
    s_lshl_b32 s32, s27, 5
    v_add_u32 v202, s32, v202
    v_add_u32 v203, 786432, v202
    v_add_u32 v204, 1572864, v202
    v_add_u32 v205, 2359296, v202
    v_lshlrev_b32 v206, 1, v200
    v_and_b32 v207, 63, v0
    v_lshrrev_b32 v208, 6, v0
    v_lshrrev_b32 v209, 2, v207
    v_and_b32 v210, 3, v207
    s_lshl_b32 s32, s2, 3
    v_lshl_add_u32 v211, v208, 1, s32
    v_lshlrev_b32 v212, 6, v209
    v_lshl_add_u32 v212, v210, 3, v212
    v_lshl_add_u32 v213, v211, 10, v212
    s_and_b32 s32, s2, 7
    s_lshr_b32 s33, s32, 1
    s_lshl_b32 s33, s33, 3
    s_lshr_b32 s34, s2, 5
    s_add_u32 s46, s33, s34
    s_and_b32 s32, s32, 1
    s_lshl_b32 s32, s32, 2
    s_lshr_b32 s34, s2, 3
    s_and_b32 s34, s34, 3
    s_add_u32 s47, s32, s34
    v_and_b32 v22, 63, v0
    v_lshrrev_b32 v23, 6, v0
    v_lshrrev_b32 v26, 4, v22
    v_readfirstlane_b32 s38, v23
    v_and_b32 v25, 15, v22
    v_lshlrev_b32 v28, 1, v26
    v_xor_b32 v28, v25, v28
    v_lshl_add_u32 v29, v23, 4, v26
    v_lshlrev_b32 v30, 13, v26
    v_lshl_add_u32 v96, v28, 4, v30
    v_xor_b32 v97, 0x80, v96
    v_add_u32 v98, 63488, v96
    v_add_u32 v99, 95232, v97
    v_add_u32 v97, 31744, v97
    v_lshlrev_b32 v30, 16, v23
    v_lshl_add_u32 v100, v22, 4, v30
    s_lshl_b32 s26, s38, 12
    s_memrealtime s[34:35]
    s_waitcnt lgkmcnt(0)
    s_mov_b32 s3, s34
    s_or_b32 s32, s2, s38
    s_cbranch_scc1 L_notag
    s_or_b32 s34, s34, 1
    v_mov_b32 v224, 0
    v_mov_b32 v225, s34
    s_mov_b64 exec, 1
    global_store_dword v224, v225, s[36:37] sc1
    s_mov_b64 exec, -1
L_notag:
    s_cmp_eq_u32 s28, 3
    s_cbranch_scc1 L_nomod_ld
    global_load_ushort v128, v206, s[20:21] offset:0
    global_load_ushort v129, v206, s[20:21] offset:256
    global_load_ushort v130, v206, s[20:21] offset:512
    global_load_ushort v131, v206, s[20:21] offset:768
    global_load_dwordx4 v[132:135], v202, s[22:23]
    global_load_dwordx4 v[136:139], v203, s[22:23]
    global_load_dwordx4 v[140:143], v204, s[22:23]
    global_load_dwordx4 v[144:147], v205, s[22:23]
L_nomod_ld:
    global_load_dwordx2 v[160:161], v213, s[4:5] offset:0
    global_load_dwordx2 v[162:163], v213, s[4:5] offset:32
    global_load_dwordx2 v[164:165], v213, s[4:5] offset:1024
    global_load_dwordx2 v[166:167], v213, s[4:5] offset:1056
    v_and_b32 v224, 63, v0
    s_and_b32 s32, s2, 15
    s_lshl_b32 s32, s32, 13
    v_lshl_add_u32 v224, v224, 7, s32
    s_cmp_lg_u32 s28, 3
    s_cbranch_scc1 L_notouch
    global_load_dword v112, v224, s[56:57] sc1
L_notouch:
    s_getpc_b64 s[32:33]
L_pc0:
    v_lshlrev_b32 v224, 7, v0
    v_min_u32 v224, L_tail-L_pc0-4, v224
    v_mov_b32 v225, s33
    v_add_co_u32 v224, vcc, s32, v224
    s_nop 1
    v_addc_co_u32 v225, vcc, 0, v225, vcc
    global_load_dword v112, v[224:225], off
    s_mov_b32 s58, s4
    s_mov_b32 s59, s5
    s_lshl_b32 s35, s46, 8
    s_sub_u32 s34, 4194304, s35
    s_add_u32 s12, s10, s35
    s_addc_u32 s13, s11, 0
    s_mov_b32 s14, s34
    s_mov_b32 s15, 0x20000
    s_bitcmp0_b32 s2, 0
    s_cselect_b32 s96, s16, s18
    s_cselect_b32 s97, s17, s19
    s_add_u32 s32, s56, 67108864
    s_addc_u32 s33, s57, 0
    s_mov_b32 s34, 3670016
    s_cmp_eq_u32 s38, 3
    s_cselect_b32 s32, s98, s32
    s_cselect_b32 s33, s99, s33
    s_cselect_b32 s34, 1835008, s34
    s_cmp_eq_u32 s38, 0
    s_cselect_b32 s48, s40, s32
    s_cselect_b32 s49, s41, s33
    s_cselect_b32 s50, 4194304, s34
    s_mov_b32 s51, 0x20000
    s_lshl_b32 s35, s47, 18
    s_add_u32 s35, s35, 131072
    s_add_u32 s16, s56, s35
    s_addc_u32 s17, s57, 0
    s_mov_b32 s18, 262144
    s_mov_b32 s19, 0x20000
    s_mov_b32 s30, 0
    s_mov_b32 s29, 0
    s_mov_b32 s31, 16384
    v_add_u32 v102, 32768, v100
    s_mov_b32 s45, s28
    s_lshl_b32 s35, s46, 19
    s_add_u32 s4, s6, s35
    s_addc_u32 s5, s7, 0
    s_mov_b32 s6, 524288
    s_mov_b32 s7, 0x20000
    s_add_u32 s8, s8, s35
    s_addc_u32 s9, s9, 0
    s_mov_b32 s10, 524288
    s_mov_b32 s11, 0x20000
    s_lshl_b32 s35, s47, 21
    s_lshl_b32 s34, s46, 12
    s_add_u32 s35, s35, s34
    s_add_u32 s35, s35, 4194304
    s_add_u32 s20, s56, s35
    s_addc_u32 s21, s57, 0
    s_mov_b32 s22, 2097152
    s_mov_b32 s23, 0x20000
    s_add_u32 s52, s56, 32768
    s_addc_u32 s53, s57, 0
    s_mov_b32 s54, 83968
    s_mov_b32 s55, 0x20000
    s_lshr_b32 s35, s46, 3
    s_and_b32 s34, s46, 1
    s_lshl_b32 s33, s47, 1
    s_add_u32 s33, s33, s34
    s_bfe_u32 s34, s46, 0x20001
    s_lshl_b32 s35, s35, 20
    s_lshl_b32 s34, s34, 8
    s_add_u32 s35, s35, s34
    s_sub_u32 s34, 4194304, s35
    s_add_u32 s40, s40, s35
    s_addc_u32 s41, s41, 0
    s_mov_b32 s42, s34
    s_mov_b32 s43, 0x20000
    s_mov_b32 s24, 0
    s_mov_b32 s25, 0
    s_mov_b32 s28, 0
    s_and_b32 s44, s46, 7
    s_lshl_b32 s44, s44, 17
    v_lshlrev_b32 v113, 6, v22
    v_lshlrev_b32 v27, 12, v23
    v_lshl_add_u32 v27, v26, 8, v27
    v_lshl_add_u32 v17, v28, 4, v27
    v_xor_b32 v18, 0x80, v17
    v_xor_b32 v28, v25, v26
    v_lshl_add_u32 v13, v28, 4, v27
    v_xor_b32 v14, 64, v13
    v_xor_b32 v15, 128, v13
    v_xor_b32 v16, 192, v13
    v_lshlrev_b32 v30, 1, v26
    v_xor_b32 v30, v25, v30
    v_lshlrev_b32 v31, 10, v29
    v_lshl_add_u32 v108, v30, 4, v31
    v_xor_b32 v109, 0x80, v108
    v_add_u32 v110, 6144, v108
    v_add_u32 v111, 9216, v109
    v_add_u32 v109, 3072, v109
    v_lshlrev_b32 v27, 8, v25
    v_lshl_add_u32 v1, v28, 4, v27
    v_xor_b32 v2, 64, v1
    v_xor_b32 v3, 128, v1
    v_xor_b32 v4, 192, v1
    v_lshrrev_b32 v27, 2, v22
    v_and_b32 v28, 7, v27
    v_lshlrev_b32 v27, 8, v27
    v_add_u32 v27, 0x10000, v27
    v_and_b32 v29, 3, v22
    v_lshl_add_u32 v30, v28, 5, v27
    v_lshl_add_u32 v5, v29, 3, v30
    v_xor_b32 v6, 32, v5
    v_xor_b32 v7, 64, v5
    v_xor_b32 v8, 96, v5
    v_xor_b32 v9, 128, v5
    v_xor_b32 v10, 160, v5
    v_xor_b32 v11, 192, v5
    v_xor_b32 v12, 224, v5
    v_lshrrev_b32 v30, 1, v29
    v_xor_b32 v30, v30, v28
    v_lshl_add_u32 v30, v30, 5, v27
    v_and_b32 v29, 1, v29
    v_lshl_add_u32 v104, v29, 4, v30
    v_xor_b32 v105, 64, v104
    v_xor_b32 v106, 128, v104
    v_xor_b32 v107, 192, v104
    v_lshlrev_b32 v29, 19, v23
    v_lshl_add_u32 v101, v22, 4, v29
    v_subrev_u32 v24, 0x10000, v104
    v_subrev_u32 v25, 0x10000, v105
    v_subrev_u32 v26, 0x10000, v106
    v_subrev_u32 v27, 0x10000, v107
    v_and_b32 v30, 7, v22
    v_lshlrev_b32 v103, 7, v30
    v_mov_b32 v30, 0x3f803f80
    v_accvgpr_write_b32 a240, v30
    v_accvgpr_write_b32 a241, v30
    v_accvgpr_write_b32 a242, v30
    v_accvgpr_write_b32 a243, v30
    s_bfe_u32 s32, s2, 0x30001
    s_lshl_b32 s32, s32, 2
    s_add_u32 s32, s32, s38
    s_mul_i32 s32, s32, 57344
    s_lshr_b32 s33, s2, 4
    s_mul_i32 s33, s33, 224
    s_add_u32 s32, s32, s33
    s_mul_i32 s33, s2, 14336
    s_mul_i32 s34, s38, 3584
    s_add_u32 s33, s33, s34
    s_add_u32 s33, s33, 67108864
    v_lshl_add_u32 v114, v22, 4, s33
    v_min_u32 v115, 31, v22
    v_add_u32 v116, 0, v22
    v_mul_u32_u24 v117, 4682, v116
    v_lshrrev_b32 v117, 16, v117
    v_mul_u32_u24 v118, 14, v117
    v_sub_u32 v116, v116, v118
    v_mul_u32_u24 v117, 3584, v117
    v_lshl_add_u32 v117, v116, 4, v117
    v_add_u32 v28, s32, v117
    v_add_u32 v116, 64, v22
    v_mul_u32_u24 v117, 4682, v116
    v_lshrrev_b32 v117, 16, v117
    v_mul_u32_u24 v118, 14, v117
    v_sub_u32 v116, v116, v118
    v_mul_u32_u24 v117, 3584, v117
    v_lshl_add_u32 v117, v116, 4, v117
    v_add_u32 v29, s32, v117
    v_add_u32 v116, 128, v22
    v_mul_u32_u24 v117, 4682, v116
    v_lshrrev_b32 v117, 16, v117
    v_mul_u32_u24 v118, 14, v117
    v_sub_u32 v116, v116, v118
    v_mul_u32_u24 v117, 3584, v117
    v_lshl_add_u32 v117, v116, 4, v117
    v_add_u32 v30, s32, v117
    v_add_u32 v116, 192, v115
    v_mul_u32_u24 v117, 4682, v116
    v_lshrrev_b32 v117, 16, v117
    v_mul_u32_u24 v118, 14, v117
    v_sub_u32 v116, v116, v118
    v_mul_u32_u24 v117, 3584, v117
    v_lshl_add_u32 v117, v116, 4, v117
    v_add_u32 v31, s32, v117
    v_lshl_add_u32 v115, v115, 4, s33
    v_add_u32 v19, 0x10000, v104
    v_add_u32 v20, 0x10000, v105
    v_add_u32 v21, 0x10000, v106
    v_add_u32 v22, 0x10000, v107
    v_mov_b32 v217, 0
    global_load_dword v126, v217, s[36:37] sc1
    v_lshlrev_b32 v214, 1, v212
    v_add_u32 v214, 16384, v214
    v_lshlrev_b32 v216, 7, v207
    v_lshl_add_u32 v216, v208, 5, v216
    v_add_u32 v216, 0x1000, v216
    v_lshlrev_b32 v221, 4, v207
    v_lshl_add_u32 v221, v208, 11, v221
    v_add_u32 v221, 0x1000, v221
    v_lshrrev_b32 v215, 3, v207
    v_lshl_add_u32 v215, v208, 4, v215
    v_lshlrev_b32 v215, 8, v215
    v_and_b32 v222, 7, v207
    v_lshl_add_u32 v215, v222, 4, v215
    s_lshr_b32 s32, s2, 1
    s_lshl_b32 s32, s32, 14
    s_and_b32 s33, s2, 1
    s_lshl_b32 s33, s33, 7
    s_add_u32 s32, s32, s33
    s_add_u32 s32, s32, 131072
    v_add_u32 v215, s32, v215
    v_and_b32 v218, 7, v207
    v_lshlrev_b32 v218, 7, v218
    s_cmp_eq_u32 s45, 3
    s_cbranch_scc1 L_nomod
    s_waitcnt vmcnt(10)
    v_lshlrev_b32 v128, 16, v128
    v_lshlrev_b32 v129, 16, v129
    v_lshlrev_b32 v130, 16, v130
    v_lshlrev_b32 v131, 16, v131
    v_mul_f32 v192, 0xbfb8aa3b, v128
    v_mul_f32 v193, 0xbfb8aa3b, v129
    v_mul_f32 v194, 0xbfb8aa3b, v130
    v_mul_f32 v195, 0xbfb8aa3b, v131
    v_exp_f32 v192, v192
    v_exp_f32 v193, v193
    v_exp_f32 v194, v194
    v_exp_f32 v195, v195
    v_add_f32 v192, 1.0, v192
    v_add_f32 v193, 1.0, v193
    v_add_f32 v194, 1.0, v194
    v_add_f32 v195, 1.0, v195
    v_rcp_f32 v192, v192
    v_rcp_f32 v193, v193
    v_rcp_f32 v194, v194
    v_rcp_f32 v195, v195
    v_mul_f32 v128, v128, v192
    v_mul_f32 v129, v129, v193
    v_mul_f32 v130, v130, v194
    v_mul_f32 v131, v131, v195
    v_cvt_pk_bf16_f32 v192, v128, v129
    v_cvt_pk_bf16_f32 v193, v130, v131
    v_lshlrev_b32 v128, 16, v192
    v_and_b32 v129, 0xffff0000, v192
    v_lshlrev_b32 v130, 16, v193
    v_and_b32 v131, 0xffff0000, v193
    v_lshrrev_b32 v219, 4, v0
    v_lshlrev_b32 v219, 6, v219
    v_lshl_add_u32 v219, v201, 5, v219
    v_and_b32 v220, 15, v0
    s_waitcnt vmcnt(9)
    v_lshlrev_b32 v192, 16, v132
    v_and_b32 v193, 0xffff0000, v132
    v_lshlrev_b32 v194, 16, v133
    v_and_b32 v195, 0xffff0000, v133
    v_lshlrev_b32 v196, 16, v134
    v_and_b32 v197, 0xffff0000, v134
    v_lshlrev_b32 v198, 16, v135
    v_and_b32 v199, 0xffff0000, v135
    v_mul_f32 v148, v128, v192
    v_mul_f32 v149, v128, v193
    v_mul_f32 v150, v128, v194
    v_mul_f32 v151, v128, v195
    v_mul_f32 v152, v128, v196
    v_mul_f32 v153, v128, v197
    v_mul_f32 v154, v128, v198
    v_mul_f32 v155, v128, v199
    s_waitcnt vmcnt(8)
    v_lshlrev_b32 v192, 16, v136
    v_and_b32 v193, 0xffff0000, v136
    v_lshlrev_b32 v194, 16, v137
    v_and_b32 v195, 0xffff0000, v137
    v_lshlrev_b32 v196, 16, v138
    v_and_b32 v197, 0xffff0000, v138
    v_lshlrev_b32 v198, 16, v139
    v_and_b32 v199, 0xffff0000, v139
    v_fmac_f32 v148, v129, v192
    v_fmac_f32 v149, v129, v193
    v_fmac_f32 v150, v129, v194
    v_fmac_f32 v151, v129, v195
    v_fmac_f32 v152, v129, v196
    v_fmac_f32 v153, v129, v197
    v_fmac_f32 v154, v129, v198
    v_fmac_f32 v155, v129, v199
    s_waitcnt vmcnt(7)
    v_lshlrev_b32 v192, 16, v140
    v_and_b32 v193, 0xffff0000, v140
    v_lshlrev_b32 v194, 16, v141
    v_and_b32 v195, 0xffff0000, v141
    v_lshlrev_b32 v196, 16, v142
    v_and_b32 v197, 0xffff0000, v142
    v_lshlrev_b32 v198, 16, v143
    v_and_b32 v199, 0xffff0000, v143
    v_fmac_f32 v148, v130, v192
    v_fmac_f32 v149, v130, v193
    v_fmac_f32 v150, v130, v194
    v_fmac_f32 v151, v130, v195
    v_fmac_f32 v152, v130, v196
    v_fmac_f32 v153, v130, v197
    v_fmac_f32 v154, v130, v198
    v_fmac_f32 v155, v130, v199
    s_waitcnt vmcnt(6)
    v_lshlrev_b32 v192, 16, v144
    v_and_b32 v193, 0xffff0000, v144
    v_lshlrev_b32 v194, 16, v145
    v_and_b32 v195, 0xffff0000, v145
    v_lshlrev_b32 v196, 16, v146
    v_and_b32 v197, 0xffff0000, v146
    v_lshlrev_b32 v198, 16, v147
    v_and_b32 v199, 0xffff0000, v147
    v_fmac_f32 v148, v131, v192
    v_fmac_f32 v149, v131, v193
    v_fmac_f32 v150, v131, v194
    v_fmac_f32 v151, v131, v195
    v_fmac_f32 v152, v131, v196
    v_fmac_f32 v153, v131, v197
    v_fmac_f32 v154, v131, v198
    v_fmac_f32 v155, v131, v199
    v_add_f32_dpp v148, v148, v148 quad_perm:[2,3,0,1] row_mask:0xf bank_mask:0xf
    v_add_f32_dpp v149, v149, v149 quad_perm:[2,3,0,1] row_mask:0xf bank_mask:0xf
    v_add_f32_dpp v150, v150, v150 quad_perm:[2,3,0,1] row_mask:0xf bank_mask:0xf
    v_add_f32_dpp v151, v151, v151 quad_perm:[2,3,0,1] row_mask:0xf bank_mask:0xf
    v_add_f32_dpp v152, v152, v152 quad_perm:[2,3,0,1] row_mask:0xf bank_mask:0xf
    v_add_f32_dpp v153, v153, v153 quad_perm:[2,3,0,1] row_mask:0xf bank_mask:0xf
    v_add_f32_dpp v154, v154, v154 quad_perm:[2,3,0,1] row_mask:0xf bank_mask:0xf
    v_add_f32_dpp v155, v155, v155 quad_perm:[2,3,0,1] row_mask:0xf bank_mask:0xf
    v_add_f32_dpp v148, v148, v148 row_ror:4 row_mask:0xf bank_mask:0xf
    v_add_f32_dpp v149, v149, v149 row_ror:4 row_mask:0xf bank_mask:0xf
    v_add_f32_dpp v150, v150, v150 row_ror:4 row_mask:0xf bank_mask:0xf
    v_add_f32_dpp v151, v151, v151 row_ror:4 row_mask:0xf bank_mask:0xf
    v_add_f32_dpp v152, v152, v152 row_ror:4 row_mask:0xf bank_mask:0xf
    v_add_f32_dpp v153, v153, v153 row_ror:4 row_mask:0xf bank_mask:0xf
    v_add_f32_dpp v154, v154, v154 row_ror:4 row_mask:0xf bank_mask:0xf
    v_add_f32_dpp v155, v155, v155 row_ror:4 row_mask:0xf bank_mask:0xf
    v_add_f32_dpp v148, v148, v148 row_ror:8 row_mask:0xf bank_mask:0xf
    v_add_f32_dpp v149, v149, v149 row_ror:8 row_mask:0xf bank_mask:0xf
    v_add_f32_dpp v150, v150, v150 row_ror:8 row_mask:0xf bank_mask:0xf
    v_add_f32_dpp v151, v151, v151 row_ror:8 row_mask:0xf bank_mask:0xf
    v_add_f32_dpp v152, v152, v152 row_ror:8 row_mask:0xf bank_mask:0xf
    v_add_f32_dpp v153, v153, v153 row_ror:8 row_mask:0xf bank_mask:0xf
    v_add_f32_dpp v154, v154, v154 row_ror:8 row_mask:0xf bank_mask:0xf
    v_add_f32_dpp v155, v155, v155 row_ror:8 row_mask:0xf bank_mask:0xf
    v_cmp_gt_u32 vcc, 2, v220
    s_and_saveexec_b64 s[32:33], vcc
    ds_write_b128 v219, v[148:151]
    ds_write_b128 v219, v[152:155] offset:16
    s_mov_b64 exec, -1
    v_lshlrev_b32 v219, 4, v207
    s_waitcnt lgkmcnt(0)
    s_barrier
    s_cmp_lg_u32 s38, 0
    s_cbranch_scc1 L_nomod
    ds_read_b128 v[132:135], v219
    s_lshl_b32 s34, s27, 6
    v_add_u32 v219, s34, v219
    s_waitcnt lgkmcnt(0)
    v_add_f32_dpp v132, v132, v132 row_ror:4 row_mask:0xf bank_mask:0xf
    v_add_f32_dpp v133, v133, v133 row_ror:4 row_mask:0xf bank_mask:0xf
    v_add_f32_dpp v134, v134, v134 row_ror:4 row_mask:0xf bank_mask:0xf
    v_add_f32_dpp v135, v135, v135 row_ror:4 row_mask:0xf bank_mask:0xf
    v_add_f32_dpp v132, v132, v132 row_ror:8 row_mask:0xf bank_mask:0xf
    v_add_f32_dpp v133, v133, v133 row_ror:8 row_mask:0xf bank_mask:0xf
    v_add_f32_dpp v134, v134, v134 row_ror:8 row_mask:0xf bank_mask:0xf
    v_add_f32_dpp v135, v135, v135 row_ror:8 row_mask:0xf bank_mask:0xf
    v_mov_b32 v136, v132
    v_mov_b32 v137, v133
    v_mov_b32 v138, v134
    v_mov_b32 v139, v135
    s_nop 1
    v_permlane16_swap_b32 v132, v136
    v_permlane16_swap_b32 v133, v137
    v_permlane16_swap_b32 v134, v138
    v_permlane16_swap_b32 v135, v139
    v_add_f32 v132, v132, v136
    v_add_f32 v133, v133, v137
    v_add_f32 v134, v134, v138
    v_add_f32 v135, v135, v139
    v_mov_b32 v136, v132
    v_mov_b32 v137, v133
    v_mov_b32 v138, v134
    v_mov_b32 v139, v135
    s_nop 1
    v_permlane32_swap_b32 v132, v136
    v_permlane32_swap_b32 v133, v137
    v_permlane32_swap_b32 v134, v138
    v_permlane32_swap_b32 v135, v139
    v_add_f32 v132, v132, v136
    v_add_f32 v133, v133, v137
    v_add_f32 v134, v134, v138
    v_add_f32 v135, v135, v139
    v_cvt_pk_bf16_f32 v136, v132, v133
    v_cvt_pk_bf16_f32 v137, v134, v135
    s_cmp_eq_u32 s45, 0
    s_cbranch_scc1 L_modtag
    v_lshlrev_b32 v132, 16, v136
    v_and_b32 v133, 0xffff0000, v136
    v_lshlrev_b32 v134, 16, v137
    v_and_b32 v135, 0xffff0000, v137
    s_mov_b64 exec, 15
    global_store_dwordx4 v219, v[132:135], s[56:57] sc1
    s_mov_b64 exec, -1
    s_branch L_nomod
L_modtag:
    s_mov_b32 s39, 0
L_tag1:
    s_waitcnt vmcnt(0)
    v_readfirstlane_b32 s32, v126
    s_add_u32 s39, s39, 1
    s_cmp_ge_u32 s39, 0x40000
    s_cbranch_scc1 L_tagged1
    s_sub_u32 s33, s3, s32
    s_add_u32 s33, s33, 2048
    s_cmp_ge_u32 s39, 256
    s_cselect_b32 s33, 0, s33
    s_cmp_eq_u32 s32, 0
    s_cselect_b32 s33, -1, s33
    s_cmp_lt_u32 s33, 4096
    s_cbranch_scc1 L_tagged1
    global_load_dword v126, v217, s[36:37] sc1
    s_waitcnt vmcnt(0)
    s_branch L_tag1
L_tagged1:
    v_mov_b32 v138, v126
    v_mov_b32 v139, v126
    v_add_u32 v219, 16384, v219
    s_mov_b64 exec, 15
    global_store_dwordx4 v219, v[136:139], s[56:57] sc1
    s_mov_b64 exec, -1
L_nomod:
    s_waitcnt vmcnt(2)
    v_lshlrev_b32 v132, 16, v160
    v_and_b32 v133, 0xffff0000, v160
    v_lshlrev_b32 v134, 16, v161
    v_and_b32 v135, 0xffff0000, v161
    v_lshlrev_b32 v136, 16, v162
    v_and_b32 v137, 0xffff0000, v162
    v_lshlrev_b32 v138, 16, v163
    v_and_b32 v139, 0xffff0000, v163
    v_lshlrev_b32 v140, 16, v164
    v_and_b32 v141, 0xffff0000, v164
    v_lshlrev_b32 v142, 16, v165
    v_and_b32 v143, 0xffff0000, v165
    v_lshlrev_b32 v144, 16, v166
    v_and_b32 v145, 0xffff0000, v166
    v_lshlrev_b32 v146, 16, v167
    v_and_b32 v147, 0xffff0000, v167
    v_add_f32 v148, v132, v133
    v_add_f32 v148, v148, v134
    v_add_f32 v148, v148, v135
    v_add_f32 v148, v148, v136
    v_add_f32 v148, v148, v137
    v_add_f32 v148, v148, v138
    v_add_f32 v148, v148, v139
    v_add_f32 v149, v140, v141
    v_add_f32 v149, v149, v142
    v_add_f32 v149, v149, v143
    v_add_f32 v149, v149, v144
    v_add_f32 v149, v149, v145
    v_add_f32 v149, v149, v146
    v_add_f32 v149, v149, v147
    s_nop 1
    v_add_f32_dpp v148, v148, v148 quad_perm:[1,0,3,2] row_mask:0xf bank_mask:0xf
    v_add_f32_dpp v149, v149, v149 quad_perm:[1,0,3,2] row_mask:0xf bank_mask:0xf
    s_nop 1
    v_add_f32_dpp v148, v148, v148 quad_perm:[2,3,0,1] row_mask:0xf bank_mask:0xf
    v_add_f32_dpp v149, v149, v149 quad_perm:[2,3,0,1] row_mask:0xf bank_mask:0xf
    s_nop 1
    v_add_f32_dpp v148, v148, v148 row_ror:4 row_mask:0xf bank_mask:0xf
    v_add_f32_dpp v149, v149, v149 row_ror:4 row_mask:0xf bank_mask:0xf
    s_nop 1
    v_add_f32_dpp v148, v148, v148 row_ror:8 row_mask:0xf bank_mask:0xf
    v_add_f32_dpp v149, v149, v149 row_ror:8 row_mask:0xf bank_mask:0xf
    v_mov_b32 v152, v148
    v_mov_b32 v153, v149
    s_nop 1
    v_permlane16_swap_b32 v148, v152
    v_permlane16_swap_b32 v149, v153
    v_add_f32 v148, v148, v152
    v_add_f32 v149, v149, v153
    v_mov_b32 v152, v148
    v_mov_b32 v153, v149
    s_nop 1
    v_permlane32_swap_b32 v148, v152
    v_permlane32_swap_b32 v149, v153
    v_add_f32 v148, v148, v152
    v_add_f32 v149, v149, v153
    v_mul_f32 v148, 0x3b000000, v148
    v_mul_f32 v149, 0x3b000000, v149
    v_sub_f32 v132, v132, v148
    v_sub_f32 v133, v133, v148
    v_sub_f32 v134, v134, v148
    v_sub_f32 v135, v135, v148
    v_sub_f32 v136, v136, v148
    v_sub_f32 v137, v137, v148
    v_sub_f32 v138, v138, v148
    v_sub_f32 v139, v139, v148
    v_sub_f32 v140, v140, v149
    v_sub_f32 v141, v141, v149
    v_sub_f32 v142, v142, v149
    v_sub_f32 v143, v143, v149
    v_sub_f32 v144, v144, v149
    v_sub_f32 v145, v145, v149
    v_sub_f32 v146, v146, v149
    v_sub_f32 v147, v147, v149
    v_mul_f32 v150, v132, v132
    v_fmac_f32 v150, v133, v133
    v_fmac_f32 v150, v134, v134
    v_fmac_f32 v150, v135, v135
    v_fmac_f32 v150, v136, v136
    v_fmac_f32 v150, v137, v137
    v_fmac_f32 v150, v138, v138
    v_fmac_f32 v150, v139, v139
    v_mul_f32 v151, v140, v140
    v_fmac_f32 v151, v141, v141
    v_fmac_f32 v151, v142, v142
    v_fmac_f32 v151, v143, v143
    v_fmac_f32 v151, v144, v144
    v_fmac_f32 v151, v145, v145
    v_fmac_f32 v151, v146, v146
    v_fmac_f32 v151, v147, v147
    s_nop 1
    v_add_f32_dpp v150, v150, v150 quad_perm:[1,0,3,2] row_mask:0xf bank_mask:0xf
    v_add_f32_dpp v151, v151, v151 quad_perm:[1,0,3,2] row_mask:0xf bank_mask:0xf
    s_nop 1
    v_add_f32_dpp v150, v150, v150 quad_perm:[2,3,0,1] row_mask:0xf bank_mask:0xf
    v_add_f32_dpp v151, v151, v151 quad_perm:[2,3,0,1] row_mask:0xf bank_mask:0xf
    s_nop 1
    v_add_f32_dpp v150, v150, v150 row_ror:4 row_mask:0xf bank_mask:0xf
    v_add_f32_dpp v151, v151, v151 row_ror:4 row_mask:0xf bank_mask:0xf
    s_nop 1
    v_add_f32_dpp v150, v150, v150 row_ror:8 row_mask:0xf bank_mask:0xf
    v_add_f32_dpp v151, v151, v151 row_ror:8 row_mask:0xf bank_mask:0xf
    v_mov_b32 v152, v150
    v_mov_b32 v153, v151
    s_nop 1
    v_permlane16_swap_b32 v150, v152
    v_permlane16_swap_b32 v151, v153
    v_add_f32 v150, v150, v152
    v_add_f32 v151, v151, v153
    v_mov_b32 v152, v150
    v_mov_b32 v153, v151
    s_nop 1
    v_permlane32_swap_b32 v150, v152
    v_permlane32_swap_b32 v151, v153
    v_add_f32 v150, v150, v152
    v_add_f32 v151, v151, v153
    v_mul_f32 v150, 0x3b000000, v150
    v_mul_f32 v151, 0x3b000000, v151
    v_add_f32 v150, 0x3727c5ac, v150
    v_add_f32 v151, 0x3727c5ac, v151
    v_rsq_f32 v150, v150
    v_rsq_f32 v151, v151
    s_nop 0
    v_mul_f32 v132, v132, v150
    v_mul_f32 v133, v133, v150
    v_mul_f32 v134, v134, v150
    v_mul_f32 v135, v135, v150
    v_mul_f32 v136, v136, v150
    v_mul_f32 v137, v137, v150
    v_mul_f32 v138, v138, v150
    v_mul_f32 v139, v139, v150
    v_mul_f32 v140, v140, v151
    v_mul_f32 v141, v141, v151
    v_mul_f32 v142, v142, v151
    v_mul_f32 v143, v143, v151
    v_mul_f32 v144, v144, v151
    v_mul_f32 v145, v145, v151
    v_mul_f32 v146, v146, v151
    v_mul_f32 v147, v147, v151
    v_lshlrev_b32 v219, 4, v207
    v_add_u32 v219, 0x800, v219
    s_cmp_eq_u32 s38, 0
    s_cbranch_scc1 L_wave0
    s_sub_u32 s32, s38, 1
    s_lshl_b32 s33, s32, 12
    s_add_u32 m0, s33, 32768
    s_lshl_b32 s30, s32, 17
L_wloop1:
    buffer_load_dwordx4 v96, s[12:15], s30 offen offset:0 lds
    buffer_load_dwordx4 v97, s[12:15], s30 offen offset:1024 lds
    buffer_load_dwordx4 v98, s[12:15], s30 offen offset:2048 lds
    buffer_load_dwordx4 v99, s[12:15], s30 offen offset:3072 lds
    s_add_u32 m0, m0, 12288
    s_add_u32 s30, s30, 393216
    s_cmp_lt_u32 s30, 4194304
    s_cbranch_scc1 L_wloop1
L_now1:
    s_branch L_skip_m
L_wave0:
    s_mov_b32 s39, 0
L_tag2:
    s_waitcnt vmcnt(0)
    v_readfirstlane_b32 s32, v126
    s_add_u32 s39, s39, 1
    s_cmp_ge_u32 s39, 0x40000
    s_cbranch_scc1 L_tagged2
    s_sub_u32 s33, s3, s32
    s_add_u32 s33, s33, 2048
    s_cmp_ge_u32 s39, 256
    s_cselect_b32 s33, 0, s33
    s_cmp_eq_u32 s32, 0
    s_cselect_b32 s33, -1, s33
    s_cmp_lt_u32 s33, 4096
    s_cbranch_scc1 L_tagged2
    global_load_dword v126, v217, s[36:37] sc1
    s_waitcnt vmcnt(0)
    s_branch L_tag2
L_tagged2:
    s_mov_b32 s39, 0
L_poll_m:
    s_sleep 12
    global_load_dwordx4 v[176:179], v214, s[56:57] offset:0 sc1
    global_load_dwordx4 v[180:183], v214, s[56:57] offset:64 sc1
    global_load_dwordx4 v[184:187], v214, s[56:57] offset:2048 sc1
    global_load_dwordx4 v[188:191], v214, s[56:57] offset:2112 sc1
    s_add_u32 s39, s39, 1
    s_waitcnt vmcnt(0)
    v_xor_b32 v178, v126, v178
    v_xor_b32 v179, v126, v179
    v_xor_b32 v182, v126, v182
    v_xor_b32 v183, v126, v183
    v_xor_b32 v186, v126, v186
    v_xor_b32 v187, v126, v187
    v_xor_b32 v190, v126, v190
    v_xor_b32 v191, v126, v191
    v_or3_b32 v178, v178, v179, v182
    v_or3_b32 v186, v186, v187, v183
    v_or3_b32 v178, v178, v190, v191
    v_or_b32 v178, v178, v186
    s_cmp_ge_u32 s39, 0x40000
    v_cmp_ne_u32 vcc, 0, v178
    s_cbranch_scc1 L_polled_m
    s_cbranch_vccnz L_poll_m
L_polled_m:
    v_mov_b64 v[178:179], v[180:181]
    v_mov_b64 v[186:187], v[188:189]
    ds_write_b128 v219, v[176:179]
    ds_write_b128 v219, v[184:187] offset:1024
    ds_write_b32 v217, v126 offset:1024
    s_waitcnt lgkmcnt(0)
L_skip_m:
    s_barrier
    ds_read_b32 v127, v217 offset:1024
    ds_read_b128 v[152:155], v219
    ds_read_b128 v[156:159], v219 offset:1024
    s_waitcnt lgkmcnt(0)
    v_readfirstlane_b32 s36, v127
    v_lshlrev_b32 v176, 16, v152
    v_and_b32 v177, 0xffff0000, v152
    v_lshlrev_b32 v178, 16, v153
    v_and_b32 v179, 0xffff0000, v153
    v_lshlrev_b32 v180, 16, v154
    v_and_b32 v181, 0xffff0000, v154
    v_lshlrev_b32 v182, 16, v155
    v_and_b32 v183, 0xffff0000, v155
    v_lshlrev_b32 v184, 16, v156
    v_and_b32 v185, 0xffff0000, v156
    v_lshlrev_b32 v186, 16, v157
    v_and_b32 v187, 0xffff0000, v157
    v_lshlrev_b32 v188, 16, v158
    v_and_b32 v189, 0xffff0000, v158
    v_lshlrev_b32 v190, 16, v159
    v_and_b32 v191, 0xffff0000, v159
    s_getreg_b32 s3, hwreg(HW_REG_XCC_ID, 0, 4)
    s_and_b32 s35, s2, 7
    s_lshl_b32 s35, s35, 5
    s_lshr_b32 s34, s2, 3
    s_add_u32 s35, s35, s34
    s_lshl_b32 s35, s35, 2
    s_add_u32 s37, s35, 16384
    s_add_u32 s3, s3, s36
    s_lshl_b32 s32, s2, 7
    s_add_u32 s32, s32, 18432
    s_lshl_b32 s33, s47, 2
    s_add_u32 s33, s33, s38
    s_lshl_b32 s33, s33, 10
    s_add_u32 s33, s33, 18432
    v_add_f32 v184, 1.0, v184
    v_add_f32 v185, 1.0, v185
    v_add_f32 v186, 1.0, v186
    v_add_f32 v187, 1.0, v187
    v_add_f32 v188, 1.0, v188
    v_add_f32 v189, 1.0, v189
    v_add_f32 v190, 1.0, v190
    v_add_f32 v191, 1.0, v191
    v_cvt_pk_bf16_f32 v152, v184, v185
    v_cvt_pk_bf16_f32 v153, v186, v187
    v_cvt_pk_bf16_f32 v154, v188, v189
    v_cvt_pk_bf16_f32 v155, v190, v191
    v_lshlrev_b32 v184, 16, v152
    v_and_b32 v185, 0xffff0000, v152
    v_lshlrev_b32 v186, 16, v153
    v_and_b32 v187, 0xffff0000, v153
    v_lshlrev_b32 v188, 16, v154
    v_and_b32 v189, 0xffff0000, v154
    v_lshlrev_b32 v190, 16, v155
    v_and_b32 v191, 0xffff0000, v155
    v_fma_f32 v132, v132, v184, v176
    v_fma_f32 v133, v133, v185, v177
    v_fma_f32 v134, v134, v186, v178
    v_fma_f32 v135, v135, v187, v179
    v_fma_f32 v136, v136, v188, v180
    v_fma_f32 v137, v137, v189, v181
    v_fma_f32 v138, v138, v190, v182
    v_fma_f32 v139, v139, v191, v183
    v_mul_f32 v132, 0x3e0293ee, v132
    v_mul_f32 v133, 0x3e0293ee, v133
    v_mul_f32 v134, 0x3e0293ee, v134
    v_mul_f32 v135, 0x3e0293ee, v135
    v_mul_f32 v136, 0x3e0293ee, v136
    v_mul_f32 v137, 0x3e0293ee, v137
    v_mul_f32 v138, 0x3e0293ee, v138
    v_mul_f32 v139, 0x3e0293ee, v139
    v_cvt_pk_bf16_f32 v160, v132, v133
    v_cvt_pk_bf16_f32 v161, v134, v135
    v_cvt_pk_bf16_f32 v162, v136, v137
    v_cvt_pk_bf16_f32 v163, v138, v139
    ds_write_b128 v216, v[160:163] offset:0
    v_fma_f32 v140, v140, v184, v176
    v_fma_f32 v141, v141, v185, v177
    v_fma_f32 v142, v142, v186, v178
    v_fma_f32 v143, v143, v187, v179
    v_fma_f32 v144, v144, v188, v180
    v_fma_f32 v145, v145, v189, v181
    v_fma_f32 v146, v146, v190, v182
    v_fma_f32 v147, v147, v191, v183
    v_mul_f32 v140, 0x3e0293ee, v140
    v_mul_f32 v141, 0x3e0293ee, v141
    v_mul_f32 v142, 0x3e0293ee, v142
    v_mul_f32 v143, 0x3e0293ee, v143
    v_mul_f32 v144, 0x3e0293ee, v144
    v_mul_f32 v145, 0x3e0293ee, v145
    v_mul_f32 v146, 0x3e0293ee, v146
    v_mul_f32 v147, 0x3e0293ee, v147
    v_cvt_pk_bf16_f32 v164, v140, v141
    v_cvt_pk_bf16_f32 v165, v142, v143
    v_cvt_pk_bf16_f32 v166, v144, v145
    v_cvt_pk_bf16_f32 v167, v146, v147
    ds_write_b128 v216, v[164:167] offset:16
    s_waitcnt lgkmcnt(0)
    s_barrier
    ds_read_b128 v[160:163], v221 offset:0
    ds_read_b128 v[164:167], v221 offset:1024
    s_waitcnt lgkmcnt(1)
    global_store_dwordx4 v215, v[160:163], s[56:57] offset:0 sc1
    s_waitcnt lgkmcnt(0)
    global_store_dwordx4 v215, v[164:167], s[56:57] offset:2048 sc1
    s_waitcnt vmcnt(0)
    s_barrier
    s_cmp_lg_u32 s38, 0
    s_cbranch_scc1 L_nomod2
    v_mov_b32 v127, s36
    s_lshl_b32 s34, s27, 2
    s_add_u32 s34, s34, 17152
    s_sub_u32 s35, s45, 1
    s_mov_b64 exec, 1
    buffer_store_dword v127, off, s[52:55], s32 sc1
    s_cmp_ge_u32 s35, 2
    s_cbranch_scc1 L_nomod3
    buffer_store_dword v127, off, s[52:55], s34 sc1
L_nomod3:
    s_mov_b64 exec, -1
L_nomod2:
    s_lshl_b32 s45, s2, 12
    s_sub_u32 s34, s38, 1
    s_cmp_lt_u32 s34, 2
    s_cselect_b32 s45, 0x7000000, s45
    s_mov_b32 s39, 0
    s_branch L_pollgo_h
L_poll_h:
    s_sleep 6
L_pollgo_h:
    buffer_load_dword v126, v218, s[52:55], s33 offen sc1
    s_add_u32 s39, s39, 1
    s_waitcnt vmcnt(0)
    v_cmp_ne_u32 vcc, s36, v126
    s_cmp_ge_u32 s39, 0x40000
    s_cbranch_scc1 L_polled_h
    s_cbranch_vccnz L_poll_h
L_polled_h:
    buffer_load_dwordx4 a[0:3], v100, s[16:19], s29 offen offset:0 sc1
    buffer_load_dwordx4 a[4:7], v100, s[16:19], s31 offen offset:0 sc1
    buffer_load_dwordx4 a[8:11], v102, s[16:19], s29 offen offset:0 sc1
    buffer_load_dwordx4 a[12:15], v102, s[16:19], s31 offen offset:0 sc1
    buffer_load_dwordx4 a[16:19], v100, s[16:19], s29 offen offset:1024 sc1
    buffer_load_dwordx4 a[20:23], v100, s[16:19], s31 offen offset:1024 sc1
    buffer_load_dwordx4 a[24:27], v102, s[16:19], s29 offen offset:1024 sc1
    buffer_load_dwordx4 a[28:31], v102, s[16:19], s31 offen offset:1024 sc1
    buffer_load_dwordx4 a[32:35], v100, s[16:19], s29 offen offset:2048 sc1
    buffer_load_dwordx4 a[36:39], v100, s[16:19], s31 offen offset:2048 sc1
    buffer_load_dwordx4 a[40:43], v102, s[16:19], s29 offen offset:2048 sc1
    buffer_load_dwordx4 a[44:47], v102, s[16:19], s31 offen offset:2048 sc1
    buffer_load_dwordx4 a[48:51], v100, s[16:19], s29 offen offset:3072 sc1
    buffer_load_dwordx4 a[52:55], v100, s[16:19], s31 offen offset:3072 sc1
    buffer_load_dwordx4 a[56:59], v102, s[16:19], s29 offen offset:3072 sc1
    buffer_load_dwordx4 a[60:63], v102, s[16:19], s31 offen offset:3072 sc1
    s_add_u32 s29, s29, 4096
    s_add_u32 s31, s31, 4096
    ds_read_b64_tr_b16 a[128:129], v24 offset:32768
    buffer_load_dwordx4 a[64:67], v100, s[16:19], s29 offen offset:0 sc1
    ds_read_b64_tr_b16 a[130:131], v24 offset:36864
    ds_read_b64_tr_b16 a[132:133], v24 offset:40960
    buffer_load_dwordx4 a[68:71], v100, s[16:19], s31 offen offset:0 sc1
    ds_read_b64_tr_b16 a[134:135], v24 offset:45056
    ds_read_b64_tr_b16 a[136:137], v24 offset:32776
    ds_read_b64_tr_b16 a[138:139], v24 offset:36872
    buffer_load_dwordx4 a[72:75], v102, s[16:19], s29 offen offset:0 sc1
    ds_read_b64_tr_b16 a[140:141], v24 offset:40968
    ds_read_b64_tr_b16 a[142:143], v24 offset:45064
    buffer_load_dwordx4 a[76:79], v102, s[16:19], s31 offen offset:0 sc1
    ds_read_b64_tr_b16 a[144:145], v25 offset:32768
    ds_read_b64_tr_b16 a[146:147], v25 offset:36864
    ds_read_b64_tr_b16 a[148:149], v25 offset:40960
    buffer_load_dwordx4 a[80:83], v100, s[16:19], s29 offen offset:1024 sc1
    ds_read_b64_tr_b16 a[150:151], v25 offset:45056
    s_waitcnt lgkmcnt(4)
    s_waitcnt vmcnt(20)
    v_mfma_f32_16x16x32_bf16 v[128:131], a[128:131], a[0:3], 0
    ds_read_b64_tr_b16 a[152:153], v25 offset:32776
    s_waitcnt vmcnt(16)
    v_mfma_f32_16x16x32_bf16 v[128:131], a[132:135], a[16:19], v[128:131]
    s_waitcnt vmcnt(15)
    v_mfma_f32_16x16x32_bf16 v[132:135], a[132:135], a[20:23], 0
    buffer_load_dwordx4 a[84:87], v100, s[16:19], s31 offen offset:1024 sc1
    ds_read_b64_tr_b16 a[154:155], v25 offset:36872
    v_mfma_f32_16x16x32_bf16 v[132:135], a[128:131], a[4:7], v[132:135]
    v_mfma_f32_16x16x32_bf16 v[136:139], a[128:131], a[8:11], 0
    ds_read_b64_tr_b16 a[156:157], v25 offset:40968
    s_waitcnt vmcnt(15)
    v_mfma_f32_16x16x32_bf16 v[136:139], a[132:135], a[24:27], v[136:139]
    s_waitcnt vmcnt(14)
    v_mfma_f32_16x16x32_bf16 v[140:143], a[132:135], a[28:31], 0
    ds_read_b64_tr_b16 a[158:159], v25 offset:45064
    v_mfma_f32_16x16x32_bf16 v[140:143], a[128:131], a[12:15], v[140:143]
    buffer_load_dwordx4 a[88:91], v102, s[16:19], s29 offen offset:1024 sc1
    v_mfma_f32_16x16x32_bf16 v[156:159], a[136:139], a[12:15], 0
    ds_read_b64_tr_b16 a[160:161], v26 offset:32768
    v_mfma_f32_16x16x32_bf16 v[156:159], a[140:143], a[28:31], v[156:159]
    v_mfma_f32_16x16x32_bf16 v[152:155], a[140:143], a[24:27], 0
    ds_read_b64_tr_b16 a[162:163], v26 offset:36864
    v_mfma_f32_16x16x32_bf16 v[152:155], a[136:139], a[8:11], v[152:155]
    v_mfma_f32_16x16x32_bf16 v[148:151], a[136:139], a[4:7], 0
    buffer_load_dwordx4 a[92:95], v102, s[16:19], s31 offen offset:1024 sc1
    ds_read_b64_tr_b16 a[164:165], v26 offset:40960
    v_mfma_f32_16x16x32_bf16 v[148:151], a[140:143], a[20:23], v[148:151]
    v_mfma_f32_16x16x32_bf16 v[144:147], a[140:143], a[16:19], 0
    ds_read_b64_tr_b16 a[166:167], v26 offset:45056
    v_mfma_f32_16x16x32_bf16 v[144:147], a[136:139], a[0:3], v[144:147]
    s_waitcnt lgkmcnt(4)
    v_mfma_f32_16x16x32_bf16 v[160:163], a[144:147], a[0:3], 0
    ds_read_b64_tr_b16 a[168:169], v26 offset:32776
    v_mfma_f32_16x16x32_bf16 v[160:163], a[148:151], a[16:19], v[160:163]
    v_mfma_f32_16x16x32_bf16 v[164:167], a[148:151], a[20:23], 0
    ds_read_b64_tr_b16 a[170:171], v26 offset:36872
    v_mfma_f32_16x16x32_bf16 v[164:167], a[144:147], a[4:7], v[164:167]
    v_mfma_f32_16x16x32_bf16 v[168:171], a[144:147], a[8:11], 0
    ds_read_b64_tr_b16 a[172:173], v26 offset:40968
    v_mfma_f32_16x16x32_bf16 v[168:171], a[148:151], a[24:27], v[168:171]
    v_mfma_f32_16x16x32_bf16 v[172:175], a[148:151], a[28:31], 0
    ds_read_b64_tr_b16 a[174:175], v26 offset:45064
    v_mfma_f32_16x16x32_bf16 v[172:175], a[144:147], a[12:15], v[172:175]
    v_mfma_f32_16x16x32_bf16 v[188:191], a[152:155], a[12:15], 0
    ds_read_b64_tr_b16 a[176:177], v27 offset:32768
    v_mfma_f32_16x16x32_bf16 v[188:191], a[156:159], a[28:31], v[188:191]
    v_mfma_f32_16x16x32_bf16 v[184:187], a[156:159], a[24:27], 0
    ds_read_b64_tr_b16 a[178:179], v27 offset:36864
    v_mfma_f32_16x16x32_bf16 v[184:187], a[152:155], a[8:11], v[184:187]
    v_mfma_f32_16x16x32_bf16 v[180:183], a[152:155], a[4:7], 0
    ds_read_b64_tr_b16 a[180:181], v27 offset:40960
    v_mfma_f32_16x16x32_bf16 v[180:183], a[156:159], a[20:23], v[180:183]
    v_mfma_f32_16x16x32_bf16 v[176:179], a[156:159], a[16:19], 0
    ds_read_b64_tr_b16 a[182:183], v27 offset:45056
    v_mfma_f32_16x16x32_bf16 v[176:179], a[152:155], a[0:3], v[176:179]
    s_waitcnt lgkmcnt(4)
    v_mfma_f32_16x16x32_bf16 v[192:195], a[160:163], a[0:3], 0
    ds_read_b64_tr_b16 a[184:185], v27 offset:32776
    v_mfma_f32_16x16x32_bf16 v[192:195], a[164:167], a[16:19], v[192:195]
    v_mfma_f32_16x16x32_bf16 v[196:199], a[164:167], a[20:23], 0
    ds_read_b64_tr_b16 a[186:187], v27 offset:36872
    v_mfma_f32_16x16x32_bf16 v[196:199], a[160:163], a[4:7], v[196:199]
    v_mfma_f32_16x16x32_bf16 v[200:203], a[160:163], a[8:11], 0
    ds_read_b64_tr_b16 a[188:189], v27 offset:40968
    v_mfma_f32_16x16x32_bf16 v[200:203], a[164:167], a[24:27], v[200:203]
    v_mfma_f32_16x16x32_bf16 v[204:207], a[164:167], a[28:31], 0
    ds_read_b64_tr_b16 a[190:191], v27 offset:45064
    v_mfma_f32_16x16x32_bf16 v[204:207], a[160:163], a[12:15], v[204:207]
    v_mfma_f32_16x16x32_bf16 v[220:223], a[168:171], a[12:15], 0
    ds_read_b64_tr_b16 a[128:129], v24 offset:49152
    v_mfma_f32_16x16x32_bf16 v[220:223], a[172:175], a[28:31], v[220:223]
    buffer_load_dwordx4 a[96:99], v100, s[16:19], s29 offen offset:2048 sc1
    v_mfma_f32_16x16x32_bf16 v[216:219], a[172:175], a[24:27], 0
    ds_read_b64_tr_b16 a[130:131], v24 offset:53248
    v_mfma_f32_16x16x32_bf16 v[216:219], a[168:171], a[8:11], v[216:219]
    v_mfma_f32_16x16x32_bf16 v[212:215], a[168:171], a[4:7], 0
    ds_read_b64_tr_b16 a[132:133], v24 offset:57344
    v_mfma_f32_16x16x32_bf16 v[212:215], a[172:175], a[20:23], v[212:215]
    v_mfma_f32_16x16x32_bf16 v[208:211], a[172:175], a[16:19], 0
    buffer_load_dwordx4 a[100:103], v100, s[16:19], s31 offen offset:2048 sc1
    ds_read_b64_tr_b16 a[134:135], v24 offset:61440
    v_mfma_f32_16x16x32_bf16 v[208:211], a[168:171], a[0:3], v[208:211]
    s_waitcnt lgkmcnt(4)
    v_mfma_f32_16x16x32_bf16 v[224:227], a[176:179], a[0:3], 0
    ds_read_b64_tr_b16 a[136:137], v24 offset:49160
    v_mfma_f32_16x16x32_bf16 v[224:227], a[180:183], a[16:19], v[224:227]
    v_mfma_f32_16x16x32_bf16 v[228:231], a[180:183], a[20:23], 0
    ds_read_b64_tr_b16 a[138:139], v24 offset:53256
    v_mfma_f32_16x16x32_bf16 v[228:231], a[176:179], a[4:7], v[228:231]
    buffer_load_dwordx4 a[104:107], v102, s[16:19], s29 offen offset:2048 sc1
    v_mfma_f32_16x16x32_bf16 v[232:235], a[176:179], a[8:11], 0
    ds_read_b64_tr_b16 a[140:141], v24 offset:57352
    v_mfma_f32_16x16x32_bf16 v[232:235], a[180:183], a[24:27], v[232:235]
    v_mfma_f32_16x16x32_bf16 v[236:239], a[180:183], a[28:31], 0
    ds_read_b64_tr_b16 a[142:143], v24 offset:61448
    v_mfma_f32_16x16x32_bf16 v[236:239], a[176:179], a[12:15], v[236:239]
    v_mfma_f32_16x16x32_bf16 v[252:255], a[184:187], a[12:15], 0
    buffer_load_dwordx4 a[108:111], v102, s[16:19], s31 offen offset:2048 sc1
    ds_read_b64_tr_b16 a[144:145], v25 offset:49152
    v_mfma_f32_16x16x32_bf16 v[252:255], a[188:191], a[28:31], v[252:255]
    v_mfma_f32_16x16x32_bf16 v[248:251], a[188:191], a[24:27], 0
    ds_read_b64_tr_b16 a[146:147], v25 offset:53248
    v_mfma_f32_16x16x32_bf16 v[248:251], a[184:187], a[8:11], v[248:251]
    v_mfma_f32_16x16x32_bf16 v[244:247], a[184:187], a[4:7], 0
    ds_read_b64_tr_b16 a[148:149], v25 offset:57344
    v_mfma_f32_16x16x32_bf16 v[244:247], a[188:191], a[20:23], v[244:247]
    buffer_load_dwordx4 a[112:115], v100, s[16:19], s29 offen offset:3072 sc1
    v_mfma_f32_16x16x32_bf16 v[240:243], a[188:191], a[16:19], 0
    ds_read_b64_tr_b16 a[150:151], v25 offset:61440
    v_mfma_f32_16x16x32_bf16 v[240:243], a[184:187], a[0:3], v[240:243]
    s_waitcnt lgkmcnt(4)
    s_waitcnt vmcnt(20)
    v_mfma_f32_16x16x32_bf16 v[128:131], a[128:131], a[32:35], v[128:131]
    ds_read_b64_tr_b16 a[152:153], v25 offset:49160
    s_waitcnt vmcnt(16)
    v_mfma_f32_16x16x32_bf16 v[128:131], a[132:135], a[48:51], v[128:131]
    s_waitcnt vmcnt(15)
    v_mfma_f32_16x16x32_bf16 v[132:135], a[132:135], a[52:55], v[132:135]
    buffer_load_dwordx4 a[116:119], v100, s[16:19], s31 offen offset:3072 sc1
    ds_read_b64_tr_b16 a[154:155], v25 offset:53256
    v_mfma_f32_16x16x32_bf16 v[132:135], a[128:131], a[36:39], v[132:135]
    v_mfma_f32_16x16x32_bf16 v[136:139], a[128:131], a[40:43], v[136:139]
    ds_read_b64_tr_b16 a[156:157], v25 offset:57352
    s_waitcnt vmcnt(15)
    v_mfma_f32_16x16x32_bf16 v[136:139], a[132:135], a[56:59], v[136:139]
    s_waitcnt vmcnt(14)
    v_mfma_f32_16x16x32_bf16 v[140:143], a[132:135], a[60:63], v[140:143]
    ds_read_b64_tr_b16 a[158:159], v25 offset:61448
    v_mfma_f32_16x16x32_bf16 v[140:143], a[128:131], a[44:47], v[140:143]
    buffer_load_dwordx4 a[120:123], v102, s[16:19], s29 offen offset:3072 sc1
    v_mfma_f32_16x16x32_bf16 v[156:159], a[136:139], a[44:47], v[156:159]
    ds_read_b64_tr_b16 a[160:161], v26 offset:49152
    v_mfma_f32_16x16x32_bf16 v[156:159], a[140:143], a[60:63], v[156:159]
    v_mfma_f32_16x16x32_bf16 v[152:155], a[140:143], a[56:59], v[152:155]
    ds_read_b64_tr_b16 a[162:163], v26 offset:53248
    v_mfma_f32_16x16x32_bf16 v[152:155], a[136:139], a[40:43], v[152:155]
    v_mfma_f32_16x16x32_bf16 v[148:151], a[136:139], a[36:39], v[148:151]
    buffer_load_dwordx4 a[124:127], v102, s[16:19], s31 offen offset:3072 sc1
    ds_read_b64_tr_b16 a[164:165], v26 offset:57344
    s_add_u32 s29, s29, 4096
    s_add_u32 s31, s31, 4096
    v_mfma_f32_16x16x32_bf16 v[148:151], a[140:143], a[52:55], v[148:151]
    v_mfma_f32_16x16x32_bf16 v[144:147], a[140:143], a[48:51], v[144:147]
    ds_read_b64_tr_b16 a[166:167], v26 offset:61440
    v_mfma_f32_16x16x32_bf16 v[144:147], a[136:139], a[32:35], v[144:147]
    s_waitcnt lgkmcnt(4)
    v_mfma_f32_16x16x32_bf16 v[160:163], a[144:147], a[32:35], v[160:163]
    ds_read_b64_tr_b16 a[168:169], v26 offset:49160
    v_mfma_f32_16x16x32_bf16 v[160:163], a[148:151], a[48:51], v[160:163]
    s_add_u32 m0, s26, 0
    v_mfma_f32_16x16x32_bf16 v[164:167], a[148:151], a[52:55], v[164:167]
    buffer_load_dwordx4 v13, s[4:7], s24 offen offset:0 nt lds
    ds_read_b64_tr_b16 a[170:171], v26 offset:53256
    v_mfma_f32_16x16x32_bf16 v[164:167], a[144:147], a[36:39], v[164:167]
    v_mfma_f32_16x16x32_bf16 v[168:171], a[144:147], a[40:43], v[168:171]
    ds_read_b64_tr_b16 a[172:173], v26 offset:57352
    v_mfma_f32_16x16x32_bf16 v[168:171], a[148:151], a[56:59], v[168:171]
    v_mfma_f32_16x16x32_bf16 v[172:175], a[148:151], a[60:63], v[172:175]
    ds_read_b64_tr_b16 a[174:175], v26 offset:61448
    v_mfma_f32_16x16x32_bf16 v[172:175], a[144:147], a[44:47], v[172:175]
    buffer_load_dwordx4 v14, s[4:7], s24 offen offset:1024 nt lds
    v_mfma_f32_16x16x32_bf16 v[188:191], a[152:155], a[44:47], v[188:191]
    ds_read_b64_tr_b16 a[176:177], v27 offset:49152
    v_mfma_f32_16x16x32_bf16 v[188:191], a[156:159], a[60:63], v[188:191]
    v_mfma_f32_16x16x32_bf16 v[184:187], a[156:159], a[56:59], v[184:187]
    ds_read_b64_tr_b16 a[178:179], v27 offset:53248
    v_mfma_f32_16x16x32_bf16 v[184:187], a[152:155], a[40:43], v[184:187]
    v_mfma_f32_16x16x32_bf16 v[180:183], a[152:155], a[36:39], v[180:183]
    buffer_load_dwordx4 v15, s[4:7], s24 offen offset:2048 nt lds
    ds_read_b64_tr_b16 a[180:181], v27 offset:57344
    v_mfma_f32_16x16x32_bf16 v[180:183], a[156:159], a[52:55], v[180:183]
    v_mfma_f32_16x16x32_bf16 v[176:179], a[156:159], a[48:51], v[176:179]
    ds_read_b64_tr_b16 a[182:183], v27 offset:61440
    v_mfma_f32_16x16x32_bf16 v[176:179], a[152:155], a[32:35], v[176:179]
    s_waitcnt lgkmcnt(4)
    v_mfma_f32_16x16x32_bf16 v[192:195], a[160:163], a[32:35], v[192:195]
    ds_read_b64_tr_b16 a[184:185], v27 offset:49160
    v_mfma_f32_16x16x32_bf16 v[192:195], a[164:167], a[48:51], v[192:195]
    buffer_load_dwordx4 v16, s[4:7], s24 offen offset:3072 nt lds
    s_add_u32 s24, s24, 16384
    v_mfma_f32_16x16x32_bf16 v[196:199], a[164:167], a[52:55], v[196:199]
    ds_read_b64_tr_b16 a[186:187], v27 offset:53256
    v_mfma_f32_16x16x32_bf16 v[196:199], a[160:163], a[36:39], v[196:199]
    v_mfma_f32_16x16x32_bf16 v[200:203], a[160:163], a[40:43], v[200:203]
    ds_read_b64_tr_b16 a[188:189], v27 offset:57352
    v_mfma_f32_16x16x32_bf16 v[200:203], a[164:167], a[56:59], v[200:203]
    v_mfma_f32_16x16x32_bf16 v[204:207], a[164:167], a[60:63], v[204:207]
    ds_read_b64_tr_b16 a[190:191], v27 offset:61448
    v_mfma_f32_16x16x32_bf16 v[204:207], a[160:163], a[44:47], v[204:207]
    s_barrier
    v_mfma_f32_16x16x32_bf16 v[220:223], a[168:171], a[44:47], v[220:223]
    ds_read_b64_tr_b16 a[128:129], v104 offset:0
    v_mfma_f32_16x16x32_bf16 v[220:223], a[172:175], a[60:63], v[220:223]
    buffer_load_dwordx4 a[0:3], v100, s[16:19], s29 offen offset:0 sc1
    v_mfma_f32_16x16x32_bf16 v[216:219], a[172:175], a[56:59], v[216:219]
    ds_read_b64_tr_b16 a[130:131], v104 offset:4096
    v_mfma_f32_16x16x32_bf16 v[216:219], a[168:171], a[40:43], v[216:219]
    v_mfma_f32_16x16x32_bf16 v[212:215], a[168:171], a[36:39], v[212:215]
    ds_read_b64_tr_b16 a[132:133], v104 offset:8192
    v_mfma_f32_16x16x32_bf16 v[212:215], a[172:175], a[52:55], v[212:215]
    v_mfma_f32_16x16x32_bf16 v[208:211], a[172:175], a[48:51], v[208:211]
    buffer_load_dwordx4 a[4:7], v100, s[16:19], s31 offen offset:0 sc1
    ds_read_b64_tr_b16 a[134:135], v104 offset:12288
    v_mfma_f32_16x16x32_bf16 v[208:211], a[168:171], a[32:35], v[208:211]
    s_waitcnt lgkmcnt(4)
    v_mfma_f32_16x16x32_bf16 v[224:227], a[176:179], a[32:35], v[224:227]
    ds_read_b64_tr_b16 a[136:137], v104 offset:8
    v_mfma_f32_16x16x32_bf16 v[224:227], a[180:183], a[48:51], v[224:227]
    v_mfma_f32_16x16x32_bf16 v[228:231], a[180:183], a[52:55], v[228:231]
    ds_read_b64_tr_b16 a[138:139], v104 offset:4104
    v_mfma_f32_16x16x32_bf16 v[228:231], a[176:179], a[36:39], v[228:231]
    buffer_load_dwordx4 a[8:11], v102, s[16:19], s29 offen offset:0 sc1
    v_mfma_f32_16x16x32_bf16 v[232:235], a[176:179], a[40:43], v[232:235]
    ds_read_b64_tr_b16 a[140:141], v104 offset:8200
    v_mfma_f32_16x16x32_bf16 v[232:235], a[180:183], a[56:59], v[232:235]
    v_mfma_f32_16x16x32_bf16 v[236:239], a[180:183], a[60:63], v[236:239]
    ds_read_b64_tr_b16 a[142:143], v104 offset:12296
    v_mfma_f32_16x16x32_bf16 v[236:239], a[176:179], a[44:47], v[236:239]
    v_mfma_f32_16x16x32_bf16 v[252:255], a[184:187], a[44:47], v[252:255]
    buffer_load_dwordx4 a[12:15], v102, s[16:19], s31 offen offset:0 sc1
    ds_read_b64_tr_b16 a[144:145], v105 offset:0
    v_mfma_f32_16x16x32_bf16 v[252:255], a[188:191], a[60:63], v[252:255]
    v_mfma_f32_16x16x32_bf16 v[248:251], a[188:191], a[56:59], v[248:251]
    ds_read_b64_tr_b16 a[146:147], v105 offset:4096
    v_mfma_f32_16x16x32_bf16 v[248:251], a[184:187], a[40:43], v[248:251]
    v_mfma_f32_16x16x32_bf16 v[244:247], a[184:187], a[36:39], v[244:247]
    ds_read_b64_tr_b16 a[148:149], v105 offset:8192
    v_mfma_f32_16x16x32_bf16 v[244:247], a[188:191], a[52:55], v[244:247]
    buffer_load_dwordx4 a[16:19], v100, s[16:19], s29 offen offset:1024 sc1
    v_mfma_f32_16x16x32_bf16 v[240:243], a[188:191], a[48:51], v[240:243]
    ds_read_b64_tr_b16 a[150:151], v105 offset:12288
    v_mfma_f32_16x16x32_bf16 v[240:243], a[184:187], a[32:35], v[240:243]
    s_waitcnt lgkmcnt(4)
    s_waitcnt vmcnt(24)
    v_mfma_f32_16x16x32_bf16 v[128:131], a[128:131], a[64:67], v[128:131]
    ds_read_b64_tr_b16 a[152:153], v105 offset:8
    s_waitcnt vmcnt(20)
    v_mfma_f32_16x16x32_bf16 v[128:131], a[132:135], a[80:83], v[128:131]
    s_waitcnt vmcnt(19)
    v_mfma_f32_16x16x32_bf16 v[132:135], a[132:135], a[84:87], v[132:135]
    buffer_load_dwordx4 a[20:23], v100, s[16:19], s31 offen offset:1024 sc1
    ds_read_b64_tr_b16 a[154:155], v105 offset:4104
    v_mfma_f32_16x16x32_bf16 v[132:135], a[128:131], a[68:71], v[132:135]
    v_mfma_f32_16x16x32_bf16 v[136:139], a[128:131], a[72:75], v[136:139]
    ds_read_b64_tr_b16 a[156:157], v105 offset:8200
    s_waitcnt vmcnt(19)
    v_mfma_f32_16x16x32_bf16 v[136:139], a[132:135], a[88:91], v[136:139]
    s_waitcnt vmcnt(18)
    v_mfma_f32_16x16x32_bf16 v[140:143], a[132:135], a[92:95], v[140:143]
    ds_read_b64_tr_b16 a[158:159], v105 offset:12296
    v_mfma_f32_16x16x32_bf16 v[140:143], a[128:131], a[76:79], v[140:143]
    buffer_load_dwordx4 a[24:27], v102, s[16:19], s29 offen offset:1024 sc1
    v_mfma_f32_16x16x32_bf16 v[156:159], a[136:139], a[76:79], v[156:159]
    ds_read_b64_tr_b16 a[160:161], v106 offset:0
    v_mfma_f32_16x16x32_bf16 v[156:159], a[140:143], a[92:95], v[156:159]
    v_mfma_f32_16x16x32_bf16 v[152:155], a[140:143], a[88:91], v[152:155]
    ds_read_b64_tr_b16 a[162:163], v106 offset:4096
    v_mfma_f32_16x16x32_bf16 v[152:155], a[136:139], a[72:75], v[152:155]
    v_mfma_f32_16x16x32_bf16 v[148:151], a[136:139], a[68:71], v[148:151]
    buffer_load_dwordx4 a[28:31], v102, s[16:19], s31 offen offset:1024 sc1
    ds_read_b64_tr_b16 a[164:165], v106 offset:8192
    v_mfma_f32_16x16x32_bf16 v[148:151], a[140:143], a[84:87], v[148:151]
    v_mfma_f32_16x16x32_bf16 v[144:147], a[140:143], a[80:83], v[144:147]
    ds_read_b64_tr_b16 a[166:167], v106 offset:12288
    v_mfma_f32_16x16x32_bf16 v[144:147], a[136:139], a[64:67], v[144:147]
    s_waitcnt lgkmcnt(4)
    v_mfma_f32_16x16x32_bf16 v[160:163], a[144:147], a[64:67], v[160:163]
    ds_read_b64_tr_b16 a[168:169], v106 offset:8
    v_mfma_f32_16x16x32_bf16 v[160:163], a[148:151], a[80:83], v[160:163]
    s_add_u32 m0, s26, 16384
    v_mfma_f32_16x16x32_bf16 v[164:167], a[148:151], a[84:87], v[164:167]
    buffer_load_dwordx4 v13, s[4:7], s24 offen offset:0 nt lds
    ds_read_b64_tr_b16 a[170:171], v106 offset:4104
    v_mfma_f32_16x16x32_bf16 v[164:167], a[144:147], a[68:71], v[164:167]
    v_mfma_f32_16x16x32_bf16 v[168:171], a[144:147], a[72:75], v[168:171]
    ds_read_b64_tr_b16 a[172:173], v106 offset:8200
    v_mfma_f32_16x16x32_bf16 v[168:171], a[148:151], a[88:91], v[168:171]
    v_mfma_f32_16x16x32_bf16 v[172:175], a[148:151], a[92:95], v[172:175]
    ds_read_b64_tr_b16 a[174:175], v106 offset:12296
    v_mfma_f32_16x16x32_bf16 v[172:175], a[144:147], a[76:79], v[172:175]
    buffer_load_dwordx4 v14, s[4:7], s24 offen offset:1024 nt lds
    v_mfma_f32_16x16x32_bf16 v[188:191], a[152:155], a[76:79], v[188:191]
    ds_read_b64_tr_b16 a[176:177], v107 offset:0
    v_mfma_f32_16x16x32_bf16 v[188:191], a[156:159], a[92:95], v[188:191]
    v_mfma_f32_16x16x32_bf16 v[184:187], a[156:159], a[88:91], v[184:187]
    ds_read_b64_tr_b16 a[178:179], v107 offset:4096
    v_mfma_f32_16x16x32_bf16 v[184:187], a[152:155], a[72:75], v[184:187]
    v_mfma_f32_16x16x32_bf16 v[180:183], a[152:155], a[68:71], v[180:183]
    buffer_load_dwordx4 v15, s[4:7], s24 offen offset:2048 nt lds
    ds_read_b64_tr_b16 a[180:181], v107 offset:8192
    v_mfma_f32_16x16x32_bf16 v[180:183], a[156:159], a[84:87], v[180:183]
    v_mfma_f32_16x16x32_bf16 v[176:179], a[156:159], a[80:83], v[176:179]
    ds_read_b64_tr_b16 a[182:183], v107 offset:12288
    v_mfma_f32_16x16x32_bf16 v[176:179], a[152:155], a[64:67], v[176:179]
    s_waitcnt lgkmcnt(4)
    v_mfma_f32_16x16x32_bf16 v[192:195], a[160:163], a[64:67], v[192:195]
    ds_read_b64_tr_b16 a[184:185], v107 offset:8
    v_mfma_f32_16x16x32_bf16 v[192:195], a[164:167], a[80:83], v[192:195]
    buffer_load_dwordx4 v16, s[4:7], s24 offen offset:3072 nt lds
    s_add_u32 s24, s24, 16384
    v_mfma_f32_16x16x32_bf16 v[196:199], a[164:167], a[84:87], v[196:199]
    ds_read_b64_tr_b16 a[186:187], v107 offset:4104
    v_mfma_f32_16x16x32_bf16 v[196:199], a[160:163], a[68:71], v[196:199]
    v_mfma_f32_16x16x32_bf16 v[200:203], a[160:163], a[72:75], v[200:203]
    ds_read_b64_tr_b16 a[188:189], v107 offset:8200
    v_mfma_f32_16x16x32_bf16 v[200:203], a[164:167], a[88:91], v[200:203]
    v_mfma_f32_16x16x32_bf16 v[204:207], a[164:167], a[92:95], v[204:207]
    ds_read_b64_tr_b16 a[190:191], v107 offset:12296
    v_mfma_f32_16x16x32_bf16 v[204:207], a[160:163], a[76:79], v[204:207]
    v_mfma_f32_16x16x32_bf16 v[220:223], a[168:171], a[76:79], v[220:223]
    ds_read_b64_tr_b16 a[128:129], v104 offset:16384
    v_mfma_f32_16x16x32_bf16 v[220:223], a[172:175], a[92:95], v[220:223]
    buffer_load_dwordx4 a[32:35], v100, s[16:19], s29 offen offset:2048 sc1
    v_mfma_f32_16x16x32_bf16 v[216:219], a[172:175], a[88:91], v[216:219]
    ds_read_b64_tr_b16 a[130:131], v104 offset:20480
    v_mfma_f32_16x16x32_bf16 v[216:219], a[168:171], a[72:75], v[216:219]
    v_mfma_f32_16x16x32_bf16 v[212:215], a[168:171], a[68:71], v[212:215]
    ds_read_b64_tr_b16 a[132:133], v104 offset:24576
    v_mfma_f32_16x16x32_bf16 v[212:215], a[172:175], a[84:87], v[212:215]
    v_mfma_f32_16x16x32_bf16 v[208:211], a[172:175], a[80:83], v[208:211]
    buffer_load_dwordx4 a[36:39], v100, s[16:19], s31 offen offset:2048 sc1
    ds_read_b64_tr_b16 a[134:135], v104 offset:28672
    v_mfma_f32_16x16x32_bf16 v[208:211], a[168:171], a[64:67], v[208:211]
    s_waitcnt lgkmcnt(4)
    v_mfma_f32_16x16x32_bf16 v[224:227], a[176:179], a[64:67], v[224:227]
    ds_read_b64_tr_b16 a[136:137], v104 offset:16392
    v_mfma_f32_16x16x32_bf16 v[224:227], a[180:183], a[80:83], v[224:227]
    v_mfma_f32_16x16x32_bf16 v[228:231], a[180:183], a[84:87], v[228:231]
    ds_read_b64_tr_b16 a[138:139], v104 offset:20488
    v_mfma_f32_16x16x32_bf16 v[228:231], a[176:179], a[68:71], v[228:231]
    buffer_load_dwordx4 a[40:43], v102, s[16:19], s29 offen offset:2048 sc1
    v_mfma_f32_16x16x32_bf16 v[232:235], a[176:179], a[72:75], v[232:235]
    ds_read_b64_tr_b16 a[140:141], v104 offset:24584
    v_mfma_f32_16x16x32_bf16 v[232:235], a[180:183], a[88:91], v[232:235]
    v_mfma_f32_16x16x32_bf16 v[236:239], a[180:183], a[92:95], v[236:239]
    ds_read_b64_tr_b16 a[142:143], v104 offset:28680
    v_mfma_f32_16x16x32_bf16 v[236:239], a[176:179], a[76:79], v[236:239]
    v_mfma_f32_16x16x32_bf16 v[252:255], a[184:187], a[76:79], v[252:255]
    buffer_load_dwordx4 a[44:47], v102, s[16:19], s31 offen offset:2048 sc1
    ds_read_b64_tr_b16 a[144:145], v105 offset:16384
    v_mfma_f32_16x16x32_bf16 v[252:255], a[188:191], a[92:95], v[252:255]
    v_mfma_f32_16x16x32_bf16 v[248:251], a[188:191], a[88:91], v[248:251]
    ds_read_b64_tr_b16 a[146:147], v105 offset:20480
    v_mfma_f32_16x16x32_bf16 v[248:251], a[184:187], a[72:75], v[248:251]
    v_mfma_f32_16x16x32_bf16 v[244:247], a[184:187], a[68:71], v[244:247]
    ds_read_b64_tr_b16 a[148:149], v105 offset:24576
    v_mfma_f32_16x16x32_bf16 v[244:247], a[188:191], a[84:87], v[244:247]
    buffer_load_dwordx4 a[48:51], v100, s[16:19], s29 offen offset:3072 sc1
    v_mfma_f32_16x16x32_bf16 v[240:243], a[188:191], a[80:83], v[240:243]
    ds_read_b64_tr_b16 a[150:151], v105 offset:28672
    v_mfma_f32_16x16x32_bf16 v[240:243], a[184:187], a[64:67], v[240:243]
    s_waitcnt lgkmcnt(4)
    s_waitcnt vmcnt(28)
    v_mfma_f32_16x16x32_bf16 v[128:131], a[128:131], a[96:99], v[128:131]
    ds_read_b64_tr_b16 a[152:153], v105 offset:16392
    s_waitcnt vmcnt(24)
    v_mfma_f32_16x16x32_bf16 v[128:131], a[132:135], a[112:115], v[128:131]
    s_waitcnt vmcnt(23)
    v_mfma_f32_16x16x32_bf16 v[132:135], a[132:135], a[116:119], v[132:135]
    buffer_load_dwordx4 a[52:55], v100, s[16:19], s31 offen offset:3072 sc1
    ds_read_b64_tr_b16 a[154:155], v105 offset:20488
    v_mfma_f32_16x16x32_bf16 v[132:135], a[128:131], a[100:103], v[132:135]
    v_mfma_f32_16x16x32_bf16 v[136:139], a[128:131], a[104:107], v[136:139]
    ds_read_b64_tr_b16 a[156:157], v105 offset:24584
    s_waitcnt vmcnt(23)
    v_mfma_f32_16x16x32_bf16 v[136:139], a[132:135], a[120:123], v[136:139]
    s_waitcnt vmcnt(22)
    v_mfma_f32_16x16x32_bf16 v[140:143], a[132:135], a[124:127], v[140:143]
    ds_read_b64_tr_b16 a[158:159], v105 offset:28680
    v_mfma_f32_16x16x32_bf16 v[140:143], a[128:131], a[108:111], v[140:143]
    buffer_load_dwordx4 a[56:59], v102, s[16:19], s29 offen offset:3072 sc1
    v_mfma_f32_16x16x32_bf16 v[156:159], a[136:139], a[108:111], v[156:159]
    ds_read_b64_tr_b16 a[160:161], v106 offset:16384
    v_mfma_f32_16x16x32_bf16 v[156:159], a[140:143], a[124:127], v[156:159]
    v_mfma_f32_16x16x32_bf16 v[152:155], a[140:143], a[120:123], v[152:155]
    ds_read_b64_tr_b16 a[162:163], v106 offset:20480
    v_mfma_f32_16x16x32_bf16 v[152:155], a[136:139], a[104:107], v[152:155]
    v_mfma_f32_16x16x32_bf16 v[148:151], a[136:139], a[100:103], v[148:151]
    buffer_load_dwordx4 a[60:63], v102, s[16:19], s31 offen offset:3072 sc1
    ds_read_b64_tr_b16 a[164:165], v106 offset:24576
    s_add_u32 s29, s29, 4096
    s_add_u32 s31, s31, 4096
    v_mfma_f32_16x16x32_bf16 v[148:151], a[140:143], a[116:119], v[148:151]
    v_mfma_f32_16x16x32_bf16 v[144:147], a[140:143], a[112:115], v[144:147]
    ds_read_b64_tr_b16 a[166:167], v106 offset:28672
    v_mfma_f32_16x16x32_bf16 v[144:147], a[136:139], a[96:99], v[144:147]
    s_waitcnt lgkmcnt(4)
    v_mfma_f32_16x16x32_bf16 v[160:163], a[144:147], a[96:99], v[160:163]
    ds_read_b64_tr_b16 a[168:169], v106 offset:16392
    v_mfma_f32_16x16x32_bf16 v[160:163], a[148:151], a[112:115], v[160:163]
    s_add_u32 m0, s26, 32768
    v_mfma_f32_16x16x32_bf16 v[164:167], a[148:151], a[116:119], v[164:167]
    buffer_load_dwordx4 v13, s[4:7], s24 offen offset:0 nt lds
    ds_read_b64_tr_b16 a[170:171], v106 offset:20488
    v_mfma_f32_16x16x32_bf16 v[164:167], a[144:147], a[100:103], v[164:167]
    v_mfma_f32_16x16x32_bf16 v[168:171], a[144:147], a[104:107], v[168:171]
    ds_read_b64_tr_b16 a[172:173], v106 offset:24584
    v_mfma_f32_16x16x32_bf16 v[168:171], a[148:151], a[120:123], v[168:171]
    v_mfma_f32_16x16x32_bf16 v[172:175], a[148:151], a[124:127], v[172:175]
    ds_read_b64_tr_b16 a[174:175], v106 offset:28680
    v_mfma_f32_16x16x32_bf16 v[172:175], a[144:147], a[108:111], v[172:175]
    buffer_load_dwordx4 v14, s[4:7], s24 offen offset:1024 nt lds
    v_mfma_f32_16x16x32_bf16 v[188:191], a[152:155], a[108:111], v[188:191]
    ds_read_b64_tr_b16 a[176:177], v107 offset:16384
    v_mfma_f32_16x16x32_bf16 v[188:191], a[156:159], a[124:127], v[188:191]
    v_mfma_f32_16x16x32_bf16 v[184:187], a[156:159], a[120:123], v[184:187]
    ds_read_b64_tr_b16 a[178:179], v107 offset:20480
    v_mfma_f32_16x16x32_bf16 v[184:187], a[152:155], a[104:107], v[184:187]
    v_mfma_f32_16x16x32_bf16 v[180:183], a[152:155], a[100:103], v[180:183]
    buffer_load_dwordx4 v15, s[4:7], s24 offen offset:2048 nt lds
    ds_read_b64_tr_b16 a[180:181], v107 offset:24576
    v_mfma_f32_16x16x32_bf16 v[180:183], a[156:159], a[116:119], v[180:183]
    v_mfma_f32_16x16x32_bf16 v[176:179], a[156:159], a[112:115], v[176:179]
    ds_read_b64_tr_b16 a[182:183], v107 offset:28672
    v_mfma_f32_16x16x32_bf16 v[176:179], a[152:155], a[96:99], v[176:179]
    s_waitcnt lgkmcnt(4)
    v_mfma_f32_16x16x32_bf16 v[192:195], a[160:163], a[96:99], v[192:195]
    ds_read_b64_tr_b16 a[184:185], v107 offset:16392
    v_mfma_f32_16x16x32_bf16 v[192:195], a[164:167], a[112:115], v[192:195]
    buffer_load_dwordx4 v16, s[4:7], s24 offen offset:3072 nt lds
    s_add_u32 s24, s24, 16384
    v_mfma_f32_16x16x32_bf16 v[196:199], a[164:167], a[116:119], v[196:199]
    ds_read_b64_tr_b16 a[186:187], v107 offset:20488
    v_mfma_f32_16x16x32_bf16 v[196:199], a[160:163], a[100:103], v[196:199]
    v_mfma_f32_16x16x32_bf16 v[200:203], a[160:163], a[104:107], v[200:203]
    ds_read_b64_tr_b16 a[188:189], v107 offset:24584
    v_mfma_f32_16x16x32_bf16 v[200:203], a[164:167], a[120:123], v[200:203]
    v_mfma_f32_16x16x32_bf16 v[204:207], a[164:167], a[124:127], v[204:207]
    ds_read_b64_tr_b16 a[190:191], v107 offset:28680
    v_mfma_f32_16x16x32_bf16 v[204:207], a[160:163], a[108:111], v[204:207]
    s_barrier
    v_mfma_f32_16x16x32_bf16 v[220:223], a[168:171], a[108:111], v[220:223]
    ds_read_b64_tr_b16 a[128:129], v104 offset:32768
    v_mfma_f32_16x16x32_bf16 v[220:223], a[172:175], a[124:127], v[220:223]
    buffer_load_dwordx4 a[64:67], v100, s[16:19], s29 offen offset:0 sc1
    v_mfma_f32_16x16x32_bf16 v[216:219], a[172:175], a[120:123], v[216:219]
    ds_read_b64_tr_b16 a[130:131], v104 offset:36864
    v_mfma_f32_16x16x32_bf16 v[216:219], a[168:171], a[104:107], v[216:219]
    v_mfma_f32_16x16x32_bf16 v[212:215], a[168:171], a[100:103], v[212:215]
    ds_read_b64_tr_b16 a[132:133], v104 offset:40960
    v_mfma_f32_16x16x32_bf16 v[212:215], a[172:175], a[116:119], v[212:215]
    v_mfma_f32_16x16x32_bf16 v[208:211], a[172:175], a[112:115], v[208:211]
    buffer_load_dwordx4 a[68:71], v100, s[16:19], s31 offen offset:0 sc1
    ds_read_b64_tr_b16 a[134:135], v104 offset:45056
    v_mfma_f32_16x16x32_bf16 v[208:211], a[168:171], a[96:99], v[208:211]
    s_waitcnt lgkmcnt(4)
    v_mfma_f32_16x16x32_bf16 v[224:227], a[176:179], a[96:99], v[224:227]
    ds_read_b64_tr_b16 a[136:137], v104 offset:32776
    v_mfma_f32_16x16x32_bf16 v[224:227], a[180:183], a[112:115], v[224:227]
    v_mfma_f32_16x16x32_bf16 v[228:231], a[180:183], a[116:119], v[228:231]
    ds_read_b64_tr_b16 a[138:139], v104 offset:36872
    v_mfma_f32_16x16x32_bf16 v[228:231], a[176:179], a[100:103], v[228:231]
    buffer_load_dwordx4 a[72:75], v102, s[16:19], s29 offen offset:0 sc1
    v_mfma_f32_16x16x32_bf16 v[232:235], a[176:179], a[104:107], v[232:235]
    ds_read_b64_tr_b16 a[140:141], v104 offset:40968
    v_mfma_f32_16x16x32_bf16 v[232:235], a[180:183], a[120:123], v[232:235]
    v_mfma_f32_16x16x32_bf16 v[236:239], a[180:183], a[124:127], v[236:239]
    ds_read_b64_tr_b16 a[142:143], v104 offset:45064
    v_mfma_f32_16x16x32_bf16 v[236:239], a[176:179], a[108:111], v[236:239]
    v_mfma_f32_16x16x32_bf16 v[252:255], a[184:187], a[108:111], v[252:255]
    buffer_load_dwordx4 a[76:79], v102, s[16:19], s31 offen offset:0 sc1
    ds_read_b64_tr_b16 a[144:145], v105 offset:32768
    v_mfma_f32_16x16x32_bf16 v[252:255], a[188:191], a[124:127], v[252:255]
    v_mfma_f32_16x16x32_bf16 v[248:251], a[188:191], a[120:123], v[248:251]
    ds_read_b64_tr_b16 a[146:147], v105 offset:36864
    v_mfma_f32_16x16x32_bf16 v[248:251], a[184:187], a[104:107], v[248:251]
    v_mfma_f32_16x16x32_bf16 v[244:247], a[184:187], a[100:103], v[244:247]
    ds_read_b64_tr_b16 a[148:149], v105 offset:40960
    v_mfma_f32_16x16x32_bf16 v[244:247], a[188:191], a[116:119], v[244:247]
    buffer_load_dwordx4 a[80:83], v100, s[16:19], s29 offen offset:1024 sc1
    v_mfma_f32_16x16x32_bf16 v[240:243], a[188:191], a[112:115], v[240:243]
    ds_read_b64_tr_b16 a[150:151], v105 offset:45056
    v_mfma_f32_16x16x32_bf16 v[240:243], a[184:187], a[96:99], v[240:243]
    s_waitcnt lgkmcnt(4)
    s_waitcnt vmcnt(28)
    v_mfma_f32_16x16x32_bf16 v[128:131], a[128:131], a[0:3], v[128:131]
    ds_read_b64_tr_b16 a[152:153], v105 offset:32776
    s_waitcnt vmcnt(24)
    v_mfma_f32_16x16x32_bf16 v[128:131], a[132:135], a[16:19], v[128:131]
    s_waitcnt vmcnt(23)
    v_mfma_f32_16x16x32_bf16 v[132:135], a[132:135], a[20:23], v[132:135]
    buffer_load_dwordx4 a[84:87], v100, s[16:19], s31 offen offset:1024 sc1
    ds_read_b64_tr_b16 a[154:155], v105 offset:36872
    v_mfma_f32_16x16x32_bf16 v[132:135], a[128:131], a[4:7], v[132:135]
    v_mfma_f32_16x16x32_bf16 v[136:139], a[128:131], a[8:11], v[136:139]
    ds_read_b64_tr_b16 a[156:157], v105 offset:40968
    s_waitcnt vmcnt(23)
    v_mfma_f32_16x16x32_bf16 v[136:139], a[132:135], a[24:27], v[136:139]
    s_waitcnt vmcnt(22)
    v_mfma_f32_16x16x32_bf16 v[140:143], a[132:135], a[28:31], v[140:143]
    ds_read_b64_tr_b16 a[158:159], v105 offset:45064
    v_mfma_f32_16x16x32_bf16 v[140:143], a[128:131], a[12:15], v[140:143]
    buffer_load_dwordx4 a[88:91], v102, s[16:19], s29 offen offset:1024 sc1
    v_mfma_f32_16x16x32_bf16 v[156:159], a[136:139], a[12:15], v[156:159]
    ds_read_b64_tr_b16 a[160:161], v106 offset:32768
    v_mfma_f32_16x16x32_bf16 v[156:159], a[140:143], a[28:31], v[156:159]
    v_mfma_f32_16x16x32_bf16 v[152:155], a[140:143], a[24:27], v[152:155]
    ds_read_b64_tr_b16 a[162:163], v106 offset:36864
    v_mfma_f32_16x16x32_bf16 v[152:155], a[136:139], a[8:11], v[152:155]
    v_mfma_f32_16x16x32_bf16 v[148:151], a[136:139], a[4:7], v[148:151]
    buffer_load_dwordx4 a[92:95], v102, s[16:19], s31 offen offset:1024 sc1
    ds_read_b64_tr_b16 a[164:165], v106 offset:40960
    v_mfma_f32_16x16x32_bf16 v[148:151], a[140:143], a[20:23], v[148:151]
    v_mfma_f32_16x16x32_bf16 v[144:147], a[140:143], a[16:19], v[144:147]
    ds_read_b64_tr_b16 a[166:167], v106 offset:45056
    v_mfma_f32_16x16x32_bf16 v[144:147], a[136:139], a[0:3], v[144:147]
    s_waitcnt lgkmcnt(4)
    v_mfma_f32_16x16x32_bf16 v[160:163], a[144:147], a[0:3], v[160:163]
    ds_read_b64_tr_b16 a[168:169], v106 offset:32776
    v_mfma_f32_16x16x32_bf16 v[160:163], a[148:151], a[16:19], v[160:163]
    s_add_u32 m0, s26, 65536
    v_mfma_f32_16x16x32_bf16 v[164:167], a[148:151], a[20:23], v[164:167]
    buffer_load_dwordx4 v17, s[8:11], s25 offen offset:0 nt lds
    ds_read_b64_tr_b16 a[170:171], v106 offset:36872
    v_mfma_f32_16x16x32_bf16 v[164:167], a[144:147], a[4:7], v[164:167]
    v_mfma_f32_16x16x32_bf16 v[168:171], a[144:147], a[8:11], v[168:171]
    ds_read_b64_tr_b16 a[172:173], v106 offset:40968
    v_mfma_f32_16x16x32_bf16 v[168:171], a[148:151], a[24:27], v[168:171]
    v_mfma_f32_16x16x32_bf16 v[172:175], a[148:151], a[28:31], v[172:175]
    ds_read_b64_tr_b16 a[174:175], v106 offset:45064
    v_mfma_f32_16x16x32_bf16 v[172:175], a[144:147], a[12:15], v[172:175]
    buffer_load_dwordx4 v18, s[8:11], s25 offen offset:1024 nt lds
    v_mfma_f32_16x16x32_bf16 v[188:191], a[152:155], a[12:15], v[188:191]
    ds_read_b64_tr_b16 a[176:177], v107 offset:32768
    v_mfma_f32_16x16x32_bf16 v[188:191], a[156:159], a[28:31], v[188:191]
    v_mfma_f32_16x16x32_bf16 v[184:187], a[156:159], a[24:27], v[184:187]
    ds_read_b64_tr_b16 a[178:179], v107 offset:36864
    v_mfma_f32_16x16x32_bf16 v[184:187], a[152:155], a[8:11], v[184:187]
    v_mfma_f32_16x16x32_bf16 v[180:183], a[152:155], a[4:7], v[180:183]
    buffer_load_dwordx4 v17, s[8:11], s25 offen offset:2048 nt lds
    ds_read_b64_tr_b16 a[180:181], v107 offset:40960
    v_mfma_f32_16x16x32_bf16 v[180:183], a[156:159], a[20:23], v[180:183]
    v_mfma_f32_16x16x32_bf16 v[176:179], a[156:159], a[16:19], v[176:179]
    ds_read_b64_tr_b16 a[182:183], v107 offset:45056
    v_mfma_f32_16x16x32_bf16 v[176:179], a[152:155], a[0:3], v[176:179]
    s_waitcnt lgkmcnt(4)
    v_mfma_f32_16x16x32_bf16 v[192:195], a[160:163], a[0:3], v[192:195]
    ds_read_b64_tr_b16 a[184:185], v107 offset:32776
    v_mfma_f32_16x16x32_bf16 v[192:195], a[164:167], a[16:19], v[192:195]
    buffer_load_dwordx4 v18, s[8:11], s25 offen offset:3072 nt lds
    s_add_u32 s25, s25, 16384
    v_mfma_f32_16x16x32_bf16 v[196:199], a[164:167], a[20:23], v[196:199]
    ds_read_b64_tr_b16 a[186:187], v107 offset:36872
    v_mfma_f32_16x16x32_bf16 v[196:199], a[160:163], a[4:7], v[196:199]
    v_mfma_f32_16x16x32_bf16 v[200:203], a[160:163], a[8:11], v[200:203]
    ds_read_b64_tr_b16 a[188:189], v107 offset:40968
    v_mfma_f32_16x16x32_bf16 v[200:203], a[164:167], a[24:27], v[200:203]
    v_mfma_f32_16x16x32_bf16 v[204:207], a[164:167], a[28:31], v[204:207]
    ds_read_b64_tr_b16 a[190:191], v107 offset:45064
    v_mfma_f32_16x16x32_bf16 v[204:207], a[160:163], a[12:15], v[204:207]
    s_barrier
    v_mfma_f32_16x16x32_bf16 v[220:223], a[168:171], a[12:15], v[220:223]
    ds_read_b64_tr_b16 a[128:129], v104 offset:49152
    v_mfma_f32_16x16x32_bf16 v[220:223], a[172:175], a[28:31], v[220:223]
    buffer_load_dwordx4 a[96:99], v100, s[16:19], s29 offen offset:2048 sc1
    v_mfma_f32_16x16x32_bf16 v[216:219], a[172:175], a[24:27], v[216:219]
    ds_read_b64_tr_b16 a[130:131], v104 offset:53248
    v_mfma_f32_16x16x32_bf16 v[216:219], a[168:171], a[8:11], v[216:219]
    v_mfma_f32_16x16x32_bf16 v[212:215], a[168:171], a[4:7], v[212:215]
    ds_read_b64_tr_b16 a[132:133], v104 offset:57344
    v_mfma_f32_16x16x32_bf16 v[212:215], a[172:175], a[20:23], v[212:215]
    v_mfma_f32_16x16x32_bf16 v[208:211], a[172:175], a[16:19], v[208:211]
    buffer_load_dwordx4 a[100:103], v100, s[16:19], s31 offen offset:2048 sc1
    ds_read_b64_tr_b16 a[134:135], v104 offset:61440
    v_mfma_f32_16x16x32_bf16 v[208:211], a[168:171], a[0:3], v[208:211]
    s_waitcnt lgkmcnt(4)
    v_mfma_f32_16x16x32_bf16 v[224:227], a[176:179], a[0:3], v[224:227]
    ds_read_b64_tr_b16 a[136:137], v104 offset:49160
    v_mfma_f32_16x16x32_bf16 v[224:227], a[180:183], a[16:19], v[224:227]
    v_mfma_f32_16x16x32_bf16 v[228:231], a[180:183], a[20:23], v[228:231]
    ds_read_b64_tr_b16 a[138:139], v104 offset:53256
    v_mfma_f32_16x16x32_bf16 v[228:231], a[176:179], a[4:7], v[228:231]
    buffer_load_dwordx4 a[104:107], v102, s[16:19], s29 offen offset:2048 sc1
    v_mfma_f32_16x16x32_bf16 v[232:235], a[176:179], a[8:11], v[232:235]
    ds_read_b64_tr_b16 a[140:141], v104 offset:57352
    v_mfma_f32_16x16x32_bf16 v[232:235], a[180:183], a[24:27], v[232:235]
    v_mfma_f32_16x16x32_bf16 v[236:239], a[180:183], a[28:31], v[236:239]
    ds_read_b64_tr_b16 a[142:143], v104 offset:61448
    v_mfma_f32_16x16x32_bf16 v[236:239], a[176:179], a[12:15], v[236:239]
    v_mfma_f32_16x16x32_bf16 v[252:255], a[184:187], a[12:15], v[252:255]
    buffer_load_dwordx4 a[108:111], v102, s[16:19], s31 offen offset:2048 sc1
    ds_read_b64_tr_b16 a[144:145], v105 offset:49152
    v_mfma_f32_16x16x32_bf16 v[252:255], a[188:191], a[28:31], v[252:255]
    v_mfma_f32_16x16x32_bf16 v[248:251], a[188:191], a[24:27], v[248:251]
    ds_read_b64_tr_b16 a[146:147], v105 offset:53248
    v_mfma_f32_16x16x32_bf16 v[248:251], a[184:187], a[8:11], v[248:251]
    v_mfma_f32_16x16x32_bf16 v[244:247], a[184:187], a[4:7], v[244:247]
    ds_read_b64_tr_b16 a[148:149], v105 offset:57344
    v_mfma_f32_16x16x32_bf16 v[244:247], a[188:191], a[20:23], v[244:247]
    buffer_load_dwordx4 a[112:115], v100, s[16:19], s29 offen offset:3072 sc1
    v_mfma_f32_16x16x32_bf16 v[240:243], a[188:191], a[16:19], v[240:243]
    ds_read_b64_tr_b16 a[150:151], v105 offset:61440
    v_mfma_f32_16x16x32_bf16 v[240:243], a[184:187], a[0:3], v[240:243]
    s_waitcnt lgkmcnt(4)
    s_waitcnt vmcnt(28)
    v_mfma_f32_16x16x32_bf16 v[128:131], a[128:131], a[32:35], v[128:131]
    ds_read_b64_tr_b16 a[152:153], v105 offset:49160
    s_waitcnt vmcnt(24)
    v_mfma_f32_16x16x32_bf16 v[128:131], a[132:135], a[48:51], v[128:131]
    s_waitcnt vmcnt(23)
    v_mfma_f32_16x16x32_bf16 v[132:135], a[132:135], a[52:55], v[132:135]
    buffer_load_dwordx4 a[116:119], v100, s[16:19], s31 offen offset:3072 sc1
    ds_read_b64_tr_b16 a[154:155], v105 offset:53256
    v_mfma_f32_16x16x32_bf16 v[132:135], a[128:131], a[36:39], v[132:135]
    v_mfma_f32_16x16x32_bf16 v[136:139], a[128:131], a[40:43], v[136:139]
    ds_read_b64_tr_b16 a[156:157], v105 offset:57352
    s_waitcnt vmcnt(23)
    v_mfma_f32_16x16x32_bf16 v[136:139], a[132:135], a[56:59], v[136:139]
    s_waitcnt vmcnt(22)
    v_mfma_f32_16x16x32_bf16 v[140:143], a[132:135], a[60:63], v[140:143]
    ds_read_b64_tr_b16 a[158:159], v105 offset:61448
    v_mfma_f32_16x16x32_bf16 v[140:143], a[128:131], a[44:47], v[140:143]
    buffer_load_dwordx4 a[120:123], v102, s[16:19], s29 offen offset:3072 sc1
    v_mfma_f32_16x16x32_bf16 v[156:159], a[136:139], a[44:47], v[156:159]
    ds_read_b64_tr_b16 a[160:161], v106 offset:49152
    v_mfma_f32_16x16x32_bf16 v[156:159], a[140:143], a[60:63], v[156:159]
    v_mfma_f32_16x16x32_bf16 v[152:155], a[140:143], a[56:59], v[152:155]
    ds_read_b64_tr_b16 a[162:163], v106 offset:53248
    v_mfma_f32_16x16x32_bf16 v[152:155], a[136:139], a[40:43], v[152:155]
    v_mfma_f32_16x16x32_bf16 v[148:151], a[136:139], a[36:39], v[148:151]
    buffer_load_dwordx4 a[124:127], v102, s[16:19], s31 offen offset:3072 sc1
    ds_read_b64_tr_b16 a[164:165], v106 offset:57344
    s_add_u32 s29, s29, 4096
    s_add_u32 s31, s31, 4096
    v_mfma_f32_16x16x32_bf16 v[148:151], a[140:143], a[52:55], v[148:151]
    v_mfma_f32_16x16x32_bf16 v[144:147], a[140:143], a[48:51], v[144:147]
    ds_read_b64_tr_b16 a[166:167], v106 offset:61440
    v_mfma_f32_16x16x32_bf16 v[144:147], a[136:139], a[32:35], v[144:147]
    s_waitcnt lgkmcnt(4)
    v_mfma_f32_16x16x32_bf16 v[160:163], a[144:147], a[32:35], v[160:163]
    ds_read_b64_tr_b16 a[168:169], v106 offset:49160
    v_mfma_f32_16x16x32_bf16 v[160:163], a[148:151], a[48:51], v[160:163]
    s_add_u32 m0, s26, 81920
    v_mfma_f32_16x16x32_bf16 v[164:167], a[148:151], a[52:55], v[164:167]
    buffer_load_dwordx4 v17, s[8:11], s25 offen offset:0 nt lds
    ds_read_b64_tr_b16 a[170:171], v106 offset:53256
    v_mfma_f32_16x16x32_bf16 v[164:167], a[144:147], a[36:39], v[164:167]
    v_mfma_f32_16x16x32_bf16 v[168:171], a[144:147], a[40:43], v[168:171]
    ds_read_b64_tr_b16 a[172:173], v106 offset:57352
    v_mfma_f32_16x16x32_bf16 v[168:171], a[148:151], a[56:59], v[168:171]
    v_mfma_f32_16x16x32_bf16 v[172:175], a[148:151], a[60:63], v[172:175]
    ds_read_b64_tr_b16 a[174:175], v106 offset:61448
    v_mfma_f32_16x16x32_bf16 v[172:175], a[144:147], a[44:47], v[172:175]
    buffer_load_dwordx4 v18, s[8:11], s25 offen offset:1024 nt lds
    v_mfma_f32_16x16x32_bf16 v[188:191], a[152:155], a[44:47], v[188:191]
    ds_read_b64_tr_b16 a[176:177], v107 offset:49152
    v_mfma_f32_16x16x32_bf16 v[188:191], a[156:159], a[60:63], v[188:191]
    v_mfma_f32_16x16x32_bf16 v[184:187], a[156:159], a[56:59], v[184:187]
    ds_read_b64_tr_b16 a[178:179], v107 offset:53248
    v_mfma_f32_16x16x32_bf16 v[184:187], a[152:155], a[40:43], v[184:187]
    v_mfma_f32_16x16x32_bf16 v[180:183], a[152:155], a[36:39], v[180:183]
    buffer_load_dwordx4 v17, s[8:11], s25 offen offset:2048 nt lds
    ds_read_b64_tr_b16 a[180:181], v107 offset:57344
    v_mfma_f32_16x16x32_bf16 v[180:183], a[156:159], a[52:55], v[180:183]
    v_mfma_f32_16x16x32_bf16 v[176:179], a[156:159], a[48:51], v[176:179]
    ds_read_b64_tr_b16 a[182:183], v107 offset:61440
    v_mfma_f32_16x16x32_bf16 v[176:179], a[152:155], a[32:35], v[176:179]
    s_waitcnt lgkmcnt(4)
    v_mfma_f32_16x16x32_bf16 v[192:195], a[160:163], a[32:35], v[192:195]
    ds_read_b64_tr_b16 a[184:185], v107 offset:49160
    v_mfma_f32_16x16x32_bf16 v[192:195], a[164:167], a[48:51], v[192:195]
    buffer_load_dwordx4 v18, s[8:11], s25 offen offset:3072 nt lds
    s_add_u32 s25, s25, 16384
    v_mfma_f32_16x16x32_bf16 v[196:199], a[164:167], a[52:55], v[196:199]
    ds_read_b64_tr_b16 a[186:187], v107 offset:53256
    v_mfma_f32_16x16x32_bf16 v[196:199], a[160:163], a[36:39], v[196:199]
    v_mfma_f32_16x16x32_bf16 v[200:203], a[160:163], a[40:43], v[200:203]
    ds_read_b64_tr_b16 a[188:189], v107 offset:57352
    v_mfma_f32_16x16x32_bf16 v[200:203], a[164:167], a[56:59], v[200:203]
    v_mfma_f32_16x16x32_bf16 v[204:207], a[164:167], a[60:63], v[204:207]
    ds_read_b64_tr_b16 a[190:191], v107 offset:61448
    v_mfma_f32_16x16x32_bf16 v[204:207], a[160:163], a[44:47], v[204:207]
    v_mfma_f32_16x16x32_bf16 v[220:223], a[168:171], a[44:47], v[220:223]
    ds_read_b64_tr_b16 a[128:129], v19 offset:0
    s_add_u32 m0, s26, 49152
    v_mfma_f32_16x16x32_bf16 v[220:223], a[172:175], a[60:63], v[220:223]
    buffer_load_dwordx4 v13, s[4:7], s24 offen offset:0 nt lds
    v_mfma_f32_16x16x32_bf16 v[216:219], a[172:175], a[56:59], v[216:219]
    ds_read_b64_tr_b16 a[130:131], v19 offset:4096
    v_mfma_f32_16x16x32_bf16 v[216:219], a[168:171], a[40:43], v[216:219]
    v_mfma_f32_16x16x32_bf16 v[212:215], a[168:171], a[36:39], v[212:215]
    ds_read_b64_tr_b16 a[132:133], v19 offset:8192
    v_mfma_f32_16x16x32_bf16 v[212:215], a[172:175], a[52:55], v[212:215]
    v_mfma_f32_16x16x32_bf16 v[208:211], a[172:175], a[48:51], v[208:211]
    buffer_load_dwordx4 v14, s[4:7], s24 offen offset:1024 nt lds
    ds_read_b64_tr_b16 a[134:135], v19 offset:12288
    v_mfma_f32_16x16x32_bf16 v[208:211], a[168:171], a[32:35], v[208:211]
    s_waitcnt lgkmcnt(4)
    v_mfma_f32_16x16x32_bf16 v[224:227], a[176:179], a[32:35], v[224:227]
    ds_read_b64_tr_b16 a[136:137], v19 offset:8
    v_mfma_f32_16x16x32_bf16 v[224:227], a[180:183], a[48:51], v[224:227]
    v_mfma_f32_16x16x32_bf16 v[228:231], a[180:183], a[52:55], v[228:231]
    ds_read_b64_tr_b16 a[138:139], v19 offset:4104
    v_mfma_f32_16x16x32_bf16 v[228:231], a[176:179], a[36:39], v[228:231]
    buffer_load_dwordx4 v15, s[4:7], s24 offen offset:2048 nt lds
    v_mfma_f32_16x16x32_bf16 v[232:235], a[176:179], a[40:43], v[232:235]
    ds_read_b64_tr_b16 a[140:141], v19 offset:8200
    v_mfma_f32_16x16x32_bf16 v[232:235], a[180:183], a[56:59], v[232:235]
    v_mfma_f32_16x16x32_bf16 v[236:239], a[180:183], a[60:63], v[236:239]
    ds_read_b64_tr_b16 a[142:143], v19 offset:12296
    v_mfma_f32_16x16x32_bf16 v[236:239], a[176:179], a[44:47], v[236:239]
    v_mfma_f32_16x16x32_bf16 v[252:255], a[184:187], a[44:47], v[252:255]
    buffer_load_dwordx4 v16, s[4:7], s24 offen offset:3072 nt lds
    ds_read_b64_tr_b16 a[144:145], v20 offset:0
    s_add_u32 s24, s24, 16384
    v_mfma_f32_16x16x32_bf16 v[252:255], a[188:191], a[60:63], v[252:255]
    v_mfma_f32_16x16x32_bf16 v[248:251], a[188:191], a[56:59], v[248:251]
    ds_read_b64_tr_b16 a[146:147], v20 offset:4096
    v_mfma_f32_16x16x32_bf16 v[248:251], a[184:187], a[40:43], v[248:251]
    v_mfma_f32_16x16x32_bf16 v[244:247], a[184:187], a[36:39], v[244:247]
    ds_read_b64_tr_b16 a[148:149], v20 offset:8192
    v_mfma_f32_16x16x32_bf16 v[244:247], a[188:191], a[52:55], v[244:247]
    v_mfma_f32_16x16x32_bf16 v[240:243], a[188:191], a[48:51], v[240:243]
    ds_read_b64_tr_b16 a[150:151], v20 offset:12288
    v_mfma_f32_16x16x32_bf16 v[240:243], a[184:187], a[32:35], v[240:243]
    s_waitcnt lgkmcnt(4)
    s_waitcnt vmcnt(27)
    v_mfma_f32_16x16x32_bf16 v[128:131], a[128:131], a[64:67], v[128:131]
    ds_read_b64_tr_b16 a[152:153], v20 offset:8
    s_waitcnt vmcnt(23)
    v_mfma_f32_16x16x32_bf16 v[128:131], a[132:135], a[80:83], v[128:131]
    s_waitcnt vmcnt(22)
    v_mfma_f32_16x16x32_bf16 v[132:135], a[132:135], a[84:87], v[132:135]
    ds_read_b64_tr_b16 a[154:155], v20 offset:4104
    v_mfma_f32_16x16x32_bf16 v[132:135], a[128:131], a[68:71], v[132:135]
    v_mfma_f32_16x16x32_bf16 v[136:139], a[128:131], a[72:75], v[136:139]
    ds_read_b64_tr_b16 a[156:157], v20 offset:8200
    s_waitcnt vmcnt(21)
    v_mfma_f32_16x16x32_bf16 v[136:139], a[132:135], a[88:91], v[136:139]
    s_waitcnt vmcnt(20)
    v_mfma_f32_16x16x32_bf16 v[140:143], a[132:135], a[92:95], v[140:143]
    ds_read_b64_tr_b16 a[158:159], v20 offset:12296
    v_mfma_f32_16x16x32_bf16 v[140:143], a[128:131], a[76:79], v[140:143]
    v_mfma_f32_16x16x32_bf16 v[156:159], a[136:139], a[76:79], v[156:159]
    ds_read_b64_tr_b16 a[160:161], v21 offset:0
    v_mfma_f32_16x16x32_bf16 v[156:159], a[140:143], a[92:95], v[156:159]
    v_mfma_f32_16x16x32_bf16 v[152:155], a[140:143], a[88:91], v[152:155]
    ds_read_b64_tr_b16 a[162:163], v21 offset:4096
    v_mfma_f32_16x16x32_bf16 v[152:155], a[136:139], a[72:75], v[152:155]
    v_mfma_f32_16x16x32_bf16 v[148:151], a[136:139], a[68:71], v[148:151]
    ds_read_b64_tr_b16 a[164:165], v21 offset:8192
    v_mfma_f32_16x16x32_bf16 v[148:151], a[140:143], a[84:87], v[148:151]
    v_mfma_f32_16x16x32_bf16 v[144:147], a[140:143], a[80:83], v[144:147]
    ds_read_b64_tr_b16 a[166:167], v21 offset:12288
    v_mfma_f32_16x16x32_bf16 v[144:147], a[136:139], a[64:67], v[144:147]
    s_waitcnt lgkmcnt(4)
    v_mfma_f32_16x16x32_bf16 v[160:163], a[144:147], a[64:67], v[160:163]
    ds_read_b64_tr_b16 a[168:169], v21 offset:8
    v_mfma_f32_16x16x32_bf16 v[160:163], a[148:151], a[80:83], v[160:163]
    v_mfma_f32_16x16x32_bf16 v[164:167], a[148:151], a[84:87], v[164:167]
    ds_read_b64_tr_b16 a[170:171], v21 offset:4104
    v_mfma_f32_16x16x32_bf16 v[164:167], a[144:147], a[68:71], v[164:167]
    v_mfma_f32_16x16x32_bf16 v[168:171], a[144:147], a[72:75], v[168:171]
    ds_read_b64_tr_b16 a[172:173], v21 offset:8200
    v_mfma_f32_16x16x32_bf16 v[168:171], a[148:151], a[88:91], v[168:171]
    v_mfma_f32_16x16x32_bf16 v[172:175], a[148:151], a[92:95], v[172:175]
    ds_read_b64_tr_b16 a[174:175], v21 offset:12296
    v_mfma_f32_16x16x32_bf16 v[172:175], a[144:147], a[76:79], v[172:175]
    v_mfma_f32_16x16x32_bf16 v[188:191], a[152:155], a[76:79], v[188:191]
    ds_read_b64_tr_b16 a[176:177], v22 offset:0
    v_mfma_f32_16x16x32_bf16 v[188:191], a[156:159], a[92:95], v[188:191]
    v_mfma_f32_16x16x32_bf16 v[184:187], a[156:159], a[88:91], v[184:187]
    ds_read_b64_tr_b16 a[178:179], v22 offset:4096
    v_mfma_f32_16x16x32_bf16 v[184:187], a[152:155], a[72:75], v[184:187]
    v_mfma_f32_16x16x32_bf16 v[180:183], a[152:155], a[68:71], v[180:183]
    ds_read_b64_tr_b16 a[180:181], v22 offset:8192
    v_mfma_f32_16x16x32_bf16 v[180:183], a[156:159], a[84:87], v[180:183]
    v_mfma_f32_16x16x32_bf16 v[176:179], a[156:159], a[80:83], v[176:179]
    ds_read_b64_tr_b16 a[182:183], v22 offset:12288
    v_mfma_f32_16x16x32_bf16 v[176:179], a[152:155], a[64:67], v[176:179]
    s_waitcnt lgkmcnt(4)
    v_mfma_f32_16x16x32_bf16 v[192:195], a[160:163], a[64:67], v[192:195]
    ds_read_b64_tr_b16 a[184:185], v22 offset:8
    v_mfma_f32_16x16x32_bf16 v[192:195], a[164:167], a[80:83], v[192:195]
    v_mfma_f32_16x16x32_bf16 v[196:199], a[164:167], a[84:87], v[196:199]
    ds_read_b64_tr_b16 a[186:187], v22 offset:4104
    v_mfma_f32_16x16x32_bf16 v[196:199], a[160:163], a[68:71], v[196:199]
    v_mfma_f32_16x16x32_bf16 v[200:203], a[160:163], a[72:75], v[200:203]
    ds_read_b64_tr_b16 a[188:189], v22 offset:8200
    v_mfma_f32_16x16x32_bf16 v[200:203], a[164:167], a[88:91], v[200:203]
    v_mfma_f32_16x16x32_bf16 v[204:207], a[164:167], a[92:95], v[204:207]
    ds_read_b64_tr_b16 a[190:191], v22 offset:12296
    v_mfma_f32_16x16x32_bf16 v[204:207], a[160:163], a[76:79], v[204:207]
    v_mfma_f32_16x16x32_bf16 v[220:223], a[168:171], a[76:79], v[220:223]
    ds_read_b64_tr_b16 a[128:129], v19 offset:16384
    v_mfma_f32_16x16x32_bf16 v[220:223], a[172:175], a[92:95], v[220:223]
    v_mfma_f32_16x16x32_bf16 v[216:219], a[172:175], a[88:91], v[216:219]
    ds_read_b64_tr_b16 a[130:131], v19 offset:20480
    v_mfma_f32_16x16x32_bf16 v[216:219], a[168:171], a[72:75], v[216:219]
    v_mfma_f32_16x16x32_bf16 v[212:215], a[168:171], a[68:71], v[212:215]
    ds_read_b64_tr_b16 a[132:133], v19 offset:24576
    v_mfma_f32_16x16x32_bf16 v[212:215], a[172:175], a[84:87], v[212:215]
    v_mfma_f32_16x16x32_bf16 v[208:211], a[172:175], a[80:83], v[208:211]
    ds_read_b64_tr_b16 a[134:135], v19 offset:28672
    v_mfma_f32_16x16x32_bf16 v[208:211], a[168:171], a[64:67], v[208:211]
    s_waitcnt lgkmcnt(4)
    v_mfma_f32_16x16x32_bf16 v[224:227], a[176:179], a[64:67], v[224:227]
    ds_read_b64_tr_b16 a[136:137], v19 offset:16392
    v_mfma_f32_16x16x32_bf16 v[224:227], a[180:183], a[80:83], v[224:227]
    v_mfma_f32_16x16x32_bf16 v[228:231], a[180:183], a[84:87], v[228:231]
    ds_read_b64_tr_b16 a[138:139], v19 offset:20488
    v_mfma_f32_16x16x32_bf16 v[228:231], a[176:179], a[68:71], v[228:231]
    v_mfma_f32_16x16x32_bf16 v[232:235], a[176:179], a[72:75], v[232:235]
    ds_read_b64_tr_b16 a[140:141], v19 offset:24584
    v_mfma_f32_16x16x32_bf16 v[232:235], a[180:183], a[88:91], v[232:235]
    v_mfma_f32_16x16x32_bf16 v[236:239], a[180:183], a[92:95], v[236:239]
    ds_read_b64_tr_b16 a[142:143], v19 offset:28680
    v_mfma_f32_16x16x32_bf16 v[236:239], a[176:179], a[76:79], v[236:239]
    v_mfma_f32_16x16x32_bf16 v[252:255], a[184:187], a[76:79], v[252:255]
    ds_read_b64_tr_b16 a[144:145], v20 offset:16384
    v_mfma_f32_16x16x32_bf16 v[252:255], a[188:191], a[92:95], v[252:255]
    v_mfma_f32_16x16x32_bf16 v[248:251], a[188:191], a[88:91], v[248:251]
    ds_read_b64_tr_b16 a[146:147], v20 offset:20480
    v_mfma_f32_16x16x32_bf16 v[248:251], a[184:187], a[72:75], v[248:251]
    v_mfma_f32_16x16x32_bf16 v[244:247], a[184:187], a[68:71], v[244:247]
    ds_read_b64_tr_b16 a[148:149], v20 offset:24576
    v_mfma_f32_16x16x32_bf16 v[244:247], a[188:191], a[84:87], v[244:247]
    v_mfma_f32_16x16x32_bf16 v[240:243], a[188:191], a[80:83], v[240:243]
    ds_read_b64_tr_b16 a[150:151], v20 offset:28672
    v_mfma_f32_16x16x32_bf16 v[240:243], a[184:187], a[64:67], v[240:243]
    s_waitcnt lgkmcnt(4)
    s_waitcnt vmcnt(15)
    v_mfma_f32_16x16x32_bf16 v[128:131], a[128:131], a[96:99], v[128:131]
    ds_read_b64_tr_b16 a[152:153], v20 offset:16392
    s_waitcnt vmcnt(11)
    v_mfma_f32_16x16x32_bf16 v[128:131], a[132:135], a[112:115], v[128:131]
    s_waitcnt vmcnt(10)
    v_mfma_f32_16x16x32_bf16 v[132:135], a[132:135], a[116:119], v[132:135]
    ds_read_b64_tr_b16 a[154:155], v20 offset:20488
    v_mfma_f32_16x16x32_bf16 v[132:135], a[128:131], a[100:103], v[132:135]
    v_mfma_f32_16x16x32_bf16 v[136:139], a[128:131], a[104:107], v[136:139]
    global_load_dwordx4 a[192:195], v28, s[96:97]
    ds_read_b64_tr_b16 a[156:157], v20 offset:24584
    s_waitcnt vmcnt(10)
    v_mfma_f32_16x16x32_bf16 v[136:139], a[132:135], a[120:123], v[136:139]
    s_waitcnt vmcnt(9)
    v_mfma_f32_16x16x32_bf16 v[140:143], a[132:135], a[124:127], v[140:143]
    ds_read_b64_tr_b16 a[158:159], v20 offset:28680
    v_mfma_f32_16x16x32_bf16 v[140:143], a[128:131], a[108:111], v[140:143]
    v_mfma_f32_16x16x32_bf16 v[156:159], a[136:139], a[108:111], v[156:159]
    ds_read_b64_tr_b16 a[160:161], v21 offset:16384
    v_mfma_f32_16x16x32_bf16 v[156:159], a[140:143], a[124:127], v[156:159]
    v_mfma_f32_16x16x32_bf16 v[152:155], a[140:143], a[120:123], v[152:155]
    global_load_dwordx4 a[196:199], v29, s[96:97]
    ds_read_b64_tr_b16 a[162:163], v21 offset:20480
    v_mfma_f32_16x16x32_bf16 v[152:155], a[136:139], a[104:107], v[152:155]
    v_mfma_f32_16x16x32_bf16 v[148:151], a[136:139], a[100:103], v[148:151]
    ds_read_b64_tr_b16 a[164:165], v21 offset:24576
    v_mfma_f32_16x16x32_bf16 v[148:151], a[140:143], a[116:119], v[148:151]
    v_mfma_f32_16x16x32_bf16 v[144:147], a[140:143], a[112:115], v[144:147]
    ds_read_b64_tr_b16 a[166:167], v21 offset:28672
    v_mfma_f32_16x16x32_bf16 v[144:147], a[136:139], a[96:99], v[144:147]
    s_waitcnt lgkmcnt(4)
    v_mfma_f32_16x16x32_bf16 v[160:163], a[144:147], a[96:99], v[160:163]
    global_load_dwordx4 a[200:203], v30, s[96:97]
    ds_read_b64_tr_b16 a[168:169], v21 offset:16392
    v_mfma_f32_16x16x32_bf16 v[160:163], a[148:151], a[112:115], v[160:163]
    v_mfma_f32_16x16x32_bf16 v[164:167], a[148:151], a[116:119], v[164:167]
    ds_read_b64_tr_b16 a[170:171], v21 offset:20488
    v_mfma_f32_16x16x32_bf16 v[164:167], a[144:147], a[100:103], v[164:167]
    v_mfma_f32_16x16x32_bf16 v[168:171], a[144:147], a[104:107], v[168:171]
    ds_read_b64_tr_b16 a[172:173], v21 offset:24584
    v_cvt_pk_bf16_f32 v32, v128, v129
    v_mfma_f32_16x16x32_bf16 v[168:171], a[148:151], a[120:123], v[168:171]
    v_cvt_pk_bf16_f32 v33, v130, v131
    v_mfma_f32_16x16x32_bf16 v[172:175], a[148:151], a[124:127], v[172:175]
    global_load_dwordx4 a[204:207], v31, s[96:97]
    ds_read_b64_tr_b16 a[174:175], v21 offset:28680
    v_cvt_pk_bf16_f32 v34, v144, v145
    v_mfma_f32_16x16x32_bf16 v[172:175], a[144:147], a[108:111], v[172:175]
    v_cvt_pk_bf16_f32 v35, v146, v147
    v_mfma_f32_16x16x32_bf16 v[188:191], a[152:155], a[108:111], v[188:191]
    ds_read_b64_tr_b16 a[176:177], v22 offset:16384
    v_cvt_pk_bf16_f32 v48, v132, v133
    v_mfma_f32_16x16x32_bf16 v[188:191], a[156:159], a[124:127], v[188:191]
    v_cvt_pk_bf16_f32 v49, v134, v135
    v_mfma_f32_16x16x32_bf16 v[184:187], a[156:159], a[120:123], v[184:187]
    ds_read_b64_tr_b16 a[178:179], v22 offset:20480
    v_cvt_pk_bf16_f32 v50, v148, v149
    v_mfma_f32_16x16x32_bf16 v[184:187], a[152:155], a[104:107], v[184:187]
    v_cvt_pk_bf16_f32 v51, v150, v151
    v_mfma_f32_16x16x32_bf16 v[180:183], a[152:155], a[100:103], v[180:183]
    ds_read_b64_tr_b16 a[180:181], v22 offset:24576
    v_cvt_pk_bf16_f32 v64, v136, v137
    v_mfma_f32_16x16x32_bf16 v[180:183], a[156:159], a[116:119], v[180:183]
    v_cvt_pk_bf16_f32 v65, v138, v139
    v_mfma_f32_16x16x32_bf16 v[176:179], a[156:159], a[112:115], v[176:179]
    ds_read_b64_tr_b16 a[182:183], v22 offset:28672
    v_cvt_pk_bf16_f32 v66, v152, v153
    v_mfma_f32_16x16x32_bf16 v[176:179], a[152:155], a[96:99], v[176:179]
    v_cvt_pk_bf16_f32 v67, v154, v155
    s_waitcnt lgkmcnt(4)
    v_mfma_f32_16x16x32_bf16 v[192:195], a[160:163], a[96:99], v[192:195]
    ds_read_b64_tr_b16 a[184:185], v22 offset:16392
    v_cvt_pk_bf16_f32 v80, v140, v141
    v_mfma_f32_16x16x32_bf16 v[192:195], a[164:167], a[112:115], v[192:195]
    v_cvt_pk_bf16_f32 v81, v142, v143
    v_mfma_f32_16x16x32_bf16 v[196:199], a[164:167], a[116:119], v[196:199]
    ds_read_b64_tr_b16 a[186:187], v22 offset:20488
    v_cvt_pk_bf16_f32 v82, v156, v157
    s_barrier
    v_mfma_f32_16x16x32_bf16 v[196:199], a[160:163], a[100:103], v[196:199]
    ds_read_b128 a[128:131], v1 offset:0
    v_cvt_pk_bf16_f32 v83, v158, v159
    v_mfma_f32_16x16x32_bf16 v[200:203], a[160:163], a[104:107], v[200:203]
    ds_read_b64_tr_b16 a[188:189], v22 offset:24584
    v_cvt_pk_bf16_f32 v36, v160, v161
    v_mfma_f32_16x16x32_bf16 v[200:203], a[164:167], a[120:123], v[200:203]
    ds_read_b128 a[132:135], v2 offset:0
    v_cvt_pk_bf16_f32 v37, v162, v163
    v_mfma_f32_16x16x32_bf16 v[204:207], a[164:167], a[124:127], v[204:207]
    ds_read_b64_tr_b16 a[190:191], v22 offset:28680
    v_cvt_pk_bf16_f32 v38, v176, v177
    v_mfma_f32_16x16x32_bf16 v[204:207], a[160:163], a[108:111], v[204:207]
    ds_read_b128 a[136:139], v3 offset:0
    v_cvt_pk_bf16_f32 v39, v178, v179
    v_mfma_f32_16x16x32_bf16 v[220:223], a[168:171], a[108:111], v[220:223]
    v_cvt_pk_bf16_f32 v52, v164, v165
    v_mfma_f32_16x16x32_bf16 v[220:223], a[172:175], a[124:127], v[220:223]
    ds_read_b128 a[140:143], v4 offset:0
    v_cvt_pk_bf16_f32 v53, v166, v167
    v_mfma_f32_16x16x32_bf16 v[216:219], a[172:175], a[120:123], v[216:219]
    v_cvt_pk_bf16_f32 v54, v180, v181
    v_mfma_f32_16x16x32_bf16 v[216:219], a[168:171], a[104:107], v[216:219]
    ds_read_b128 a[144:147], v1 offset:4096
    v_cvt_pk_bf16_f32 v55, v182, v183
    v_mfma_f32_16x16x32_bf16 v[212:215], a[168:171], a[100:103], v[212:215]
    v_cvt_pk_bf16_f32 v68, v168, v169
    v_mfma_f32_16x16x32_bf16 v[212:215], a[172:175], a[116:119], v[212:215]
    ds_read_b128 a[148:151], v2 offset:4096
    v_cvt_pk_bf16_f32 v69, v170, v171
    v_mfma_f32_16x16x32_bf16 v[208:211], a[172:175], a[112:115], v[208:211]
    v_cvt_pk_bf16_f32 v70, v184, v185
    v_mfma_f32_16x16x32_bf16 v[208:211], a[168:171], a[96:99], v[208:211]
    ds_read_b128 a[152:155], v3 offset:4096
    v_cvt_pk_bf16_f32 v71, v186, v187
    s_waitcnt lgkmcnt(5)
    v_mfma_f32_16x16x32_bf16 v[224:227], a[176:179], a[96:99], v[224:227]
    v_cvt_pk_bf16_f32 v84, v172, v173
    v_mfma_f32_16x16x32_bf16 v[224:227], a[180:183], a[112:115], v[224:227]
    ds_read_b128 a[156:159], v4 offset:4096
    v_cvt_pk_bf16_f32 v85, v174, v175
    v_mfma_f32_16x16x32_bf16 v[228:231], a[180:183], a[116:119], v[228:231]
    v_cvt_pk_bf16_f32 v86, v188, v189
    v_mfma_f32_16x16x32_bf16 v[228:231], a[176:179], a[100:103], v[228:231]
    v_cvt_pk_bf16_f32 v87, v190, v191
    v_mfma_f32_16x16x32_bf16 v[232:235], a[176:179], a[104:107], v[232:235]
    v_cvt_pk_bf16_f32 v40, v192, v193
    v_mfma_f32_16x16x32_bf16 v[232:235], a[180:183], a[120:123], v[232:235]
    v_cvt_pk_bf16_f32 v41, v194, v195
    v_mfma_f32_16x16x32_bf16 v[236:239], a[180:183], a[124:127], v[236:239]
    v_cvt_pk_bf16_f32 v42, v208, v209
    v_mfma_f32_16x16x32_bf16 v[236:239], a[176:179], a[108:111], v[236:239]
    v_cvt_pk_bf16_f32 v43, v210, v211
    v_mfma_f32_16x16x32_bf16 v[252:255], a[184:187], a[108:111], v[252:255]
    v_cvt_pk_bf16_f32 v56, v196, v197
    v_mfma_f32_16x16x32_bf16 v[252:255], a[188:191], a[124:127], v[252:255]
    v_cvt_pk_bf16_f32 v57, v198, v199
    v_mfma_f32_16x16x32_bf16 v[248:251], a[188:191], a[120:123], v[248:251]
    v_cvt_pk_bf16_f32 v58, v212, v213
    v_mfma_f32_16x16x32_bf16 v[248:251], a[184:187], a[104:107], v[248:251]
    v_cvt_pk_bf16_f32 v59, v214, v215
    v_mfma_f32_16x16x32_bf16 v[244:247], a[184:187], a[100:103], v[244:247]
    v_cvt_pk_bf16_f32 v72, v200, v201
    v_mfma_f32_16x16x32_bf16 v[244:247], a[188:191], a[116:119], v[244:247]
    v_cvt_pk_bf16_f32 v73, v202, v203
    v_mfma_f32_16x16x32_bf16 v[240:243], a[188:191], a[112:115], v[240:243]
    v_cvt_pk_bf16_f32 v74, v216, v217
    v_mfma_f32_16x16x32_bf16 v[240:243], a[184:187], a[96:99], v[240:243]
    v_cvt_pk_bf16_f32 v75, v218, v219
    v_cvt_pk_bf16_f32 v88, v204, v205
    v_cvt_pk_bf16_f32 v89, v206, v207
    v_cvt_pk_bf16_f32 v90, v220, v221
    v_cvt_pk_bf16_f32 v91, v222, v223
    s_nop 3
    v_cvt_pk_bf16_f32 v44, v224, v225
    v_cvt_pk_bf16_f32 v45, v226, v227
    v_cvt_pk_bf16_f32 v46, v240, v241
    v_cvt_pk_bf16_f32 v47, v242, v243
    v_cvt_pk_bf16_f32 v60, v228, v229
    v_cvt_pk_bf16_f32 v61, v230, v231
    v_cvt_pk_bf16_f32 v62, v244, v245
    v_cvt_pk_bf16_f32 v63, v246, v247
    v_cvt_pk_bf16_f32 v76, v232, v233
    v_cvt_pk_bf16_f32 v77, v234, v235
    v_cvt_pk_bf16_f32 v78, v248, v249
    v_cvt_pk_bf16_f32 v79, v250, v251
    v_cvt_pk_bf16_f32 v92, v236, v237
    v_cvt_pk_bf16_f32 v93, v238, v239
    v_cvt_pk_bf16_f32 v94, v252, v253
    v_cvt_pk_bf16_f32 v95, v254, v255
    s_nop 1
L_attn_first:
    v_mfma_f32_16x16x32_bf16 v[128:131], a[128:131], v[32:35], 0
    v_mfma_f32_16x16x32_bf16 v[132:135], a[128:131], v[48:51], 0
    v_mfma_f32_16x16x32_bf16 v[136:139], a[128:131], v[64:67], 0
    v_add_u32 v19, 262144, v101
    v_mfma_f32_16x16x32_bf16 v[140:143], a[128:131], v[80:83], 0
    ds_read_b128 a[128:131], v1 offset:8192
    v_mfma_f32_16x16x32_bf16 v[128:131], a[132:135], v[36:39], v[128:131]
    v_accvgpr_read_b32 v116, a250
    v_mfma_f32_16x16x32_bf16 v[132:135], a[132:135], v[52:55], v[132:135]
    v_accvgpr_read_b32 v117, a251
    v_mfma_f32_16x16x32_bf16 v[136:139], a[132:135], v[68:71], v[136:139]
    v_accvgpr_read_b32 v118, a252
    v_mfma_f32_16x16x32_bf16 v[140:143], a[132:135], v[84:87], v[140:143]
    ds_read_b128 a[132:135], v2 offset:8192
    v_accvgpr_read_b32 v119, a253
    s_waitcnt lgkmcnt(7)
    v_mfma_f32_16x16x32_bf16 v[128:131], a[136:139], v[40:43], v[128:131]
    v_mfma_f32_16x16x32_bf16 v[132:135], a[136:139], v[56:59], v[132:135]
    v_mfma_f32_16x16x32_bf16 v[136:139], a[136:139], v[72:75], v[136:139]
    v_mfma_f32_16x16x32_bf16 v[140:143], a[136:139], v[88:91], v[140:143]
    ds_read_b128 a[136:139], v3 offset:8192
    s_waitcnt lgkmcnt(7)
    v_mfma_f32_16x16x32_bf16 v[128:131], a[140:143], v[44:47], v[128:131]
    v_mfma_f32_16x16x32_bf16 v[132:135], a[140:143], v[60:63], v[132:135]
    v_mfma_f32_16x16x32_bf16 v[136:139], a[140:143], v[76:79], v[136:139]
    v_mfma_f32_16x16x32_bf16 v[140:143], a[140:143], v[92:95], v[140:143]
    ds_read_b128 a[140:143], v4 offset:8192
    s_waitcnt lgkmcnt(7)
    v_mfma_f32_16x16x32_bf16 v[144:147], a[144:147], v[32:35], 0
    v_mfma_f32_16x16x32_bf16 v[148:151], a[144:147], v[48:51], 0
    v_mfma_f32_16x16x32_bf16 v[152:155], a[144:147], v[64:67], 0
    v_mfma_f32_16x16x32_bf16 v[156:159], a[144:147], v[80:83], 0
    ds_read_b128 a[144:147], v1 offset:12288
    s_waitcnt lgkmcnt(7)
    v_mfma_f32_16x16x32_bf16 v[144:147], a[148:151], v[36:39], v[144:147]
    v_mfma_f32_16x16x32_bf16 v[148:151], a[148:151], v[52:55], v[148:151]
    v_mfma_f32_16x16x32_bf16 v[152:155], a[148:151], v[68:71], v[152:155]
    v_mfma_f32_16x16x32_bf16 v[156:159], a[148:151], v[84:87], v[156:159]
    ds_read_b128 a[148:151], v2 offset:12288
    s_waitcnt lgkmcnt(7)
    v_mfma_f32_16x16x32_bf16 v[144:147], a[152:155], v[40:43], v[144:147]
    v_mfma_f32_16x16x32_bf16 v[148:151], a[152:155], v[56:59], v[148:151]
    v_mfma_f32_16x16x32_bf16 v[152:155], a[152:155], v[72:75], v[152:155]
    v_mfma_f32_16x16x32_bf16 v[156:159], a[152:155], v[88:91], v[156:159]
    ds_read_b128 a[152:155], v3 offset:12288
    s_waitcnt lgkmcnt(7)
    v_mfma_f32_16x16x32_bf16 v[144:147], a[156:159], v[44:47], v[144:147]
    v_mfma_f32_16x16x32_bf16 v[148:151], a[156:159], v[60:63], v[148:151]
    v_mfma_f32_16x16x32_bf16 v[152:155], a[156:159], v[76:79], v[152:155]
    v_mfma_f32_16x16x32_bf16 v[156:159], a[156:159], v[92:95], v[156:159]
    ds_read_b128 a[156:159], v4 offset:12288
    s_waitcnt lgkmcnt(7)
    v_mfma_f32_16x16x32_bf16 v[160:163], a[128:131], v[32:35], 0
    v_mfma_f32_16x16x32_bf16 v[164:167], a[128:131], v[48:51], 0
    v_mfma_f32_16x16x32_bf16 v[168:171], a[128:131], v[64:67], 0
    v_mfma_f32_16x16x32_bf16 v[172:175], a[128:131], v[80:83], 0
    ds_read_b128 a[128:131], v1 offset:16384
    s_waitcnt lgkmcnt(7)
    v_mfma_f32_16x16x32_bf16 v[160:163], a[132:135], v[36:39], v[160:163]
    v_mfma_f32_16x16x32_bf16 v[164:167], a[132:135], v[52:55], v[164:167]
    v_mfma_f32_16x16x32_bf16 v[168:171], a[132:135], v[68:71], v[168:171]
    v_max3_f32 v240, v128, v129, v130
    v_mfma_f32_16x16x32_bf16 v[172:175], a[132:135], v[84:87], v[172:175]
    ds_read_b128 a[132:135], v2 offset:16384
    v_max3_f32 v241, v132, v133, v134
    s_waitcnt lgkmcnt(7)
    v_mfma_f32_16x16x32_bf16 v[160:163], a[136:139], v[40:43], v[160:163]
    v_max3_f32 v242, v136, v137, v138
    v_mfma_f32_16x16x32_bf16 v[164:167], a[136:139], v[56:59], v[164:167]
    v_max3_f32 v243, v140, v141, v142
    v_mfma_f32_16x16x32_bf16 v[168:171], a[136:139], v[72:75], v[168:171]
    v_max_f32 v240, v240, v131
    v_mfma_f32_16x16x32_bf16 v[172:175], a[136:139], v[88:91], v[172:175]
    ds_read_b128 a[136:139], v3 offset:16384
    v_max_f32 v241, v241, v135
    s_waitcnt lgkmcnt(7)
    v_mfma_f32_16x16x32_bf16 v[160:163], a[140:143], v[44:47], v[160:163]
    v_max_f32 v242, v242, v139
    v_mfma_f32_16x16x32_bf16 v[164:167], a[140:143], v[60:63], v[164:167]
    v_max_f32 v243, v243, v143
    v_mfma_f32_16x16x32_bf16 v[168:171], a[140:143], v[76:79], v[168:171]
    v_max3_f32 v240, v240, v144, v145
    v_mfma_f32_16x16x32_bf16 v[172:175], a[140:143], v[92:95], v[172:175]
    ds_read_b128 a[140:143], v4 offset:16384
    v_max3_f32 v241, v241, v148, v149
    s_waitcnt lgkmcnt(7)
    v_mfma_f32_16x16x32_bf16 v[176:179], a[144:147], v[32:35], 0
    v_max3_f32 v242, v242, v152, v153
    v_mfma_f32_16x16x32_bf16 v[180:183], a[144:147], v[48:51], 0
    v_max3_f32 v243, v243, v156, v157
    v_mfma_f32_16x16x32_bf16 v[184:187], a[144:147], v[64:67], 0
    v_max3_f32 v240, v240, v146, v147
    v_mfma_f32_16x16x32_bf16 v[188:191], a[144:147], v[80:83], 0
    ds_read_b128 a[144:147], v1 offset:20480
    v_max3_f32 v241, v241, v150, v151
    s_waitcnt lgkmcnt(7)
    v_mfma_f32_16x16x32_bf16 v[176:179], a[148:151], v[36:39], v[176:179]
    v_max3_f32 v242, v242, v154, v155
    v_mfma_f32_16x16x32_bf16 v[180:183], a[148:151], v[52:55], v[180:183]
    v_max3_f32 v243, v243, v158, v159
    v_mfma_f32_16x16x32_bf16 v[184:187], a[148:151], v[68:71], v[184:187]
    v_mfma_f32_16x16x32_bf16 v[188:191], a[148:151], v[84:87], v[188:191]
    ds_read_b128 a[148:151], v2 offset:20480
    s_waitcnt lgkmcnt(7)
    v_mfma_f32_16x16x32_bf16 v[176:179], a[152:155], v[40:43], v[176:179]
    v_max3_f32 v240, v240, v160, v161
    v_mfma_f32_16x16x32_bf16 v[180:183], a[152:155], v[56:59], v[180:183]
    v_max3_f32 v241, v241, v164, v165
    v_mfma_f32_16x16x32_bf16 v[184:187], a[152:155], v[72:75], v[184:187]
    v_max3_f32 v242, v242, v168, v169
    v_mfma_f32_16x16x32_bf16 v[188:191], a[152:155], v[88:91], v[188:191]
    ds_read_b128 a[152:155], v3 offset:20480
    v_max3_f32 v243, v243, v172, v173
    s_waitcnt lgkmcnt(7)
    v_mfma_f32_16x16x32_bf16 v[176:179], a[156:159], v[44:47], v[176:179]
    v_max3_f32 v240, v240, v162, v163
    v_mfma_f32_16x16x32_bf16 v[180:183], a[156:159], v[60:63], v[180:183]
    v_max3_f32 v241, v241, v166, v167
    v_mfma_f32_16x16x32_bf16 v[184:187], a[156:159], v[76:79], v[184:187]
    v_max3_f32 v242, v242, v170, v171
    v_mfma_f32_16x16x32_bf16 v[188:191], a[156:159], v[92:95], v[188:191]
    ds_read_b128 a[156:159], v4 offset:20480
    s_barrier
    v_max3_f32 v243, v243, v174, v175
    s_nop 3
    v_max3_f32 v240, v240, v176, v177
    v_max3_f32 v241, v241, v180, v181
    v_max3_f32 v242, v242, v184, v185
    v_max3_f32 v243, v243, v188, v189
    v_max3_f32 v240, v240, v178, v179
    v_max3_f32 v241, v241, v182, v183
    v_max3_f32 v242, v242, v186, v187
    v_max3_f32 v243, v243, v190, v191
    v_mov_b32 v244, v240
    v_mov_b32 v245, v241
    v_mov_b32 v246, v242
    v_mov_b32 v247, v243
    v_permlane16_swap_b32 v240, v244
    v_permlane16_swap_b32 v241, v245
    v_permlane16_swap_b32 v242, v246
    v_permlane16_swap_b32 v243, v247
    v_max_f32 v240, v240, v244
    v_max_f32 v241, v241, v245
    v_max_f32 v242, v242, v246
    v_max_f32 v243, v243, v247
    v_mov_b32 v244, v240
    v_mov_b32 v245, v241
    v_mov_b32 v246, v242
    v_mov_b32 v247, v243
    v_permlane32_swap_b32 v240, v244
    v_permlane32_swap_b32 v241, v245
    v_permlane32_swap_b32 v242, v246
    v_permlane32_swap_b32 v243, v247
    v_max_f32 v240, v240, v244
    v_max_f32 v241, v241, v245
    v_max_f32 v242, v242, v246
    v_max_f32 v243, v243, v247
    s_cmp_eq_u32 s28, 0
    s_cselect_b64 vcc, -1, 0
    v_add_f32 v240, 0x42c80000, v240
    v_add_f32 v241, 0x42c80000, v241
    v_add_f32 v242, 0x42c80000, v242
    v_add_f32 v243, 0x42c80000, v243
    v_cndmask_b32 v240, v116, v240, vcc
    v_cndmask_b32 v241, v117, v241, vcc
    v_cndmask_b32 v242, v118, v242, vcc
    v_cndmask_b32 v243, v119, v243, vcc
    v_sub_f32 v24, 0, v240
    v_sub_f32 v25, 0, v240
    v_sub_f32 v28, 0, v241
    v_sub_f32 v29, 0, v241
    v_sub_f32 v20, 0, v242
    v_sub_f32 v21, 0, v242
    v_sub_f32 v124, 0, v243
    v_sub_f32 v125, 0, v243
    v_pk_add_f32 v[128:129], v[128:129], v[24:25]
    v_pk_add_f32 v[130:131], v[130:131], v[24:25]
    v_pk_add_f32 v[132:133], v[132:133], v[28:29]
    v_pk_add_f32 v[134:135], v[134:135], v[28:29]
    v_pk_add_f32 v[136:137], v[136:137], v[20:21]
    v_pk_add_f32 v[138:139], v[138:139], v[20:21]
    v_pk_add_f32 v[140:141], v[140:141], v[124:125]
    v_pk_add_f32 v[142:143], v[142:143], v[124:125]
    v_pk_add_f32 v[144:145], v[144:145], v[24:25]
    v_pk_add_f32 v[146:147], v[146:147], v[24:25]
    v_pk_add_f32 v[148:149], v[148:149], v[28:29]
    v_pk_add_f32 v[150:151], v[150:151], v[28:29]
    v_pk_add_f32 v[152:153], v[152:153], v[20:21]
    v_pk_add_f32 v[154:155], v[154:155], v[20:21]
    v_pk_add_f32 v[156:157], v[156:157], v[124:125]
    v_pk_add_f32 v[158:159], v[158:159], v[124:125]
    v_pk_add_f32 v[160:161], v[160:161], v[24:25]
    v_pk_add_f32 v[162:163], v[162:163], v[24:25]
    v_pk_add_f32 v[164:165], v[164:165], v[28:29]
    v_pk_add_f32 v[166:167], v[166:167], v[28:29]
    v_pk_add_f32 v[168:169], v[168:169], v[20:21]
    v_pk_add_f32 v[170:171], v[170:171], v[20:21]
    v_pk_add_f32 v[172:173], v[172:173], v[124:125]
    v_pk_add_f32 v[174:175], v[174:175], v[124:125]
    v_pk_add_f32 v[176:177], v[176:177], v[24:25]
    v_pk_add_f32 v[178:179], v[178:179], v[24:25]
    v_pk_add_f32 v[180:181], v[180:181], v[28:29]
    v_pk_add_f32 v[182:183], v[182:183], v[28:29]
    v_pk_add_f32 v[184:185], v[184:185], v[20:21]
    v_pk_add_f32 v[186:187], v[186:187], v[20:21]
    v_pk_add_f32 v[188:189], v[188:189], v[124:125]
    v_pk_add_f32 v[190:191], v[190:191], v[124:125]
    v_mov_b64 v[26:27], v[24:25]
    v_mov_b64 v[30:31], v[28:29]
    v_mov_b64 v[22:23], v[20:21]
    v_mov_b64 v[126:127], v[124:125]
    s_waitcnt vmcnt(0)
    s_cmp_lg_u32 s28, 0
    s_cbranch_scc1 L_no_rts
    global_store_dwordx4 v114, a[192:195], s[56:57] offset:0 sc1
    global_store_dwordx4 v114, a[196:199], s[56:57] offset:1024 sc1
    global_store_dwordx4 v114, a[200:203], s[56:57] offset:2048 sc1
    global_store_dwordx4 v115, a[204:207], s[56:57] offset:3072 sc1
L_no_rts:
    s_getpc_b64 s[32:33]
L_pc:
    s_add_u32 s32, s32, L_tail-L_pc
    s_addc_u32 s33, s33, 0
    v_lshlrev_b32 v120, 1, v113
    v_lshl_add_u32 v120, s38, 13, v120
    v_min_u32 v120, L_code_end-L_tail-4, v120
    v_mov_b32 v121, s33
    v_add_co_u32 v120, vcc, s32, v120
    s_nop 1
    v_addc_co_u32 v121, vcc, 0, v121, vcc
    global_load_dword v112, v[120:121], off
    v_exp_f32 v128, v128
    v_exp_f32 v129, v129
    v_exp_f32 v130, v130
    v_exp_f32 v131, v131
    v_exp_f32 v132, v132
    v_exp_f32 v133, v133
    v_exp_f32 v134, v134
    v_exp_f32 v135, v135
    v_exp_f32 v136, v136
    v_exp_f32 v137, v137
    v_exp_f32 v138, v138
    v_exp_f32 v139, v139
    v_exp_f32 v140, v140
    v_exp_f32 v141, v141
    v_exp_f32 v142, v142
    v_exp_f32 v143, v143
    v_exp_f32 v144, v144
    v_exp_f32 v145, v145
    v_exp_f32 v146, v146
    v_exp_f32 v147, v147
    v_exp_f32 v148, v148
    v_exp_f32 v149, v149
    v_exp_f32 v150, v150
    v_exp_f32 v151, v151
    v_exp_f32 v152, v152
    v_exp_f32 v153, v153
    v_exp_f32 v154, v154
    v_exp_f32 v155, v155
    v_exp_f32 v156, v156
    v_exp_f32 v157, v157
    v_exp_f32 v158, v158
    v_exp_f32 v159, v159
    v_exp_f32 v160, v160
    v_exp_f32 v161, v161
    v_exp_f32 v162, v162
    v_exp_f32 v163, v163
    v_exp_f32 v164, v164
    v_cvt_pk_bf16_f32 v224, v128, v129
    v_cvt_pk_bf16_f32 v225, v130, v131
    v_cvt_pk_bf16_f32 v228, v132, v133
    v_cvt_pk_bf16_f32 v229, v134, v135
    v_cvt_pk_bf16_f32 v232, v136, v137
    v_cvt_pk_bf16_f32 v233, v138, v139
    v_cvt_pk_bf16_f32 v236, v140, v141
    v_cvt_pk_bf16_f32 v237, v142, v143
    v_cvt_pk_bf16_f32 v226, v144, v145
    v_cvt_pk_bf16_f32 v227, v146, v147
    v_cvt_pk_bf16_f32 v230, v148, v149
    v_cvt_pk_bf16_f32 v231, v150, v151
    v_cvt_pk_bf16_f32 v234, v152, v153
    v_cvt_pk_bf16_f32 v235, v154, v155
    v_cvt_pk_bf16_f32 v238, v156, v157
    v_cvt_pk_bf16_f32 v239, v158, v159
    v_cvt_pk_bf16_f32 v240, v160, v161
    v_cvt_pk_bf16_f32 v241, v162, v163
    s_nop 1
    s_waitcnt lgkmcnt(7)
    v_mfma_f32_16x16x32_bf16 v[128:131], a[128:131], v[32:35], v[24:27]
    v_exp_f32 v165, v165
    s_waitcnt lgkmcnt(6)
    v_mfma_f32_16x16x32_bf16 v[128:131], a[132:135], v[36:39], v[128:131]
    ds_read_b64_tr_b16 a[160:161], v5 offset:0
    v_cvt_pk_bf16_f32 v244, v164, v165
    s_waitcnt lgkmcnt(6)
    v_mfma_f32_16x16x32_bf16 v[128:131], a[136:139], v[40:43], v[128:131]
    v_exp_f32 v166, v166
    s_waitcnt lgkmcnt(5)
    v_mfma_f32_16x16x32_bf16 v[128:131], a[140:143], v[44:47], v[128:131]
    ds_read_b64_tr_b16 a[162:163], v5 offset:4096
    ds_read_b64_tr_b16 a[164:165], v5 offset:8192
    v_mfma_f32_16x16x32_bf16 v[132:135], a[140:143], v[60:63], v[28:31]
    v_exp_f32 v167, v167
    v_mfma_f32_16x16x32_bf16 v[132:135], a[136:139], v[56:59], v[132:135]
    ds_read_b64_tr_b16 a[166:167], v5 offset:12288
    v_cvt_pk_bf16_f32 v245, v166, v167
    v_mfma_f32_16x16x32_bf16 v[132:135], a[132:135], v[52:55], v[132:135]
    v_exp_f32 v168, v168
    v_mfma_f32_16x16x32_bf16 v[132:135], a[128:131], v[48:51], v[132:135]
    ds_read_b64_tr_b16 a[168:169], v6 offset:0
    ds_read_b64_tr_b16 a[170:171], v6 offset:4096
    v_mfma_f32_16x16x32_bf16 v[136:139], a[128:131], v[64:67], v[20:23]
    v_exp_f32 v169, v169
    v_mfma_f32_16x16x32_bf16 v[136:139], a[132:135], v[68:71], v[136:139]
    ds_read_b64_tr_b16 a[172:173], v6 offset:8192
    v_cvt_pk_bf16_f32 v248, v168, v169
    v_mfma_f32_16x16x32_bf16 v[136:139], a[136:139], v[72:75], v[136:139]
    v_exp_f32 v170, v170
    v_mfma_f32_16x16x32_bf16 v[136:139], a[140:143], v[76:79], v[136:139]
    ds_read_b64_tr_b16 a[174:175], v6 offset:12288
    ds_read_b64_tr_b16 a[176:177], v7 offset:0
    v_mfma_f32_16x16x32_bf16 v[140:143], a[140:143], v[92:95], v[124:127]
    v_exp_f32 v171, v171
    v_mfma_f32_16x16x32_bf16 v[140:143], a[136:139], v[88:91], v[140:143]
    ds_read_b64_tr_b16 a[178:179], v7 offset:4096
    v_cvt_pk_bf16_f32 v249, v170, v171
    v_mfma_f32_16x16x32_bf16 v[140:143], a[132:135], v[84:87], v[140:143]
    v_exp_f32 v172, v172
    v_mfma_f32_16x16x32_bf16 v[140:143], a[128:131], v[80:83], v[140:143]
    s_waitcnt lgkmcnt(10)
    ds_read_b64_tr_b16 a[180:181], v7 offset:8192
    v_mfma_f32_16x16x32_bf16 v[144:147], a[144:147], v[32:35], v[24:27]
    v_exp_f32 v173, v173
    v_mfma_f32_16x16x32_bf16 v[144:147], a[148:151], v[36:39], v[144:147]
    ds_read_b128 a[128:131], v1 offset:24576
    v_cvt_pk_bf16_f32 v252, v172, v173
    v_mfma_f32_16x16x32_bf16 v[144:147], a[152:155], v[40:43], v[144:147]
    v_exp_f32 v174, v174
    v_mfma_f32_16x16x32_bf16 v[144:147], a[156:159], v[44:47], v[144:147]
    ds_read_b128 a[132:135], v2 offset:24576
    ds_read_b128 a[136:139], v3 offset:24576
    v_mfma_f32_16x16x32_bf16 v[148:151], a[156:159], v[60:63], v[28:31]
    v_exp_f32 v175, v175
    v_mfma_f32_16x16x32_bf16 v[148:151], a[152:155], v[56:59], v[148:151]
    ds_read_b128 a[140:143], v4 offset:24576
    v_cvt_pk_bf16_f32 v253, v174, v175
    v_mfma_f32_16x16x32_bf16 v[148:151], a[148:151], v[52:55], v[148:151]
    v_exp_f32 v176, v176
    v_mfma_f32_16x16x32_bf16 v[148:151], a[144:147], v[48:51], v[148:151]
    ds_read_b64_tr_b16 a[182:183], v7 offset:12288
    ds_read_b64_tr_b16 a[184:185], v8 offset:0
    v_mfma_f32_16x16x32_bf16 v[152:155], a[144:147], v[64:67], v[20:23]
    v_exp_f32 v177, v177
    v_mfma_f32_16x16x32_bf16 v[152:155], a[148:151], v[68:71], v[152:155]
    ds_read_b64_tr_b16 a[186:187], v8 offset:4096
    v_cvt_pk_bf16_f32 v242, v176, v177
    v_mfma_f32_16x16x32_bf16 v[152:155], a[152:155], v[72:75], v[152:155]
    v_exp_f32 v178, v178
    v_mfma_f32_16x16x32_bf16 v[152:155], a[156:159], v[76:79], v[152:155]
    ds_read_b64_tr_b16 a[188:189], v8 offset:8192
    v_mfma_f32_16x16x32_bf16 v[156:159], a[156:159], v[92:95], v[124:127]
    v_exp_f32 v179, v179
    v_mfma_f32_16x16x32_bf16 v[156:159], a[152:155], v[88:91], v[156:159]
    ds_read_b64_tr_b16 a[190:191], v8 offset:12288
    v_cvt_pk_bf16_f32 v243, v178, v179
    v_mfma_f32_16x16x32_bf16 v[156:159], a[148:151], v[84:87], v[156:159]
    v_exp_f32 v180, v180
    v_mfma_f32_16x16x32_bf16 v[156:159], a[144:147], v[80:83], v[156:159]
    ds_read_b64_tr_b16 a[192:193], v9 offset:0
    s_waitcnt lgkmcnt(6)
    v_mfma_f32_16x16x32_bf16 v[160:163], a[128:131], v[32:35], v[24:27]
    v_exp_f32 v181, v181
    v_mfma_f32_16x16x32_bf16 v[160:163], a[132:135], v[36:39], v[160:163]
    ds_read_b128 a[144:147], v1 offset:28672
    v_cvt_pk_bf16_f32 v246, v180, v181
    v_mfma_f32_16x16x32_bf16 v[160:163], a[136:139], v[40:43], v[160:163]
    v_exp_f32 v182, v182
    v_mfma_f32_16x16x32_bf16 v[160:163], a[140:143], v[44:47], v[160:163]
    ds_read_b128 a[148:151], v2 offset:28672
    ds_read_b128 a[152:155], v3 offset:28672
    v_mfma_f32_16x16x32_bf16 v[164:167], a[140:143], v[60:63], v[28:31]
    v_exp_f32 v183, v183
    v_mfma_f32_16x16x32_bf16 v[164:167], a[136:139], v[56:59], v[164:167]
    ds_read_b128 a[156:159], v4 offset:28672
    v_cvt_pk_bf16_f32 v247, v182, v183
    v_mfma_f32_16x16x32_bf16 v[164:167], a[132:135], v[52:55], v[164:167]
    v_exp_f32 v184, v184
    v_mfma_f32_16x16x32_bf16 v[164:167], a[128:131], v[48:51], v[164:167]
    ds_read_b64_tr_b16 a[194:195], v9 offset:4096
    ds_read_b64_tr_b16 a[196:197], v9 offset:8192
    v_mfma_f32_16x16x32_bf16 v[168:171], a[128:131], v[64:67], v[20:23]
    v_exp_f32 v185, v185
    v_mfma_f32_16x16x32_bf16 v[168:171], a[132:135], v[68:71], v[168:171]
    ds_read_b64_tr_b16 a[198:199], v9 offset:12288
    v_cvt_pk_bf16_f32 v250, v184, v185
    v_mfma_f32_16x16x32_bf16 v[168:171], a[136:139], v[72:75], v[168:171]
    v_exp_f32 v186, v186
    v_mfma_f32_16x16x32_bf16 v[168:171], a[140:143], v[76:79], v[168:171]
    ds_read_b64_tr_b16 a[200:201], v10 offset:0
    ds_read_b64_tr_b16 a[202:203], v10 offset:4096
    v_mfma_f32_16x16x32_bf16 v[172:175], a[140:143], v[92:95], v[124:127]
    v_exp_f32 v187, v187
    v_mfma_f32_16x16x32_bf16 v[172:175], a[136:139], v[88:91], v[172:175]
    ds_read_b64_tr_b16 a[204:205], v10 offset:8192
    v_cvt_pk_bf16_f32 v251, v186, v187
    v_mfma_f32_16x16x32_bf16 v[172:175], a[132:135], v[84:87], v[172:175]
    v_exp_f32 v188, v188
    v_mfma_f32_16x16x32_bf16 v[172:175], a[128:131], v[80:83], v[172:175]
    ds_read_b64_tr_b16 a[206:207], v10 offset:12288
    s_waitcnt lgkmcnt(7)
    v_mfma_f32_16x16x32_bf16 v[176:179], a[144:147], v[32:35], v[24:27]
    v_exp_f32 v189, v189
    v_mfma_f32_16x16x32_bf16 v[176:179], a[148:151], v[36:39], v[176:179]
    ds_read_b64_tr_b16 a[208:209], v11 offset:0
    v_cvt_pk_bf16_f32 v254, v188, v189
    v_mfma_f32_16x16x32_bf16 v[176:179], a[152:155], v[40:43], v[176:179]
    v_exp_f32 v190, v190
    v_mfma_f32_16x16x32_bf16 v[176:179], a[156:159], v[44:47], v[176:179]
    ds_read_b64_tr_b16 a[210:211], v11 offset:4096
    v_mfma_f32_16x16x32_bf16 v[180:183], a[156:159], v[60:63], v[28:31]
    v_exp_f32 v191, v191
    v_mfma_f32_16x16x32_bf16 v[180:183], a[152:155], v[56:59], v[180:183]
    ds_read_b64_tr_b16 a[212:213], v11 offset:8192
    v_cvt_pk_bf16_f32 v255, v190, v191
    v_mfma_f32_16x16x32_bf16 v[180:183], a[148:151], v[52:55], v[180:183]
    v_mfma_f32_16x16x32_bf16 v[180:183], a[144:147], v[48:51], v[180:183]
    ds_read_b64_tr_b16 a[214:215], v11 offset:12288
    s_mov_b32 s16, s56
    v_mfma_f32_16x16x32_bf16 v[184:187], a[144:147], v[64:67], v[20:23]
    v_mfma_f32_16x16x32_bf16 v[184:187], a[148:151], v[68:71], v[184:187]
    ds_read_b64_tr_b16 a[216:217], v12 offset:0
    s_mov_b32 s17, s57
    v_mfma_f32_16x16x32_bf16 v[184:187], a[152:155], v[72:75], v[184:187]
    v_mfma_f32_16x16x32_bf16 v[184:187], a[156:159], v[76:79], v[184:187]
    ds_read_b64_tr_b16 a[218:219], v12 offset:4096
    s_mov_b32 s18, 50331648
    v_mfma_f32_16x16x32_bf16 v[188:191], a[156:159], v[92:95], v[124:127]
    v_mfma_f32_16x16x32_bf16 v[188:191], a[152:155], v[88:91], v[188:191]
    ds_read_b64_tr_b16 a[220:221], v12 offset:8192
    s_mov_b32 s19, 0x20000
    v_mfma_f32_16x16x32_bf16 v[188:191], a[148:151], v[84:87], v[188:191]
    v_exp_f32 v128, v128
    v_mfma_f32_16x16x32_bf16 v[188:191], a[144:147], v[80:83], v[188:191]
    ds_read_b64_tr_b16 a[222:223], v12 offset:12288
    s_lshl_b32 s14, s47, 21
    v_mfma_f32_16x16x32_bf16 a[0:3], a[160:163], v[224:227], 0
    v_exp_f32 v129, v129
    v_mfma_f32_16x16x32_bf16 a[0:3], a[164:167], v[240:243], a[0:3]
    v_cvt_pk_bf16_f32 v192, v128, v129
    s_lshl_b32 s32, s46, 12
    v_mfma_f32_16x16x32_bf16 a[4:7], a[164:167], v[244:247], 0
    v_exp_f32 v130, v130
    v_mfma_f32_16x16x32_bf16 a[4:7], a[160:163], v[228:231], a[4:7]
    ds_read_b128 a[128:131], v1 offset:32768
    s_add_u32 s14, s14, s32
    s_add_u32 m0, s26, 98304
    v_mfma_f32_16x16x32_bf16 a[8:11], a[160:163], v[232:235], 0
    v_exp_f32 v131, v131
    v_mfma_f32_16x16x32_bf16 a[8:11], a[164:167], v[248:251], a[8:11]
    buffer_load_dwordx4 v17, s[8:11], s25 offen offset:0 nt lds
    v_cvt_pk_bf16_f32 v193, v130, v131
    s_lshl_b32 s32, s38, 19
    v_mfma_f32_16x16x32_bf16 a[12:15], a[164:167], v[252:255], 0
    v_exp_f32 v132, v132
    v_mfma_f32_16x16x32_bf16 a[12:15], a[160:163], v[236:239], a[12:15]
    s_add_u32 s14, s14, s32
    v_mfma_f32_16x16x32_bf16 a[28:31], a[168:171], v[236:239], 0
    v_exp_f32 v133, v133
    v_mfma_f32_16x16x32_bf16 a[28:31], a[172:175], v[252:255], a[28:31]
    v_cvt_pk_bf16_f32 v196, v132, v133
    s_add_u32 s14, s14, 4194304
    v_mfma_f32_16x16x32_bf16 a[24:27], a[172:175], v[248:251], 0
    v_exp_f32 v134, v134
    v_mfma_f32_16x16x32_bf16 a[24:27], a[168:171], v[232:235], a[24:27]
    ds_read_b128 a[132:135], v2 offset:32768
    s_and_b32 s32, s2, 7
    v_mfma_f32_16x16x32_bf16 a[20:23], a[168:171], v[228:231], 0
    v_exp_f32 v135, v135
    v_mfma_f32_16x16x32_bf16 a[20:23], a[172:175], v[244:247], a[20:23]
    buffer_load_dwordx4 v18, s[8:11], s25 offen offset:1024 nt lds
    v_cvt_pk_bf16_f32 v197, v134, v135
    s_lshl_b32 s13, s32, 4
    v_mfma_f32_16x16x32_bf16 a[16:19], a[172:175], v[240:243], 0
    v_exp_f32 v136, v136
    v_mfma_f32_16x16x32_bf16 a[16:19], a[168:171], v[224:227], a[16:19]
    s_lshr_b32 s33, s2, 4
    v_mfma_f32_16x16x32_bf16 a[32:35], a[176:179], v[224:227], 0
    v_exp_f32 v137, v137
    v_mfma_f32_16x16x32_bf16 a[32:35], a[180:183], v[240:243], a[32:35]
    v_cvt_pk_bf16_f32 v200, v136, v137
    s_add_u32 s13, s13, s33
    v_mfma_f32_16x16x32_bf16 a[36:39], a[180:183], v[244:247], 0
    v_exp_f32 v138, v138
    v_mfma_f32_16x16x32_bf16 a[36:39], a[176:179], v[228:231], a[36:39]
    ds_read_b128 a[136:139], v3 offset:32768
    s_lshl_b32 s13, s13, 2
    v_mfma_f32_16x16x32_bf16 a[40:43], a[176:179], v[232:235], 0
    v_exp_f32 v139, v139
    v_mfma_f32_16x16x32_bf16 a[40:43], a[180:183], v[248:251], a[40:43]
    buffer_load_dwordx4 v17, s[8:11], s25 offen offset:2048 nt lds
    v_cvt_pk_bf16_f32 v201, v138, v139
    s_add_u32 s13, s13, s38
    v_mfma_f32_16x16x32_bf16 a[44:47], a[180:183], v[252:255], 0
    v_exp_f32 v140, v140
    v_mfma_f32_16x16x32_bf16 a[44:47], a[176:179], v[236:239], a[44:47]
    s_lshl_b32 s13, s13, 12
    v_mfma_f32_16x16x32_bf16 a[60:63], a[184:187], v[236:239], 0
    v_exp_f32 v141, v141
    v_mfma_f32_16x16x32_bf16 a[60:63], a[188:191], v[252:255], a[60:63]
    v_cvt_pk_bf16_f32 v204, v140, v141
    s_bfe_u32 s34, s2, 0x10003
    v_mfma_f32_16x16x32_bf16 a[56:59], a[188:191], v[248:251], 0
    v_exp_f32 v142, v142
    v_mfma_f32_16x16x32_bf16 a[56:59], a[184:187], v[232:235], a[56:59]
    ds_read_b128 a[140:143], v4 offset:32768
    s_lshl_b32 s35, s34, 22
    s_waitcnt lgkmcnt(4)
    v_mfma_f32_16x16x32_bf16 a[52:55], a[184:187], v[228:231], 0
    v_exp_f32 v143, v143
    v_mfma_f32_16x16x32_bf16 a[52:55], a[188:191], v[244:247], a[52:55]
    buffer_load_dwordx4 v18, s[8:11], s25 offen offset:3072 nt lds
    v_cvt_pk_bf16_f32 v205, v142, v143
    s_add_u32 s13, s13, s35
    v_mfma_f32_16x16x32_bf16 a[48:51], a[188:191], v[240:243], 0
    v_exp_f32 v144, v144
    v_mfma_f32_16x16x32_bf16 a[48:51], a[184:187], v[224:227], a[48:51]
    s_add_u32 s13, s13, 20971520
    s_add_u32 s25, s25, 16384
    v_mfma_f32_16x16x32_bf16 a[64:67], a[192:195], v[224:227], 0
    v_exp_f32 v145, v145
    v_mfma_f32_16x16x32_bf16 a[64:67], a[196:199], v[240:243], a[64:67]
    v_cvt_pk_bf16_f32 v194, v144, v145
    s_lshl_b32 s32, s32, 1
    v_mfma_f32_16x16x32_bf16 a[68:71], a[196:199], v[244:247], 0
    v_exp_f32 v146, v146
    v_mfma_f32_16x16x32_bf16 a[68:71], a[192:195], v[228:231], a[68:71]
    ds_read_b128 a[144:147], v1 offset:36864
    s_add_u32 s32, s32, s34
    s_add_u32 m0, s26, 0
    v_mfma_f32_16x16x32_bf16 a[72:75], a[192:195], v[232:235], 0
    v_exp_f32 v147, v147
    v_mfma_f32_16x16x32_bf16 a[72:75], a[196:199], v[248:251], a[72:75]
    buffer_load_dwordx4 v13, s[4:7], s24 offen offset:0 nt lds
    v_cvt_pk_bf16_f32 v195, v146, v147
    s_lshl_b32 s32, s32, 2
    v_mfma_f32_16x16x32_bf16 a[76:79], a[196:199], v[252:255], 0
    v_exp_f32 v148, v148
    v_mfma_f32_16x16x32_bf16 a[76:79], a[192:195], v[236:239], a[76:79]
    s_add_u32 s32, s32, s38
    v_mfma_f32_16x16x32_bf16 a[92:95], a[200:203], v[236:239], 0
    v_exp_f32 v149, v149
    v_mfma_f32_16x16x32_bf16 a[92:95], a[204:207], v[252:255], a[92:95]
    v_cvt_pk_bf16_f32 v198, v148, v149
    s_mul_i32 s32, s32, 112
    v_mfma_f32_16x16x32_bf16 a[88:91], a[204:207], v[248:251], 0
    v_exp_f32 v150, v150
    v_mfma_f32_16x16x32_bf16 a[88:91], a[200:203], v[232:235], a[88:91]
    ds_read_b128 a[148:151], v2 offset:36864
    s_mul_i32 s33, s33, 7
    v_mfma_f32_16x16x32_bf16 a[84:87], a[200:203], v[228:231], 0
    v_exp_f32 v151, v151
    v_mfma_f32_16x16x32_bf16 a[84:87], a[204:207], v[244:247], a[84:87]
    buffer_load_dwordx4 v14, s[4:7], s24 offen offset:1024 nt lds
    v_cvt_pk_bf16_f32 v199, v150, v151
    s_add_u32 s32, s32, s33
    v_mfma_f32_16x16x32_bf16 a[80:83], a[204:207], v[240:243], 0
    v_exp_f32 v152, v152
    v_mfma_f32_16x16x32_bf16 a[80:83], a[200:203], v[224:227], a[80:83]
    s_lshl_b32 s32, s32, 10
    v_mfma_f32_16x16x32_bf16 a[96:99], a[208:211], v[224:227], 0
    v_exp_f32 v153, v153
    v_mfma_f32_16x16x32_bf16 a[96:99], a[212:215], v[240:243], a[96:99]
    v_cvt_pk_bf16_f32 v202, v152, v153
    s_add_u32 s31, s32, 33554432
    v_mfma_f32_16x16x32_bf16 a[100:103], a[212:215], v[244:247], 0
    v_exp_f32 v154, v154
    v_mfma_f32_16x16x32_bf16 a[100:103], a[208:211], v[228:231], a[100:103]
    ds_read_b128 a[152:155], v3 offset:36864
    s_add_u32 s12, s31, 4096
    v_mfma_f32_16x16x32_bf16 a[104:107], a[208:211], v[232:235], 0
    v_exp_f32 v155, v155
    v_mfma_f32_16x16x32_bf16 a[104:107], a[212:215], v[248:251], a[104:107]
    buffer_load_dwordx4 v15, s[4:7], s24 offen offset:2048 nt lds
    v_cvt_pk_bf16_f32 v203, v154, v155
    v_mfma_f32_16x16x32_bf16 a[108:111], a[212:215], v[252:255], 0
    v_exp_f32 v156, v156
    v_mfma_f32_16x16x32_bf16 a[108:111], a[208:211], v[236:239], a[108:111]
    v_mfma_f32_16x16x32_bf16 a[124:127], a[216:219], v[236:239], 0
    v_exp_f32 v157, v157
    v_mfma_f32_16x16x32_bf16 a[124:127], a[220:223], v[252:255], a[124:127]
    v_cvt_pk_bf16_f32 v206, v156, v157
    v_mfma_f32_16x16x32_bf16 a[120:123], a[220:223], v[248:251], 0
    v_exp_f32 v158, v158
    v_mfma_f32_16x16x32_bf16 a[120:123], a[216:219], v[232:235], a[120:123]
    ds_read_b128 a[156:159], v4 offset:36864
    v_mfma_f32_16x16x32_bf16 a[116:119], a[216:219], v[228:231], 0
    v_exp_f32 v159, v159
    v_mfma_f32_16x16x32_bf16 a[116:119], a[220:223], v[244:247], a[116:119]
    buffer_load_dwordx4 v16, s[4:7], s24 offen offset:3072 nt lds
    v_cvt_pk_bf16_f32 v207, v158, v159
    v_mfma_f32_16x16x32_bf16 a[112:115], a[220:223], v[240:243], 0
    v_exp_f32 v160, v160
    v_mfma_f32_16x16x32_bf16 a[112:115], a[216:219], v[224:227], a[112:115]
    s_add_u32 s24, s24, 16384
    s_waitcnt vmcnt(9)
    s_barrier
    s_mov_b64 exec, 1
    v_mov_b32 v121, s3
    buffer_store_dword v121, off, s[52:55], s37 sc1
    s_mov_b64 exec, -1
    v_mfma_f32_16x16x32_bf16 a[224:227], a[240:243], v[224:227], 0
    v_exp_f32 v161, v161
    v_mfma_f32_16x16x32_bf16 a[224:227], a[240:243], v[240:243], a[224:227]
    v_cvt_pk_bf16_f32 v208, v160, v161
    v_mfma_f32_16x16x32_bf16 a[228:231], a[240:243], v[244:247], 0
    v_exp_f32 v162, v162
    v_mfma_f32_16x16x32_bf16 a[228:231], a[240:243], v[228:231], a[228:231]
    s_waitcnt lgkmcnt(4)
    v_mfma_f32_16x16x32_bf16 a[232:235], a[240:243], v[232:235], 0
    v_exp_f32 v163, v163
    v_mfma_f32_16x16x32_bf16 a[232:235], a[240:243], v[248:251], a[232:235]
    v_cvt_pk_bf16_f32 v209, v162, v163
    v_mfma_f32_16x16x32_bf16 a[236:239], a[240:243], v[252:255], 0
    v_exp_f32 v164, v164
    v_mfma_f32_16x16x32_bf16 a[236:239], a[240:243], v[236:239], a[236:239]
    s_barrier
    s_mov_b32 s27, 0
L_attn_loop:
    v_mfma_f32_16x16x32_bf16 v[128:131], a[128:131], v[32:35], v[24:27]
    v_exp_f32 v165, v165
    v_mfma_f32_16x16x32_bf16 v[128:131], a[132:135], v[36:39], v[128:131]
    ds_read_b64_tr_b16 a[160:161], v5 offset:16384
    v_cvt_pk_bf16_f32 v212, v164, v165
    v_mfma_f32_16x16x32_bf16 v[128:131], a[136:139], v[40:43], v[128:131]
    v_exp_f32 v166, v166
    v_mfma_f32_16x16x32_bf16 v[128:131], a[140:143], v[44:47], v[128:131]
    ds_read_b64_tr_b16 a[162:163], v5 offset:20480
    ds_read_b64_tr_b16 a[164:165], v5 offset:24576
    v_mfma_f32_16x16x32_bf16 v[132:135], a[140:143], v[60:63], v[28:31]
    v_exp_f32 v167, v167
    v_mfma_f32_16x16x32_bf16 v[132:135], a[136:139], v[56:59], v[132:135]
    ds_read_b64_tr_b16 a[166:167], v5 offset:28672
    v_cvt_pk_bf16_f32 v213, v166, v167
    v_mfma_f32_16x16x32_bf16 v[132:135], a[132:135], v[52:55], v[132:135]
    v_exp_f32 v168, v168
    v_mfma_f32_16x16x32_bf16 v[132:135], a[128:131], v[48:51], v[132:135]
    ds_read_b64_tr_b16 a[168:169], v6 offset:16384
    ds_read_b64_tr_b16 a[170:171], v6 offset:20480
    v_mfma_f32_16x16x32_bf16 v[136:139], a[128:131], v[64:67], v[20:23]
    v_exp_f32 v169, v169
    v_mfma_f32_16x16x32_bf16 v[136:139], a[132:135], v[68:71], v[136:139]
    ds_read_b64_tr_b16 a[172:173], v6 offset:24576
    v_cvt_pk_bf16_f32 v216, v168, v169
    v_mfma_f32_16x16x32_bf16 v[136:139], a[136:139], v[72:75], v[136:139]
    v_exp_f32 v170, v170
    v_mfma_f32_16x16x32_bf16 v[136:139], a[140:143], v[76:79], v[136:139]
    ds_read_b64_tr_b16 a[174:175], v6 offset:28672
    ds_read_b64_tr_b16 a[176:177], v7 offset:16384
    v_mfma_f32_16x16x32_bf16 v[140:143], a[140:143], v[92:95], v[124:127]
    v_exp_f32 v171, v171
    v_mfma_f32_16x16x32_bf16 v[140:143], a[136:139], v[88:91], v[140:143]
    ds_read_b64_tr_b16 a[178:179], v7 offset:20480
    v_cvt_pk_bf16_f32 v217, v170, v171
    v_mfma_f32_16x16x32_bf16 v[140:143], a[132:135], v[84:87], v[140:143]
    v_exp_f32 v172, v172
    v_mfma_f32_16x16x32_bf16 v[140:143], a[128:131], v[80:83], v[140:143]
    s_waitcnt lgkmcnt(10)
    ds_read_b64_tr_b16 a[180:181], v7 offset:24576
    v_mfma_f32_16x16x32_bf16 v[144:147], a[144:147], v[32:35], v[24:27]
    v_exp_f32 v173, v173
    v_mfma_f32_16x16x32_bf16 v[144:147], a[148:151], v[36:39], v[144:147]
    ds_read_b128 a[128:131], v1 offset:40960
    v_cvt_pk_bf16_f32 v220, v172, v173
    v_mfma_f32_16x16x32_bf16 v[144:147], a[152:155], v[40:43], v[144:147]
    v_exp_f32 v174, v174
    v_mfma_f32_16x16x32_bf16 v[144:147], a[156:159], v[44:47], v[144:147]
    ds_read_b128 a[132:135], v2 offset:40960
    ds_read_b128 a[136:139], v3 offset:40960
    v_mfma_f32_16x16x32_bf16 v[148:151], a[156:159], v[60:63], v[28:31]
    v_exp_f32 v175, v175
    v_mfma_f32_16x16x32_bf16 v[148:151], a[152:155], v[56:59], v[148:151]
    ds_read_b128 a[140:143], v4 offset:40960
    v_cvt_pk_bf16_f32 v221, v174, v175
    v_mfma_f32_16x16x32_bf16 v[148:151], a[148:151], v[52:55], v[148:151]
    v_exp_f32 v176, v176
    v_mfma_f32_16x16x32_bf16 v[148:151], a[144:147], v[48:51], v[148:151]
    ds_read_b64_tr_b16 a[182:183], v7 offset:28672
    ds_read_b64_tr_b16 a[184:185], v8 offset:16384
    v_mfma_f32_16x16x32_bf16 v[152:155], a[144:147], v[64:67], v[20:23]
    v_exp_f32 v177, v177
    v_mfma_f32_16x16x32_bf16 v[152:155], a[148:151], v[68:71], v[152:155]
    ds_read_b64_tr_b16 a[186:187], v8 offset:20480
    v_cvt_pk_bf16_f32 v210, v176, v177
    v_mfma_f32_16x16x32_bf16 v[152:155], a[152:155], v[72:75], v[152:155]
    v_exp_f32 v178, v178
    v_mfma_f32_16x16x32_bf16 v[152:155], a[156:159], v[76:79], v[152:155]
    ds_read_b64_tr_b16 a[188:189], v8 offset:24576
    v_mfma_f32_16x16x32_bf16 v[156:159], a[156:159], v[92:95], v[124:127]
    v_exp_f32 v179, v179
    v_mfma_f32_16x16x32_bf16 v[156:159], a[152:155], v[88:91], v[156:159]
    ds_read_b64_tr_b16 a[190:191], v8 offset:28672
    v_cvt_pk_bf16_f32 v211, v178, v179
    v_mfma_f32_16x16x32_bf16 v[156:159], a[148:151], v[84:87], v[156:159]
    v_exp_f32 v180, v180
    v_mfma_f32_16x16x32_bf16 v[156:159], a[144:147], v[80:83], v[156:159]
    ds_read_b64_tr_b16 a[192:193], v9 offset:16384
    s_waitcnt lgkmcnt(6)
    v_mfma_f32_16x16x32_bf16 v[160:163], a[128:131], v[32:35], v[24:27]
    v_exp_f32 v181, v181
    v_mfma_f32_16x16x32_bf16 v[160:163], a[132:135], v[36:39], v[160:163]
    ds_read_b128 a[144:147], v1 offset:45056
    v_cvt_pk_bf16_f32 v214, v180, v181
    v_mfma_f32_16x16x32_bf16 v[160:163], a[136:139], v[40:43], v[160:163]
    v_exp_f32 v182, v182
    v_mfma_f32_16x16x32_bf16 v[160:163], a[140:143], v[44:47], v[160:163]
    ds_read_b128 a[148:151], v2 offset:45056
    ds_read_b128 a[152:155], v3 offset:45056
    v_mfma_f32_16x16x32_bf16 v[164:167], a[140:143], v[60:63], v[28:31]
    v_exp_f32 v183, v183
    v_mfma_f32_16x16x32_bf16 v[164:167], a[136:139], v[56:59], v[164:167]
    ds_read_b128 a[156:159], v4 offset:45056
    v_cvt_pk_bf16_f32 v215, v182, v183
    v_mfma_f32_16x16x32_bf16 v[164:167], a[132:135], v[52:55], v[164:167]
    v_exp_f32 v184, v184
    v_mfma_f32_16x16x32_bf16 v[164:167], a[128:131], v[48:51], v[164:167]
    ds_read_b64_tr_b16 a[194:195], v9 offset:20480
    ds_read_b64_tr_b16 a[196:197], v9 offset:24576
    v_mfma_f32_16x16x32_bf16 v[168:171], a[128:131], v[64:67], v[20:23]
    v_exp_f32 v185, v185
    v_mfma_f32_16x16x32_bf16 v[168:171], a[132:135], v[68:71], v[168:171]
    ds_read_b64_tr_b16 a[198:199], v9 offset:28672
    v_cvt_pk_bf16_f32 v218, v184, v185
    v_mfma_f32_16x16x32_bf16 v[168:171], a[136:139], v[72:75], v[168:171]
    v_exp_f32 v186, v186
    v_mfma_f32_16x16x32_bf16 v[168:171], a[140:143], v[76:79], v[168:171]
    ds_read_b64_tr_b16 a[200:201], v10 offset:16384
    ds_read_b64_tr_b16 a[202:203], v10 offset:20480
    v_mfma_f32_16x16x32_bf16 v[172:175], a[140:143], v[92:95], v[124:127]
    v_exp_f32 v187, v187
    v_mfma_f32_16x16x32_bf16 v[172:175], a[136:139], v[88:91], v[172:175]
    ds_read_b64_tr_b16 a[204:205], v10 offset:24576
    v_cvt_pk_bf16_f32 v219, v186, v187
    v_mfma_f32_16x16x32_bf16 v[172:175], a[132:135], v[84:87], v[172:175]
    v_exp_f32 v188, v188
    v_mfma_f32_16x16x32_bf16 v[172:175], a[128:131], v[80:83], v[172:175]
    ds_read_b64_tr_b16 a[206:207], v10 offset:28672
    s_waitcnt lgkmcnt(7)
    v_mfma_f32_16x16x32_bf16 v[176:179], a[144:147], v[32:35], v[24:27]
    v_exp_f32 v189, v189
    v_mfma_f32_16x16x32_bf16 v[176:179], a[148:151], v[36:39], v[176:179]
    ds_read_b64_tr_b16 a[208:209], v11 offset:16384
    v_cvt_pk_bf16_f32 v222, v188, v189
    v_mfma_f32_16x16x32_bf16 v[176:179], a[152:155], v[40:43], v[176:179]
    v_exp_f32 v190, v190
    v_mfma_f32_16x16x32_bf16 v[176:179], a[156:159], v[44:47], v[176:179]
    ds_read_b64_tr_b16 a[210:211], v11 offset:20480
    v_mfma_f32_16x16x32_bf16 v[180:183], a[156:159], v[60:63], v[28:31]
    v_exp_f32 v191, v191
    v_mfma_f32_16x16x32_bf16 v[180:183], a[152:155], v[56:59], v[180:183]
    ds_read_b64_tr_b16 a[212:213], v11 offset:24576
    v_cvt_pk_bf16_f32 v223, v190, v191
    v_mfma_f32_16x16x32_bf16 v[180:183], a[148:151], v[52:55], v[180:183]
    buffer_load_dword v112, v113, s[48:51], s45 offen
    s_add_u32 s45, s45, 0x100000
    v_mfma_f32_16x16x32_bf16 v[180:183], a[144:147], v[48:51], v[180:183]
    ds_read_b64_tr_b16 a[214:215], v11 offset:28672
    v_mfma_f32_16x16x32_bf16 v[184:187], a[144:147], v[64:67], v[20:23]
    buffer_load_dword v112, v103, s[16:19], s31 offen offset:0
    v_mfma_f32_16x16x32_bf16 v[184:187], a[148:151], v[68:71], v[184:187]
    ds_read_b64_tr_b16 a[216:217], v12 offset:16384
    v_mfma_f32_16x16x32_bf16 v[184:187], a[152:155], v[72:75], v[184:187]
    v_mfma_f32_16x16x32_bf16 v[184:187], a[156:159], v[76:79], v[184:187]
    ds_read_b64_tr_b16 a[218:219], v12 offset:20480
    v_mfma_f32_16x16x32_bf16 v[188:191], a[156:159], v[92:95], v[124:127]
    v_mfma_f32_16x16x32_bf16 v[188:191], a[152:155], v[88:91], v[188:191]
    ds_read_b64_tr_b16 a[220:221], v12 offset:24576
    v_mfma_f32_16x16x32_bf16 v[188:191], a[148:151], v[84:87], v[188:191]
    v_exp_f32 v128, v128
    v_mfma_f32_16x16x32_bf16 v[188:191], a[144:147], v[80:83], v[188:191]
    ds_read_b64_tr_b16 a[222:223], v12 offset:28672
    v_mfma_f32_16x16x32_bf16 a[0:3], a[160:163], v[192:195], a[0:3]
    v_exp_f32 v129, v129
    v_mfma_f32_16x16x32_bf16 a[0:3], a[164:167], v[208:211], a[0:3]
    v_cvt_pk_bf16_f32 v224, v128, v129
    v_mfma_f32_16x16x32_bf16 a[4:7], a[164:167], v[212:215], a[4:7]
    v_exp_f32 v130, v130
    v_mfma_f32_16x16x32_bf16 a[4:7], a[160:163], v[196:199], a[4:7]
    ds_read_b128 a[128:131], v1 offset:49152
    s_add_u32 m0, s26, 114688
    v_mfma_f32_16x16x32_bf16 a[8:11], a[160:163], v[200:203], a[8:11]
    v_exp_f32 v131, v131
    v_mfma_f32_16x16x32_bf16 a[8:11], a[164:167], v[216:219], a[8:11]
    buffer_load_dwordx4 v17, s[8:11], s25 offen offset:0 nt lds
    v_cvt_pk_bf16_f32 v225, v130, v131
    v_mfma_f32_16x16x32_bf16 a[12:15], a[164:167], v[220:223], a[12:15]
    v_exp_f32 v132, v132
    v_mfma_f32_16x16x32_bf16 a[12:15], a[160:163], v[204:207], a[12:15]
    v_mfma_f32_16x16x32_bf16 a[28:31], a[168:171], v[204:207], a[28:31]
    v_exp_f32 v133, v133
    v_mfma_f32_16x16x32_bf16 a[28:31], a[172:175], v[220:223], a[28:31]
    v_cvt_pk_bf16_f32 v228, v132, v133
    v_mfma_f32_16x16x32_bf16 a[24:27], a[172:175], v[216:219], a[24:27]
    v_exp_f32 v134, v134
    v_mfma_f32_16x16x32_bf16 a[24:27], a[168:171], v[200:203], a[24:27]
    ds_read_b128 a[132:135], v2 offset:49152
    v_mfma_f32_16x16x32_bf16 a[20:23], a[168:171], v[196:199], a[20:23]
    v_exp_f32 v135, v135
    v_mfma_f32_16x16x32_bf16 a[20:23], a[172:175], v[212:215], a[20:23]
    buffer_load_dwordx4 v18, s[8:11], s25 offen offset:1024 nt lds
    v_cvt_pk_bf16_f32 v229, v134, v135
    v_mfma_f32_16x16x32_bf16 a[16:19], a[172:175], v[208:211], a[16:19]
    v_exp_f32 v136, v136
    v_mfma_f32_16x16x32_bf16 a[16:19], a[168:171], v[192:195], a[16:19]
    v_mfma_f32_16x16x32_bf16 a[32:35], a[176:179], v[192:195], a[32:35]
    v_exp_f32 v137, v137
    v_mfma_f32_16x16x32_bf16 a[32:35], a[180:183], v[208:211], a[32:35]
    v_cvt_pk_bf16_f32 v232, v136, v137
    v_mfma_f32_16x16x32_bf16 a[36:39], a[180:183], v[212:215], a[36:39]
    v_exp_f32 v138, v138
    v_mfma_f32_16x16x32_bf16 a[36:39], a[176:179], v[196:199], a[36:39]
    ds_read_b128 a[136:139], v3 offset:49152
    v_mfma_f32_16x16x32_bf16 a[40:43], a[176:179], v[200:203], a[40:43]
    v_exp_f32 v139, v139
    v_mfma_f32_16x16x32_bf16 a[40:43], a[180:183], v[216:219], a[40:43]
    buffer_load_dwordx4 v17, s[8:11], s25 offen offset:2048 nt lds
    v_cvt_pk_bf16_f32 v233, v138, v139
    v_mfma_f32_16x16x32_bf16 a[44:47], a[180:183], v[220:223], a[44:47]
    v_exp_f32 v140, v140
    v_mfma_f32_16x16x32_bf16 a[44:47], a[176:179], v[204:207], a[44:47]
    v_mfma_f32_16x16x32_bf16 a[60:63], a[184:187], v[204:207], a[60:63]
    v_exp_f32 v141, v141
    v_mfma_f32_16x16x32_bf16 a[60:63], a[188:191], v[220:223], a[60:63]
    v_cvt_pk_bf16_f32 v236, v140, v141
    v_mfma_f32_16x16x32_bf16 a[56:59], a[188:191], v[216:219], a[56:59]
    v_exp_f32 v142, v142
    v_mfma_f32_16x16x32_bf16 a[56:59], a[184:187], v[200:203], a[56:59]
    ds_read_b128 a[140:143], v4 offset:49152
    s_waitcnt lgkmcnt(4)
    v_mfma_f32_16x16x32_bf16 a[52:55], a[184:187], v[196:199], a[52:55]
    v_exp_f32 v143, v143
    v_mfma_f32_16x16x32_bf16 a[52:55], a[188:191], v[212:215], a[52:55]
    buffer_load_dwordx4 v18, s[8:11], s25 offen offset:3072 nt lds
    v_cvt_pk_bf16_f32 v237, v142, v143
    v_mfma_f32_16x16x32_bf16 a[48:51], a[188:191], v[208:211], a[48:51]
    v_exp_f32 v144, v144
    v_mfma_f32_16x16x32_bf16 a[48:51], a[184:187], v[192:195], a[48:51]
    s_add_u32 s25, s25, 16384
    v_mfma_f32_16x16x32_bf16 a[64:67], a[192:195], v[192:195], a[64:67]
    v_exp_f32 v145, v145
    v_mfma_f32_16x16x32_bf16 a[64:67], a[196:199], v[208:211], a[64:67]
    v_cvt_pk_bf16_f32 v226, v144, v145
    v_mfma_f32_16x16x32_bf16 a[68:71], a[196:199], v[212:215], a[68:71]
    v_exp_f32 v146, v146
    v_mfma_f32_16x16x32_bf16 a[68:71], a[192:195], v[196:199], a[68:71]
    ds_read_b128 a[144:147], v1 offset:53248
    s_add_u32 m0, s26, 16384
    v_mfma_f32_16x16x32_bf16 a[72:75], a[192:195], v[200:203], a[72:75]
    v_exp_f32 v147, v147
    v_mfma_f32_16x16x32_bf16 a[72:75], a[196:199], v[216:219], a[72:75]
    buffer_load_dwordx4 v13, s[4:7], s24 offen offset:0 nt lds
    v_cvt_pk_bf16_f32 v227, v146, v147
    v_mfma_f32_16x16x32_bf16 a[76:79], a[196:199], v[220:223], a[76:79]
    v_exp_f32 v148, v148
    v_mfma_f32_16x16x32_bf16 a[76:79], a[192:195], v[204:207], a[76:79]
    v_mfma_f32_16x16x32_bf16 a[92:95], a[200:203], v[204:207], a[92:95]
    v_exp_f32 v149, v149
    v_mfma_f32_16x16x32_bf16 a[92:95], a[204:207], v[220:223], a[92:95]
    v_cvt_pk_bf16_f32 v230, v148, v149
    v_mfma_f32_16x16x32_bf16 a[88:91], a[204:207], v[216:219], a[88:91]
    v_exp_f32 v150, v150
    v_mfma_f32_16x16x32_bf16 a[88:91], a[200:203], v[200:203], a[88:91]
    ds_read_b128 a[148:151], v2 offset:53248
    v_mfma_f32_16x16x32_bf16 a[84:87], a[200:203], v[196:199], a[84:87]
    v_exp_f32 v151, v151
    v_mfma_f32_16x16x32_bf16 a[84:87], a[204:207], v[212:215], a[84:87]
    buffer_load_dwordx4 v14, s[4:7], s24 offen offset:1024 nt lds
    v_cvt_pk_bf16_f32 v231, v150, v151
    v_mfma_f32_16x16x32_bf16 a[80:83], a[204:207], v[208:211], a[80:83]
    v_exp_f32 v152, v152
    v_mfma_f32_16x16x32_bf16 a[80:83], a[200:203], v[192:195], a[80:83]
    v_mfma_f32_16x16x32_bf16 a[96:99], a[208:211], v[192:195], a[96:99]
    v_exp_f32 v153, v153
    v_mfma_f32_16x16x32_bf16 a[96:99], a[212:215], v[208:211], a[96:99]
    v_cvt_pk_bf16_f32 v234, v152, v153
    v_mfma_f32_16x16x32_bf16 a[100:103], a[212:215], v[212:215], a[100:103]
    v_exp_f32 v154, v154
    v_mfma_f32_16x16x32_bf16 a[100:103], a[208:211], v[196:199], a[100:103]
    ds_read_b128 a[152:155], v3 offset:53248
    v_mfma_f32_16x16x32_bf16 a[104:107], a[208:211], v[200:203], a[104:107]
    v_exp_f32 v155, v155
    v_mfma_f32_16x16x32_bf16 a[104:107], a[212:215], v[216:219], a[104:107]
    buffer_load_dwordx4 v15, s[4:7], s24 offen offset:2048 nt lds
    v_cvt_pk_bf16_f32 v235, v154, v155
    v_mfma_f32_16x16x32_bf16 a[108:111], a[212:215], v[220:223], a[108:111]
    v_exp_f32 v156, v156
    v_mfma_f32_16x16x32_bf16 a[108:111], a[208:211], v[204:207], a[108:111]
    v_mfma_f32_16x16x32_bf16 a[124:127], a[216:219], v[204:207], a[124:127]
    v_exp_f32 v157, v157
    v_mfma_f32_16x16x32_bf16 a[124:127], a[220:223], v[220:223], a[124:127]
    v_cvt_pk_bf16_f32 v238, v156, v157
    v_mfma_f32_16x16x32_bf16 a[120:123], a[220:223], v[216:219], a[120:123]
    v_exp_f32 v158, v158
    v_mfma_f32_16x16x32_bf16 a[120:123], a[216:219], v[200:203], a[120:123]
    ds_read_b128 a[156:159], v4 offset:53248
    v_mfma_f32_16x16x32_bf16 a[116:119], a[216:219], v[196:199], a[116:119]
    v_exp_f32 v159, v159
    v_mfma_f32_16x16x32_bf16 a[116:119], a[220:223], v[212:215], a[116:119]
    buffer_load_dwordx4 v16, s[4:7], s24 offen offset:3072 nt lds
    v_cvt_pk_bf16_f32 v239, v158, v159
    v_mfma_f32_16x16x32_bf16 a[112:115], a[220:223], v[208:211], a[112:115]
    v_exp_f32 v160, v160
    v_mfma_f32_16x16x32_bf16 a[112:115], a[216:219], v[192:195], a[112:115]
    s_add_u32 s24, s24, 16384
    v_mfma_f32_16x16x32_bf16 a[224:227], a[240:243], v[192:195], a[224:227]
    v_exp_f32 v161, v161
    v_mfma_f32_16x16x32_bf16 a[224:227], a[240:243], v[208:211], a[224:227]
    v_cvt_pk_bf16_f32 v240, v160, v161
    v_mfma_f32_16x16x32_bf16 a[228:231], a[240:243], v[212:215], a[228:231]
    v_exp_f32 v162, v162
    v_mfma_f32_16x16x32_bf16 a[228:231], a[240:243], v[196:199], a[228:231]
    s_waitcnt vmcnt(10) lgkmcnt(4)
    v_mfma_f32_16x16x32_bf16 a[232:235], a[240:243], v[200:203], a[232:235]
    v_exp_f32 v163, v163
    v_mfma_f32_16x16x32_bf16 a[232:235], a[240:243], v[216:219], a[232:235]
    v_cvt_pk_bf16_f32 v241, v162, v163
    v_mfma_f32_16x16x32_bf16 a[236:239], a[240:243], v[220:223], a[236:239]
    v_exp_f32 v164, v164
    v_mfma_f32_16x16x32_bf16 a[236:239], a[240:243], v[204:207], a[236:239]
    s_barrier
    v_mfma_f32_16x16x32_bf16 v[128:131], a[128:131], v[32:35], v[24:27]
    v_exp_f32 v165, v165
    v_mfma_f32_16x16x32_bf16 v[128:131], a[132:135], v[36:39], v[128:131]
    ds_read_b64_tr_b16 a[160:161], v5 offset:32768
    v_cvt_pk_bf16_f32 v244, v164, v165
    v_mfma_f32_16x16x32_bf16 v[128:131], a[136:139], v[40:43], v[128:131]
    v_exp_f32 v166, v166
    v_mfma_f32_16x16x32_bf16 v[128:131], a[140:143], v[44:47], v[128:131]
    ds_read_b64_tr_b16 a[162:163], v5 offset:36864
    ds_read_b64_tr_b16 a[164:165], v5 offset:40960
    v_mfma_f32_16x16x32_bf16 v[132:135], a[140:143], v[60:63], v[28:31]
    v_exp_f32 v167, v167
    v_mfma_f32_16x16x32_bf16 v[132:135], a[136:139], v[56:59], v[132:135]
    ds_read_b64_tr_b16 a[166:167], v5 offset:45056
    v_cvt_pk_bf16_f32 v245, v166, v167
    v_mfma_f32_16x16x32_bf16 v[132:135], a[132:135], v[52:55], v[132:135]
    v_exp_f32 v168, v168
    v_mfma_f32_16x16x32_bf16 v[132:135], a[128:131], v[48:51], v[132:135]
    ds_read_b64_tr_b16 a[168:169], v6 offset:32768
    ds_read_b64_tr_b16 a[170:171], v6 offset:36864
    v_mfma_f32_16x16x32_bf16 v[136:139], a[128:131], v[64:67], v[20:23]
    v_exp_f32 v169, v169
    v_mfma_f32_16x16x32_bf16 v[136:139], a[132:135], v[68:71], v[136:139]
    ds_read_b64_tr_b16 a[172:173], v6 offset:40960
    v_cvt_pk_bf16_f32 v248, v168, v169
    v_mfma_f32_16x16x32_bf16 v[136:139], a[136:139], v[72:75], v[136:139]
    v_exp_f32 v170, v170
    v_mfma_f32_16x16x32_bf16 v[136:139], a[140:143], v[76:79], v[136:139]
    ds_read_b64_tr_b16 a[174:175], v6 offset:45056
    ds_read_b64_tr_b16 a[176:177], v7 offset:32768
    v_mfma_f32_16x16x32_bf16 v[140:143], a[140:143], v[92:95], v[124:127]
    v_exp_f32 v171, v171
    v_mfma_f32_16x16x32_bf16 v[140:143], a[136:139], v[88:91], v[140:143]
    ds_read_b64_tr_b16 a[178:179], v7 offset:36864
    v_cvt_pk_bf16_f32 v249, v170, v171
    v_mfma_f32_16x16x32_bf16 v[140:143], a[132:135], v[84:87], v[140:143]
    v_exp_f32 v172, v172
    v_mfma_f32_16x16x32_bf16 v[140:143], a[128:131], v[80:83], v[140:143]
    s_waitcnt lgkmcnt(10)
    ds_read_b64_tr_b16 a[180:181], v7 offset:40960
    v_mfma_f32_16x16x32_bf16 v[144:147], a[144:147], v[32:35], v[24:27]
    v_exp_f32 v173, v173
    v_mfma_f32_16x16x32_bf16 v[144:147], a[148:151], v[36:39], v[144:147]
    ds_read_b128 a[128:131], v1 offset:57344
    v_cvt_pk_bf16_f32 v252, v172, v173
    v_mfma_f32_16x16x32_bf16 v[144:147], a[152:155], v[40:43], v[144:147]
    v_exp_f32 v174, v174
    v_mfma_f32_16x16x32_bf16 v[144:147], a[156:159], v[44:47], v[144:147]
    ds_read_b128 a[132:135], v2 offset:57344
    ds_read_b128 a[136:139], v3 offset:57344
    v_mfma_f32_16x16x32_bf16 v[148:151], a[156:159], v[60:63], v[28:31]
    v_exp_f32 v175, v175
    v_mfma_f32_16x16x32_bf16 v[148:151], a[152:155], v[56:59], v[148:151]
    ds_read_b128 a[140:143], v4 offset:57344
    v_cvt_pk_bf16_f32 v253, v174, v175
    v_mfma_f32_16x16x32_bf16 v[148:151], a[148:151], v[52:55], v[148:151]
    v_exp_f32 v176, v176
    v_mfma_f32_16x16x32_bf16 v[148:151], a[144:147], v[48:51], v[148:151]
    ds_read_b64_tr_b16 a[182:183], v7 offset:45056
    ds_read_b64_tr_b16 a[184:185], v8 offset:32768
    v_mfma_f32_16x16x32_bf16 v[152:155], a[144:147], v[64:67], v[20:23]
    v_exp_f32 v177, v177
    v_mfma_f32_16x16x32_bf16 v[152:155], a[148:151], v[68:71], v[152:155]
    ds_read_b64_tr_b16 a[186:187], v8 offset:36864
    v_cvt_pk_bf16_f32 v242, v176, v177
    v_mfma_f32_16x16x32_bf16 v[152:155], a[152:155], v[72:75], v[152:155]
    v_exp_f32 v178, v178
    v_mfma_f32_16x16x32_bf16 v[152:155], a[156:159], v[76:79], v[152:155]
    ds_read_b64_tr_b16 a[188:189], v8 offset:40960
    v_mfma_f32_16x16x32_bf16 v[156:159], a[156:159], v[92:95], v[124:127]
    v_exp_f32 v179, v179
    v_mfma_f32_16x16x32_bf16 v[156:159], a[152:155], v[88:91], v[156:159]
    ds_read_b64_tr_b16 a[190:191], v8 offset:45056
    v_cvt_pk_bf16_f32 v243, v178, v179
    v_mfma_f32_16x16x32_bf16 v[156:159], a[148:151], v[84:87], v[156:159]
    v_exp_f32 v180, v180
    v_mfma_f32_16x16x32_bf16 v[156:159], a[144:147], v[80:83], v[156:159]
    ds_read_b64_tr_b16 a[192:193], v9 offset:32768
    s_waitcnt lgkmcnt(6)
    v_mfma_f32_16x16x32_bf16 v[160:163], a[128:131], v[32:35], v[24:27]
    v_exp_f32 v181, v181
    v_mfma_f32_16x16x32_bf16 v[160:163], a[132:135], v[36:39], v[160:163]
    ds_read_b128 a[144:147], v1 offset:61440
    v_cvt_pk_bf16_f32 v246, v180, v181
    v_mfma_f32_16x16x32_bf16 v[160:163], a[136:139], v[40:43], v[160:163]
    v_exp_f32 v182, v182
    v_mfma_f32_16x16x32_bf16 v[160:163], a[140:143], v[44:47], v[160:163]
    ds_read_b128 a[148:151], v2 offset:61440
    ds_read_b128 a[152:155], v3 offset:61440
    v_mfma_f32_16x16x32_bf16 v[164:167], a[140:143], v[60:63], v[28:31]
    v_exp_f32 v183, v183
    v_mfma_f32_16x16x32_bf16 v[164:167], a[136:139], v[56:59], v[164:167]
    ds_read_b128 a[156:159], v4 offset:61440
    v_cvt_pk_bf16_f32 v247, v182, v183
    v_mfma_f32_16x16x32_bf16 v[164:167], a[132:135], v[52:55], v[164:167]
    v_exp_f32 v184, v184
    v_mfma_f32_16x16x32_bf16 v[164:167], a[128:131], v[48:51], v[164:167]
    ds_read_b64_tr_b16 a[194:195], v9 offset:36864
    ds_read_b64_tr_b16 a[196:197], v9 offset:40960
    v_mfma_f32_16x16x32_bf16 v[168:171], a[128:131], v[64:67], v[20:23]
    v_exp_f32 v185, v185
    v_mfma_f32_16x16x32_bf16 v[168:171], a[132:135], v[68:71], v[168:171]
    ds_read_b64_tr_b16 a[198:199], v9 offset:45056
    v_cvt_pk_bf16_f32 v250, v184, v185
    v_mfma_f32_16x16x32_bf16 v[168:171], a[136:139], v[72:75], v[168:171]
    v_exp_f32 v186, v186
    v_mfma_f32_16x16x32_bf16 v[168:171], a[140:143], v[76:79], v[168:171]
    ds_read_b64_tr_b16 a[200:201], v10 offset:32768
    ds_read_b64_tr_b16 a[202:203], v10 offset:36864
    v_mfma_f32_16x16x32_bf16 v[172:175], a[140:143], v[92:95], v[124:127]
    v_exp_f32 v187, v187
    v_mfma_f32_16x16x32_bf16 v[172:175], a[136:139], v[88:91], v[172:175]
    ds_read_b64_tr_b16 a[204:205], v10 offset:40960
    v_cvt_pk_bf16_f32 v251, v186, v187
    v_mfma_f32_16x16x32_bf16 v[172:175], a[132:135], v[84:87], v[172:175]
    v_exp_f32 v188, v188
    v_mfma_f32_16x16x32_bf16 v[172:175], a[128:131], v[80:83], v[172:175]
    ds_read_b64_tr_b16 a[206:207], v10 offset:45056
    s_waitcnt lgkmcnt(7)
    v_mfma_f32_16x16x32_bf16 v[176:179], a[144:147], v[32:35], v[24:27]
    v_exp_f32 v189, v189
    v_mfma_f32_16x16x32_bf16 v[176:179], a[148:151], v[36:39], v[176:179]
    ds_read_b64_tr_b16 a[208:209], v11 offset:32768
    v_cvt_pk_bf16_f32 v254, v188, v189
    v_mfma_f32_16x16x32_bf16 v[176:179], a[152:155], v[40:43], v[176:179]
    v_exp_f32 v190, v190
    v_mfma_f32_16x16x32_bf16 v[176:179], a[156:159], v[44:47], v[176:179]
    ds_read_b64_tr_b16 a[210:211], v11 offset:36864
    v_mfma_f32_16x16x32_bf16 v[180:183], a[156:159], v[60:63], v[28:31]
    v_exp_f32 v191, v191
    v_mfma_f32_16x16x32_bf16 v[180:183], a[152:155], v[56:59], v[180:183]
    ds_read_b64_tr_b16 a[212:213], v11 offset:40960
    v_cvt_pk_bf16_f32 v255, v190, v191
    v_mfma_f32_16x16x32_bf16 v[180:183], a[148:151], v[52:55], v[180:183]
    v_mfma_f32_16x16x32_bf16 v[180:183], a[144:147], v[48:51], v[180:183]
    ds_read_b64_tr_b16 a[214:215], v11 offset:45056
    v_mfma_f32_16x16x32_bf16 v[184:187], a[144:147], v[64:67], v[20:23]
    buffer_load_dword v112, v103, s[16:19], s31 offen offset:1024
    v_mfma_f32_16x16x32_bf16 v[184:187], a[148:151], v[68:71], v[184:187]
    ds_read_b64_tr_b16 a[216:217], v12 offset:32768
    v_mfma_f32_16x16x32_bf16 v[184:187], a[152:155], v[72:75], v[184:187]
    v_mfma_f32_16x16x32_bf16 v[184:187], a[156:159], v[76:79], v[184:187]
    ds_read_b64_tr_b16 a[218:219], v12 offset:36864
    v_mfma_f32_16x16x32_bf16 v[188:191], a[156:159], v[92:95], v[124:127]
    v_mfma_f32_16x16x32_bf16 v[188:191], a[152:155], v[88:91], v[188:191]
    ds_read_b64_tr_b16 a[220:221], v12 offset:40960
    v_mfma_f32_16x16x32_bf16 v[188:191], a[148:151], v[84:87], v[188:191]
    v_exp_f32 v128, v128
    v_mfma_f32_16x16x32_bf16 v[188:191], a[144:147], v[80:83], v[188:191]
    ds_read_b64_tr_b16 a[222:223], v12 offset:45056
    v_mfma_f32_16x16x32_bf16 a[0:3], a[160:163], v[224:227], a[0:3]
    v_exp_f32 v129, v129
    v_mfma_f32_16x16x32_bf16 a[0:3], a[164:167], v[240:243], a[0:3]
    v_cvt_pk_bf16_f32 v192, v128, v129
    v_mfma_f32_16x16x32_bf16 a[4:7], a[164:167], v[244:247], a[4:7]
    v_exp_f32 v130, v130
    v_mfma_f32_16x16x32_bf16 a[4:7], a[160:163], v[228:231], a[4:7]
    ds_read_b128 a[128:131], v1 offset:0
    s_add_u32 m0, s26, 65536
    v_mfma_f32_16x16x32_bf16 a[8:11], a[160:163], v[232:235], a[8:11]
    v_exp_f32 v131, v131
    v_mfma_f32_16x16x32_bf16 a[8:11], a[164:167], v[248:251], a[8:11]
    buffer_load_dwordx4 v17, s[8:11], s25 offen offset:0 nt lds
    v_cvt_pk_bf16_f32 v193, v130, v131
    v_mfma_f32_16x16x32_bf16 a[12:15], a[164:167], v[252:255], a[12:15]
    v_exp_f32 v132, v132
    v_mfma_f32_16x16x32_bf16 a[12:15], a[160:163], v[236:239], a[12:15]
    v_mfma_f32_16x16x32_bf16 a[28:31], a[168:171], v[236:239], a[28:31]
    v_exp_f32 v133, v133
    v_mfma_f32_16x16x32_bf16 a[28:31], a[172:175], v[252:255], a[28:31]
    v_cvt_pk_bf16_f32 v196, v132, v133
    v_mfma_f32_16x16x32_bf16 a[24:27], a[172:175], v[248:251], a[24:27]
    v_exp_f32 v134, v134
    v_mfma_f32_16x16x32_bf16 a[24:27], a[168:171], v[232:235], a[24:27]
    ds_read_b128 a[132:135], v2 offset:0
    v_mfma_f32_16x16x32_bf16 a[20:23], a[168:171], v[228:231], a[20:23]
    v_exp_f32 v135, v135
    v_mfma_f32_16x16x32_bf16 a[20:23], a[172:175], v[244:247], a[20:23]
    buffer_load_dwordx4 v18, s[8:11], s25 offen offset:1024 nt lds
    v_cvt_pk_bf16_f32 v197, v134, v135
    v_mfma_f32_16x16x32_bf16 a[16:19], a[172:175], v[240:243], a[16:19]
    v_exp_f32 v136, v136
    v_mfma_f32_16x16x32_bf16 a[16:19], a[168:171], v[224:227], a[16:19]
    v_mfma_f32_16x16x32_bf16 a[32:35], a[176:179], v[224:227], a[32:35]
    v_exp_f32 v137, v137
    v_mfma_f32_16x16x32_bf16 a[32:35], a[180:183], v[240:243], a[32:35]
    v_cvt_pk_bf16_f32 v200, v136, v137
    v_mfma_f32_16x16x32_bf16 a[36:39], a[180:183], v[244:247], a[36:39]
    v_exp_f32 v138, v138
    v_mfma_f32_16x16x32_bf16 a[36:39], a[176:179], v[228:231], a[36:39]
    ds_read_b128 a[136:139], v3 offset:0
    v_mfma_f32_16x16x32_bf16 a[40:43], a[176:179], v[232:235], a[40:43]
    v_exp_f32 v139, v139
    v_mfma_f32_16x16x32_bf16 a[40:43], a[180:183], v[248:251], a[40:43]
    buffer_load_dwordx4 v17, s[8:11], s25 offen offset:2048 nt lds
    v_cvt_pk_bf16_f32 v201, v138, v139
    v_mfma_f32_16x16x32_bf16 a[44:47], a[180:183], v[252:255], a[44:47]
    v_exp_f32 v140, v140
    v_mfma_f32_16x16x32_bf16 a[44:47], a[176:179], v[236:239], a[44:47]
    v_mfma_f32_16x16x32_bf16 a[60:63], a[184:187], v[236:239], a[60:63]
    v_exp_f32 v141, v141
    v_mfma_f32_16x16x32_bf16 a[60:63], a[188:191], v[252:255], a[60:63]
    v_cvt_pk_bf16_f32 v204, v140, v141
    v_mfma_f32_16x16x32_bf16 a[56:59], a[188:191], v[248:251], a[56:59]
    v_exp_f32 v142, v142
    v_mfma_f32_16x16x32_bf16 a[56:59], a[184:187], v[232:235], a[56:59]
    ds_read_b128 a[140:143], v4 offset:0
    s_waitcnt lgkmcnt(4)
    v_mfma_f32_16x16x32_bf16 a[52:55], a[184:187], v[228:231], a[52:55]
    v_exp_f32 v143, v143
    v_mfma_f32_16x16x32_bf16 a[52:55], a[188:191], v[244:247], a[52:55]
    buffer_load_dwordx4 v18, s[8:11], s25 offen offset:3072 nt lds
    v_cvt_pk_bf16_f32 v205, v142, v143
    v_mfma_f32_16x16x32_bf16 a[48:51], a[188:191], v[240:243], a[48:51]
    v_exp_f32 v144, v144
    v_mfma_f32_16x16x32_bf16 a[48:51], a[184:187], v[224:227], a[48:51]
    s_add_u32 s25, s25, 16384
    v_mfma_f32_16x16x32_bf16 a[64:67], a[192:195], v[224:227], a[64:67]
    v_exp_f32 v145, v145
    v_mfma_f32_16x16x32_bf16 a[64:67], a[196:199], v[240:243], a[64:67]
    v_cvt_pk_bf16_f32 v194, v144, v145
    v_mfma_f32_16x16x32_bf16 a[68:71], a[196:199], v[244:247], a[68:71]
    v_exp_f32 v146, v146
    v_mfma_f32_16x16x32_bf16 a[68:71], a[192:195], v[228:231], a[68:71]
    ds_read_b128 a[144:147], v1 offset:4096
    s_add_u32 m0, s26, 32768
    v_mfma_f32_16x16x32_bf16 a[72:75], a[192:195], v[232:235], a[72:75]
    v_exp_f32 v147, v147
    v_mfma_f32_16x16x32_bf16 a[72:75], a[196:199], v[248:251], a[72:75]
    buffer_load_dwordx4 v13, s[4:7], s24 offen offset:0 nt lds
    v_cvt_pk_bf16_f32 v195, v146, v147
    v_mfma_f32_16x16x32_bf16 a[76:79], a[196:199], v[252:255], a[76:79]
    v_exp_f32 v148, v148
    v_mfma_f32_16x16x32_bf16 a[76:79], a[192:195], v[236:239], a[76:79]
    v_mfma_f32_16x16x32_bf16 a[92:95], a[200:203], v[236:239], a[92:95]
    v_exp_f32 v149, v149
    v_mfma_f32_16x16x32_bf16 a[92:95], a[204:207], v[252:255], a[92:95]
    v_cvt_pk_bf16_f32 v198, v148, v149
    v_mfma_f32_16x16x32_bf16 a[88:91], a[204:207], v[248:251], a[88:91]
    v_exp_f32 v150, v150
    v_mfma_f32_16x16x32_bf16 a[88:91], a[200:203], v[232:235], a[88:91]
    ds_read_b128 a[148:151], v2 offset:4096
    v_mfma_f32_16x16x32_bf16 a[84:87], a[200:203], v[228:231], a[84:87]
    v_exp_f32 v151, v151
    v_mfma_f32_16x16x32_bf16 a[84:87], a[204:207], v[244:247], a[84:87]
    buffer_load_dwordx4 v14, s[4:7], s24 offen offset:1024 nt lds
    v_cvt_pk_bf16_f32 v199, v150, v151
    v_mfma_f32_16x16x32_bf16 a[80:83], a[204:207], v[240:243], a[80:83]
    v_exp_f32 v152, v152
    v_mfma_f32_16x16x32_bf16 a[80:83], a[200:203], v[224:227], a[80:83]
    v_mfma_f32_16x16x32_bf16 a[96:99], a[208:211], v[224:227], a[96:99]
    v_exp_f32 v153, v153
    v_mfma_f32_16x16x32_bf16 a[96:99], a[212:215], v[240:243], a[96:99]
    v_cvt_pk_bf16_f32 v202, v152, v153
    v_mfma_f32_16x16x32_bf16 a[100:103], a[212:215], v[244:247], a[100:103]
    v_exp_f32 v154, v154
    v_mfma_f32_16x16x32_bf16 a[100:103], a[208:211], v[228:231], a[100:103]
    ds_read_b128 a[152:155], v3 offset:4096
    v_mfma_f32_16x16x32_bf16 a[104:107], a[208:211], v[232:235], a[104:107]
    v_exp_f32 v155, v155
    v_mfma_f32_16x16x32_bf16 a[104:107], a[212:215], v[248:251], a[104:107]
    buffer_load_dwordx4 v15, s[4:7], s24 offen offset:2048 nt lds
    v_cvt_pk_bf16_f32 v203, v154, v155
    v_mfma_f32_16x16x32_bf16 a[108:111], a[212:215], v[252:255], a[108:111]
    v_exp_f32 v156, v156
    v_mfma_f32_16x16x32_bf16 a[108:111], a[208:211], v[236:239], a[108:111]
    v_mfma_f32_16x16x32_bf16 a[124:127], a[216:219], v[236:239], a[124:127]
    v_exp_f32 v157, v157
    v_mfma_f32_16x16x32_bf16 a[124:127], a[220:223], v[252:255], a[124:127]
    v_cvt_pk_bf16_f32 v206, v156, v157
    v_mfma_f32_16x16x32_bf16 a[120:123], a[220:223], v[248:251], a[120:123]
    v_exp_f32 v158, v158
    v_mfma_f32_16x16x32_bf16 a[120:123], a[216:219], v[232:235], a[120:123]
    ds_read_b128 a[156:159], v4 offset:4096
    v_mfma_f32_16x16x32_bf16 a[116:119], a[216:219], v[228:231], a[116:119]
    v_exp_f32 v159, v159
    v_mfma_f32_16x16x32_bf16 a[116:119], a[220:223], v[244:247], a[116:119]
    buffer_load_dwordx4 v16, s[4:7], s24 offen offset:3072 nt lds
    v_cvt_pk_bf16_f32 v207, v158, v159
    v_mfma_f32_16x16x32_bf16 a[112:115], a[220:223], v[240:243], a[112:115]
    v_exp_f32 v160, v160
    v_mfma_f32_16x16x32_bf16 a[112:115], a[216:219], v[224:227], a[112:115]
    s_add_u32 s24, s24, 16384
    v_mfma_f32_16x16x32_bf16 a[224:227], a[240:243], v[224:227], a[224:227]
    v_exp_f32 v161, v161
    v_mfma_f32_16x16x32_bf16 a[224:227], a[240:243], v[240:243], a[224:227]
    v_cvt_pk_bf16_f32 v208, v160, v161
    v_mfma_f32_16x16x32_bf16 a[228:231], a[240:243], v[244:247], a[228:231]
    v_exp_f32 v162, v162
    v_mfma_f32_16x16x32_bf16 a[228:231], a[240:243], v[228:231], a[228:231]
    s_waitcnt vmcnt(9) lgkmcnt(4)
    v_mfma_f32_16x16x32_bf16 a[232:235], a[240:243], v[232:235], a[232:235]
    v_exp_f32 v163, v163
    v_mfma_f32_16x16x32_bf16 a[232:235], a[240:243], v[248:251], a[232:235]
    v_cvt_pk_bf16_f32 v209, v162, v163
    v_mfma_f32_16x16x32_bf16 a[236:239], a[240:243], v[252:255], a[236:239]
    v_exp_f32 v164, v164
    v_mfma_f32_16x16x32_bf16 a[236:239], a[240:243], v[236:239], a[236:239]
    s_barrier
    v_mfma_f32_16x16x32_bf16 v[128:131], a[128:131], v[32:35], v[24:27]
    v_exp_f32 v165, v165
    v_mfma_f32_16x16x32_bf16 v[128:131], a[132:135], v[36:39], v[128:131]
    ds_read_b64_tr_b16 a[160:161], v5 offset:49152
    v_cvt_pk_bf16_f32 v212, v164, v165
    v_mfma_f32_16x16x32_bf16 v[128:131], a[136:139], v[40:43], v[128:131]
    v_exp_f32 v166, v166
    v_mfma_f32_16x16x32_bf16 v[128:131], a[140:143], v[44:47], v[128:131]
    ds_read_b64_tr_b16 a[162:163], v5 offset:53248
    ds_read_b64_tr_b16 a[164:165], v5 offset:57344
    v_mfma_f32_16x16x32_bf16 v[132:135], a[140:143], v[60:63], v[28:31]
    v_exp_f32 v167, v167
    v_mfma_f32_16x16x32_bf16 v[132:135], a[136:139], v[56:59], v[132:135]
    ds_read_b64_tr_b16 a[166:167], v5 offset:61440
    v_cvt_pk_bf16_f32 v213, v166, v167
    v_mfma_f32_16x16x32_bf16 v[132:135], a[132:135], v[52:55], v[132:135]
    v_exp_f32 v168, v168
    v_mfma_f32_16x16x32_bf16 v[132:135], a[128:131], v[48:51], v[132:135]
    ds_read_b64_tr_b16 a[168:169], v6 offset:49152
    ds_read_b64_tr_b16 a[170:171], v6 offset:53248
    v_mfma_f32_16x16x32_bf16 v[136:139], a[128:131], v[64:67], v[20:23]
    v_exp_f32 v169, v169
    v_mfma_f32_16x16x32_bf16 v[136:139], a[132:135], v[68:71], v[136:139]
    ds_read_b64_tr_b16 a[172:173], v6 offset:57344
    v_cvt_pk_bf16_f32 v216, v168, v169
    v_mfma_f32_16x16x32_bf16 v[136:139], a[136:139], v[72:75], v[136:139]
    v_exp_f32 v170, v170
    v_mfma_f32_16x16x32_bf16 v[136:139], a[140:143], v[76:79], v[136:139]
    ds_read_b64_tr_b16 a[174:175], v6 offset:61440
    ds_read_b64_tr_b16 a[176:177], v7 offset:49152
    v_mfma_f32_16x16x32_bf16 v[140:143], a[140:143], v[92:95], v[124:127]
    v_exp_f32 v171, v171
    v_mfma_f32_16x16x32_bf16 v[140:143], a[136:139], v[88:91], v[140:143]
    ds_read_b64_tr_b16 a[178:179], v7 offset:53248
    v_cvt_pk_bf16_f32 v217, v170, v171
    v_mfma_f32_16x16x32_bf16 v[140:143], a[132:135], v[84:87], v[140:143]
    v_exp_f32 v172, v172
    v_mfma_f32_16x16x32_bf16 v[140:143], a[128:131], v[80:83], v[140:143]
    s_waitcnt lgkmcnt(10)
    ds_read_b64_tr_b16 a[180:181], v7 offset:57344
    v_mfma_f32_16x16x32_bf16 v[144:147], a[144:147], v[32:35], v[24:27]
    v_exp_f32 v173, v173
    v_mfma_f32_16x16x32_bf16 v[144:147], a[148:151], v[36:39], v[144:147]
    ds_read_b128 a[128:131], v1 offset:8192
    v_cvt_pk_bf16_f32 v220, v172, v173
    v_mfma_f32_16x16x32_bf16 v[144:147], a[152:155], v[40:43], v[144:147]
    v_exp_f32 v174, v174
    v_mfma_f32_16x16x32_bf16 v[144:147], a[156:159], v[44:47], v[144:147]
    ds_read_b128 a[132:135], v2 offset:8192
    ds_read_b128 a[136:139], v3 offset:8192
    v_mfma_f32_16x16x32_bf16 v[148:151], a[156:159], v[60:63], v[28:31]
    v_exp_f32 v175, v175
    v_mfma_f32_16x16x32_bf16 v[148:151], a[152:155], v[56:59], v[148:151]
    ds_read_b128 a[140:143], v4 offset:8192
    v_cvt_pk_bf16_f32 v221, v174, v175
    v_mfma_f32_16x16x32_bf16 v[148:151], a[148:151], v[52:55], v[148:151]
    v_exp_f32 v176, v176
    v_mfma_f32_16x16x32_bf16 v[148:151], a[144:147], v[48:51], v[148:151]
    ds_read_b64_tr_b16 a[182:183], v7 offset:61440
    ds_read_b64_tr_b16 a[184:185], v8 offset:49152
    v_mfma_f32_16x16x32_bf16 v[152:155], a[144:147], v[64:67], v[20:23]
    v_exp_f32 v177, v177
    v_mfma_f32_16x16x32_bf16 v[152:155], a[148:151], v[68:71], v[152:155]
    ds_read_b64_tr_b16 a[186:187], v8 offset:53248
    v_cvt_pk_bf16_f32 v210, v176, v177
    v_mfma_f32_16x16x32_bf16 v[152:155], a[152:155], v[72:75], v[152:155]
    v_exp_f32 v178, v178
    v_mfma_f32_16x16x32_bf16 v[152:155], a[156:159], v[76:79], v[152:155]
    ds_read_b64_tr_b16 a[188:189], v8 offset:57344
    v_mfma_f32_16x16x32_bf16 v[156:159], a[156:159], v[92:95], v[124:127]
    v_exp_f32 v179, v179
    v_mfma_f32_16x16x32_bf16 v[156:159], a[152:155], v[88:91], v[156:159]
    ds_read_b64_tr_b16 a[190:191], v8 offset:61440
    v_cvt_pk_bf16_f32 v211, v178, v179
    v_mfma_f32_16x16x32_bf16 v[156:159], a[148:151], v[84:87], v[156:159]
    v_exp_f32 v180, v180
    v_mfma_f32_16x16x32_bf16 v[156:159], a[144:147], v[80:83], v[156:159]
    ds_read_b64_tr_b16 a[192:193], v9 offset:49152
    s_waitcnt lgkmcnt(6)
    v_mfma_f32_16x16x32_bf16 v[160:163], a[128:131], v[32:35], v[24:27]
    v_exp_f32 v181, v181
    v_mfma_f32_16x16x32_bf16 v[160:163], a[132:135], v[36:39], v[160:163]
    ds_read_b128 a[144:147], v1 offset:12288
    v_cvt_pk_bf16_f32 v214, v180, v181
    v_mfma_f32_16x16x32_bf16 v[160:163], a[136:139], v[40:43], v[160:163]
    v_exp_f32 v182, v182
    v_mfma_f32_16x16x32_bf16 v[160:163], a[140:143], v[44:47], v[160:163]
    ds_read_b128 a[148:151], v2 offset:12288
    ds_read_b128 a[152:155], v3 offset:12288
    v_mfma_f32_16x16x32_bf16 v[164:167], a[140:143], v[60:63], v[28:31]
    v_exp_f32 v183, v183
    v_mfma_f32_16x16x32_bf16 v[164:167], a[136:139], v[56:59], v[164:167]
    ds_read_b128 a[156:159], v4 offset:12288
    v_cvt_pk_bf16_f32 v215, v182, v183
    v_mfma_f32_16x16x32_bf16 v[164:167], a[132:135], v[52:55], v[164:167]
    v_exp_f32 v184, v184
    v_mfma_f32_16x16x32_bf16 v[164:167], a[128:131], v[48:51], v[164:167]
    ds_read_b64_tr_b16 a[194:195], v9 offset:53248
    ds_read_b64_tr_b16 a[196:197], v9 offset:57344
    v_mfma_f32_16x16x32_bf16 v[168:171], a[128:131], v[64:67], v[20:23]
    v_exp_f32 v185, v185
    v_mfma_f32_16x16x32_bf16 v[168:171], a[132:135], v[68:71], v[168:171]
    ds_read_b64_tr_b16 a[198:199], v9 offset:61440
    v_cvt_pk_bf16_f32 v218, v184, v185
    v_mfma_f32_16x16x32_bf16 v[168:171], a[136:139], v[72:75], v[168:171]
    v_exp_f32 v186, v186
    v_mfma_f32_16x16x32_bf16 v[168:171], a[140:143], v[76:79], v[168:171]
    ds_read_b64_tr_b16 a[200:201], v10 offset:49152
    ds_read_b64_tr_b16 a[202:203], v10 offset:53248
    v_mfma_f32_16x16x32_bf16 v[172:175], a[140:143], v[92:95], v[124:127]
    v_exp_f32 v187, v187
    v_mfma_f32_16x16x32_bf16 v[172:175], a[136:139], v[88:91], v[172:175]
    ds_read_b64_tr_b16 a[204:205], v10 offset:57344
    v_cvt_pk_bf16_f32 v219, v186, v187
    v_mfma_f32_16x16x32_bf16 v[172:175], a[132:135], v[84:87], v[172:175]
    v_exp_f32 v188, v188
    v_mfma_f32_16x16x32_bf16 v[172:175], a[128:131], v[80:83], v[172:175]
    ds_read_b64_tr_b16 a[206:207], v10 offset:61440
    s_waitcnt lgkmcnt(7)
    v_mfma_f32_16x16x32_bf16 v[176:179], a[144:147], v[32:35], v[24:27]
    v_exp_f32 v189, v189
    v_mfma_f32_16x16x32_bf16 v[176:179], a[148:151], v[36:39], v[176:179]
    ds_read_b64_tr_b16 a[208:209], v11 offset:49152
    v_cvt_pk_bf16_f32 v222, v188, v189
    v_mfma_f32_16x16x32_bf16 v[176:179], a[152:155], v[40:43], v[176:179]
    v_exp_f32 v190, v190
    v_mfma_f32_16x16x32_bf16 v[176:179], a[156:159], v[44:47], v[176:179]
    ds_read_b64_tr_b16 a[210:211], v11 offset:53248
    v_mfma_f32_16x16x32_bf16 v[180:183], a[156:159], v[60:63], v[28:31]
    v_exp_f32 v191, v191
    v_mfma_f32_16x16x32_bf16 v[180:183], a[152:155], v[56:59], v[180:183]
    ds_read_b64_tr_b16 a[212:213], v11 offset:57344
    v_cvt_pk_bf16_f32 v223, v190, v191
    v_mfma_f32_16x16x32_bf16 v[180:183], a[148:151], v[52:55], v[180:183]
    v_mfma_f32_16x16x32_bf16 v[180:183], a[144:147], v[48:51], v[180:183]
    ds_read_b64_tr_b16 a[214:215], v11 offset:61440
    v_mfma_f32_16x16x32_bf16 v[184:187], a[144:147], v[64:67], v[20:23]
    buffer_load_dword v112, v103, s[16:19], s31 offen offset:2048
    v_mfma_f32_16x16x32_bf16 v[184:187], a[148:151], v[68:71], v[184:187]
    ds_read_b64_tr_b16 a[216:217], v12 offset:49152
    v_mfma_f32_16x16x32_bf16 v[184:187], a[152:155], v[72:75], v[184:187]
    v_mfma_f32_16x16x32_bf16 v[184:187], a[156:159], v[76:79], v[184:187]
    ds_read_b64_tr_b16 a[218:219], v12 offset:53248
    v_mfma_f32_16x16x32_bf16 v[188:191], a[156:159], v[92:95], v[124:127]
    v_mfma_f32_16x16x32_bf16 v[188:191], a[152:155], v[88:91], v[188:191]
    ds_read_b64_tr_b16 a[220:221], v12 offset:57344
    v_mfma_f32_16x16x32_bf16 v[188:191], a[148:151], v[84:87], v[188:191]
    v_exp_f32 v128, v128
    v_mfma_f32_16x16x32_bf16 v[188:191], a[144:147], v[80:83], v[188:191]
    ds_read_b64_tr_b16 a[222:223], v12 offset:61440
    v_mfma_f32_16x16x32_bf16 a[0:3], a[160:163], v[192:195], a[0:3]
    v_exp_f32 v129, v129
    v_mfma_f32_16x16x32_bf16 a[0:3], a[164:167], v[208:211], a[0:3]
    v_cvt_pk_bf16_f32 v224, v128, v129
    v_mfma_f32_16x16x32_bf16 a[4:7], a[164:167], v[212:215], a[4:7]
    v_exp_f32 v130, v130
    v_mfma_f32_16x16x32_bf16 a[4:7], a[160:163], v[196:199], a[4:7]
    ds_read_b128 a[128:131], v1 offset:16384
    s_add_u32 m0, s26, 81920
    v_mfma_f32_16x16x32_bf16 a[8:11], a[160:163], v[200:203], a[8:11]
    v_exp_f32 v131, v131
    v_mfma_f32_16x16x32_bf16 a[8:11], a[164:167], v[216:219], a[8:11]
    buffer_load_dwordx4 v17, s[8:11], s25 offen offset:0 nt lds
    v_cvt_pk_bf16_f32 v225, v130, v131
    v_mfma_f32_16x16x32_bf16 a[12:15], a[164:167], v[220:223], a[12:15]
    v_exp_f32 v132, v132
    v_mfma_f32_16x16x32_bf16 a[12:15], a[160:163], v[204:207], a[12:15]
    v_mfma_f32_16x16x32_bf16 a[28:31], a[168:171], v[204:207], a[28:31]
    v_exp_f32 v133, v133
    v_mfma_f32_16x16x32_bf16 a[28:31], a[172:175], v[220:223], a[28:31]
    v_cvt_pk_bf16_f32 v228, v132, v133
    v_mfma_f32_16x16x32_bf16 a[24:27], a[172:175], v[216:219], a[24:27]
    v_exp_f32 v134, v134
    v_mfma_f32_16x16x32_bf16 a[24:27], a[168:171], v[200:203], a[24:27]
    ds_read_b128 a[132:135], v2 offset:16384
    v_mfma_f32_16x16x32_bf16 a[20:23], a[168:171], v[196:199], a[20:23]
    v_exp_f32 v135, v135
    v_mfma_f32_16x16x32_bf16 a[20:23], a[172:175], v[212:215], a[20:23]
    buffer_load_dwordx4 v18, s[8:11], s25 offen offset:1024 nt lds
    v_cvt_pk_bf16_f32 v229, v134, v135
    v_mfma_f32_16x16x32_bf16 a[16:19], a[172:175], v[208:211], a[16:19]
    v_exp_f32 v136, v136
    v_mfma_f32_16x16x32_bf16 a[16:19], a[168:171], v[192:195], a[16:19]
    v_mfma_f32_16x16x32_bf16 a[32:35], a[176:179], v[192:195], a[32:35]
    v_exp_f32 v137, v137
    v_mfma_f32_16x16x32_bf16 a[32:35], a[180:183], v[208:211], a[32:35]
    v_cvt_pk_bf16_f32 v232, v136, v137
    v_mfma_f32_16x16x32_bf16 a[36:39], a[180:183], v[212:215], a[36:39]
    v_exp_f32 v138, v138
    v_mfma_f32_16x16x32_bf16 a[36:39], a[176:179], v[196:199], a[36:39]
    ds_read_b128 a[136:139], v3 offset:16384
    v_mfma_f32_16x16x32_bf16 a[40:43], a[176:179], v[200:203], a[40:43]
    v_exp_f32 v139, v139
    v_mfma_f32_16x16x32_bf16 a[40:43], a[180:183], v[216:219], a[40:43]
    buffer_load_dwordx4 v17, s[8:11], s25 offen offset:2048 nt lds
    v_cvt_pk_bf16_f32 v233, v138, v139
    v_mfma_f32_16x16x32_bf16 a[44:47], a[180:183], v[220:223], a[44:47]
    v_exp_f32 v140, v140
    v_mfma_f32_16x16x32_bf16 a[44:47], a[176:179], v[204:207], a[44:47]
    v_mfma_f32_16x16x32_bf16 a[60:63], a[184:187], v[204:207], a[60:63]
    v_exp_f32 v141, v141
    v_mfma_f32_16x16x32_bf16 a[60:63], a[188:191], v[220:223], a[60:63]
    v_cvt_pk_bf16_f32 v236, v140, v141
    v_mfma_f32_16x16x32_bf16 a[56:59], a[188:191], v[216:219], a[56:59]
    v_exp_f32 v142, v142
    v_mfma_f32_16x16x32_bf16 a[56:59], a[184:187], v[200:203], a[56:59]
    ds_read_b128 a[140:143], v4 offset:16384
    s_waitcnt lgkmcnt(4)
    v_mfma_f32_16x16x32_bf16 a[52:55], a[184:187], v[196:199], a[52:55]
    v_exp_f32 v143, v143
    v_mfma_f32_16x16x32_bf16 a[52:55], a[188:191], v[212:215], a[52:55]
    buffer_load_dwordx4 v18, s[8:11], s25 offen offset:3072 nt lds
    v_cvt_pk_bf16_f32 v237, v142, v143
    v_mfma_f32_16x16x32_bf16 a[48:51], a[188:191], v[208:211], a[48:51]
    v_exp_f32 v144, v144
    v_mfma_f32_16x16x32_bf16 a[48:51], a[184:187], v[192:195], a[48:51]
    s_add_u32 s25, s25, 16384
    v_mfma_f32_16x16x32_bf16 a[64:67], a[192:195], v[192:195], a[64:67]
    v_exp_f32 v145, v145
    v_mfma_f32_16x16x32_bf16 a[64:67], a[196:199], v[208:211], a[64:67]
    v_cvt_pk_bf16_f32 v226, v144, v145
    v_mfma_f32_16x16x32_bf16 a[68:71], a[196:199], v[212:215], a[68:71]
    v_exp_f32 v146, v146
    v_mfma_f32_16x16x32_bf16 a[68:71], a[192:195], v[196:199], a[68:71]
    ds_read_b128 a[144:147], v1 offset:20480
    s_add_u32 m0, s26, 49152
    v_mfma_f32_16x16x32_bf16 a[72:75], a[192:195], v[200:203], a[72:75]
    v_exp_f32 v147, v147
    v_mfma_f32_16x16x32_bf16 a[72:75], a[196:199], v[216:219], a[72:75]
    buffer_load_dwordx4 v13, s[4:7], s24 offen offset:0 nt lds
    v_cvt_pk_bf16_f32 v227, v146, v147
    v_mfma_f32_16x16x32_bf16 a[76:79], a[196:199], v[220:223], a[76:79]
    v_exp_f32 v148, v148
    v_mfma_f32_16x16x32_bf16 a[76:79], a[192:195], v[204:207], a[76:79]
    v_mfma_f32_16x16x32_bf16 a[92:95], a[200:203], v[204:207], a[92:95]
    v_exp_f32 v149, v149
    v_mfma_f32_16x16x32_bf16 a[92:95], a[204:207], v[220:223], a[92:95]
    v_cvt_pk_bf16_f32 v230, v148, v149
    v_mfma_f32_16x16x32_bf16 a[88:91], a[204:207], v[216:219], a[88:91]
    v_exp_f32 v150, v150
    v_mfma_f32_16x16x32_bf16 a[88:91], a[200:203], v[200:203], a[88:91]
    ds_read_b128 a[148:151], v2 offset:20480
    v_mfma_f32_16x16x32_bf16 a[84:87], a[200:203], v[196:199], a[84:87]
    v_exp_f32 v151, v151
    v_mfma_f32_16x16x32_bf16 a[84:87], a[204:207], v[212:215], a[84:87]
    buffer_load_dwordx4 v14, s[4:7], s24 offen offset:1024 nt lds
    v_cvt_pk_bf16_f32 v231, v150, v151
    v_mfma_f32_16x16x32_bf16 a[80:83], a[204:207], v[208:211], a[80:83]
    v_exp_f32 v152, v152
    v_mfma_f32_16x16x32_bf16 a[80:83], a[200:203], v[192:195], a[80:83]
    v_mfma_f32_16x16x32_bf16 a[96:99], a[208:211], v[192:195], a[96:99]
    v_exp_f32 v153, v153
    v_mfma_f32_16x16x32_bf16 a[96:99], a[212:215], v[208:211], a[96:99]
    v_cvt_pk_bf16_f32 v234, v152, v153
    v_mfma_f32_16x16x32_bf16 a[100:103], a[212:215], v[212:215], a[100:103]
    v_exp_f32 v154, v154
    v_mfma_f32_16x16x32_bf16 a[100:103], a[208:211], v[196:199], a[100:103]
    ds_read_b128 a[152:155], v3 offset:20480
    v_mfma_f32_16x16x32_bf16 a[104:107], a[208:211], v[200:203], a[104:107]
    v_exp_f32 v155, v155
    v_mfma_f32_16x16x32_bf16 a[104:107], a[212:215], v[216:219], a[104:107]
    buffer_load_dwordx4 v15, s[4:7], s24 offen offset:2048 nt lds
    v_cvt_pk_bf16_f32 v235, v154, v155
    v_mfma_f32_16x16x32_bf16 a[108:111], a[212:215], v[220:223], a[108:111]
    v_exp_f32 v156, v156
    v_mfma_f32_16x16x32_bf16 a[108:111], a[208:211], v[204:207], a[108:111]
    v_mfma_f32_16x16x32_bf16 a[124:127], a[216:219], v[204:207], a[124:127]
    v_exp_f32 v157, v157
    v_mfma_f32_16x16x32_bf16 a[124:127], a[220:223], v[220:223], a[124:127]
    v_cvt_pk_bf16_f32 v238, v156, v157
    v_mfma_f32_16x16x32_bf16 a[120:123], a[220:223], v[216:219], a[120:123]
    v_exp_f32 v158, v158
    v_mfma_f32_16x16x32_bf16 a[120:123], a[216:219], v[200:203], a[120:123]
    ds_read_b128 a[156:159], v4 offset:20480
    v_mfma_f32_16x16x32_bf16 a[116:119], a[216:219], v[196:199], a[116:119]
    v_exp_f32 v159, v159
    v_mfma_f32_16x16x32_bf16 a[116:119], a[220:223], v[212:215], a[116:119]
    buffer_load_dwordx4 v16, s[4:7], s24 offen offset:3072 nt lds
    v_cvt_pk_bf16_f32 v239, v158, v159
    v_mfma_f32_16x16x32_bf16 a[112:115], a[220:223], v[208:211], a[112:115]
    v_exp_f32 v160, v160
    v_mfma_f32_16x16x32_bf16 a[112:115], a[216:219], v[192:195], a[112:115]
    s_add_u32 s24, s24, 16384
    v_mfma_f32_16x16x32_bf16 a[224:227], a[240:243], v[192:195], a[224:227]
    v_exp_f32 v161, v161
    v_mfma_f32_16x16x32_bf16 a[224:227], a[240:243], v[208:211], a[224:227]
    v_cvt_pk_bf16_f32 v240, v160, v161
    v_mfma_f32_16x16x32_bf16 a[228:231], a[240:243], v[212:215], a[228:231]
    v_exp_f32 v162, v162
    v_mfma_f32_16x16x32_bf16 a[228:231], a[240:243], v[196:199], a[228:231]
    s_waitcnt vmcnt(9) lgkmcnt(4)
    v_mfma_f32_16x16x32_bf16 a[232:235], a[240:243], v[200:203], a[232:235]
    v_exp_f32 v163, v163
    v_mfma_f32_16x16x32_bf16 a[232:235], a[240:243], v[216:219], a[232:235]
    v_cvt_pk_bf16_f32 v241, v162, v163
    v_mfma_f32_16x16x32_bf16 a[236:239], a[240:243], v[220:223], a[236:239]
    v_exp_f32 v164, v164
    v_mfma_f32_16x16x32_bf16 a[236:239], a[240:243], v[204:207], a[236:239]
    s_barrier
    v_mfma_f32_16x16x32_bf16 v[128:131], a[128:131], v[32:35], v[24:27]
    v_exp_f32 v165, v165
    v_mfma_f32_16x16x32_bf16 v[128:131], a[132:135], v[36:39], v[128:131]
    ds_read_b64_tr_b16 a[160:161], v5 offset:0
    v_cvt_pk_bf16_f32 v244, v164, v165
    v_mfma_f32_16x16x32_bf16 v[128:131], a[136:139], v[40:43], v[128:131]
    v_exp_f32 v166, v166
    v_mfma_f32_16x16x32_bf16 v[128:131], a[140:143], v[44:47], v[128:131]
    ds_read_b64_tr_b16 a[162:163], v5 offset:4096
    ds_read_b64_tr_b16 a[164:165], v5 offset:8192
    v_mfma_f32_16x16x32_bf16 v[132:135], a[140:143], v[60:63], v[28:31]
    v_exp_f32 v167, v167
    v_mfma_f32_16x16x32_bf16 v[132:135], a[136:139], v[56:59], v[132:135]
    ds_read_b64_tr_b16 a[166:167], v5 offset:12288
    v_cvt_pk_bf16_f32 v245, v166, v167
    v_mfma_f32_16x16x32_bf16 v[132:135], a[132:135], v[52:55], v[132:135]
    v_exp_f32 v168, v168
    v_mfma_f32_16x16x32_bf16 v[132:135], a[128:131], v[48:51], v[132:135]
    ds_read_b64_tr_b16 a[168:169], v6 offset:0
    ds_read_b64_tr_b16 a[170:171], v6 offset:4096
    v_mfma_f32_16x16x32_bf16 v[136:139], a[128:131], v[64:67], v[20:23]
    v_exp_f32 v169, v169
    v_mfma_f32_16x16x32_bf16 v[136:139], a[132:135], v[68:71], v[136:139]
    ds_read_b64_tr_b16 a[172:173], v6 offset:8192
    v_cvt_pk_bf16_f32 v248, v168, v169
    v_mfma_f32_16x16x32_bf16 v[136:139], a[136:139], v[72:75], v[136:139]
    v_exp_f32 v170, v170
    v_mfma_f32_16x16x32_bf16 v[136:139], a[140:143], v[76:79], v[136:139]
    ds_read_b64_tr_b16 a[174:175], v6 offset:12288
    ds_read_b64_tr_b16 a[176:177], v7 offset:0
    v_mfma_f32_16x16x32_bf16 v[140:143], a[140:143], v[92:95], v[124:127]
    v_exp_f32 v171, v171
    v_mfma_f32_16x16x32_bf16 v[140:143], a[136:139], v[88:91], v[140:143]
    ds_read_b64_tr_b16 a[178:179], v7 offset:4096
    v_cvt_pk_bf16_f32 v249, v170, v171
    v_mfma_f32_16x16x32_bf16 v[140:143], a[132:135], v[84:87], v[140:143]
    v_exp_f32 v172, v172
    v_mfma_f32_16x16x32_bf16 v[140:143], a[128:131], v[80:83], v[140:143]
    s_waitcnt lgkmcnt(10)
    ds_read_b64_tr_b16 a[180:181], v7 offset:8192
    v_mfma_f32_16x16x32_bf16 v[144:147], a[144:147], v[32:35], v[24:27]
    v_exp_f32 v173, v173
    v_mfma_f32_16x16x32_bf16 v[144:147], a[148:151], v[36:39], v[144:147]
    ds_read_b128 a[128:131], v1 offset:24576
    v_cvt_pk_bf16_f32 v252, v172, v173
    v_mfma_f32_16x16x32_bf16 v[144:147], a[152:155], v[40:43], v[144:147]
    v_exp_f32 v174, v174
    v_mfma_f32_16x16x32_bf16 v[144:147], a[156:159], v[44:47], v[144:147]
    ds_read_b128 a[132:135], v2 offset:24576
    ds_read_b128 a[136:139], v3 offset:24576
    v_mfma_f32_16x16x32_bf16 v[148:151], a[156:159], v[60:63], v[28:31]
    v_exp_f32 v175, v175
    v_mfma_f32_16x16x32_bf16 v[148:151], a[152:155], v[56:59], v[148:151]
    ds_read_b128 a[140:143], v4 offset:24576
    v_cvt_pk_bf16_f32 v253, v174, v175
    v_mfma_f32_16x16x32_bf16 v[148:151], a[148:151], v[52:55], v[148:151]
    v_exp_f32 v176, v176
    v_mfma_f32_16x16x32_bf16 v[148:151], a[144:147], v[48:51], v[148:151]
    ds_read_b64_tr_b16 a[182:183], v7 offset:12288
    ds_read_b64_tr_b16 a[184:185], v8 offset:0
    v_mfma_f32_16x16x32_bf16 v[152:155], a[144:147], v[64:67], v[20:23]
    v_exp_f32 v177, v177
    v_mfma_f32_16x16x32_bf16 v[152:155], a[148:151], v[68:71], v[152:155]
    ds_read_b64_tr_b16 a[186:187], v8 offset:4096
    v_cvt_pk_bf16_f32 v242, v176, v177
    v_mfma_f32_16x16x32_bf16 v[152:155], a[152:155], v[72:75], v[152:155]
    v_exp_f32 v178, v178
    v_mfma_f32_16x16x32_bf16 v[152:155], a[156:159], v[76:79], v[152:155]
    ds_read_b64_tr_b16 a[188:189], v8 offset:8192
    v_mfma_f32_16x16x32_bf16 v[156:159], a[156:159], v[92:95], v[124:127]
    v_exp_f32 v179, v179
    v_mfma_f32_16x16x32_bf16 v[156:159], a[152:155], v[88:91], v[156:159]
    ds_read_b64_tr_b16 a[190:191], v8 offset:12288
    v_cvt_pk_bf16_f32 v243, v178, v179
    v_mfma_f32_16x16x32_bf16 v[156:159], a[148:151], v[84:87], v[156:159]
    v_exp_f32 v180, v180
    v_mfma_f32_16x16x32_bf16 v[156:159], a[144:147], v[80:83], v[156:159]
    ds_read_b64_tr_b16 a[192:193], v9 offset:0
    s_waitcnt lgkmcnt(6)
    v_mfma_f32_16x16x32_bf16 v[160:163], a[128:131], v[32:35], v[24:27]
    v_exp_f32 v181, v181
    v_mfma_f32_16x16x32_bf16 v[160:163], a[132:135], v[36:39], v[160:163]
    ds_read_b128 a[144:147], v1 offset:28672
    v_cvt_pk_bf16_f32 v246, v180, v181
    v_mfma_f32_16x16x32_bf16 v[160:163], a[136:139], v[40:43], v[160:163]
    v_exp_f32 v182, v182
    v_mfma_f32_16x16x32_bf16 v[160:163], a[140:143], v[44:47], v[160:163]
    ds_read_b128 a[148:151], v2 offset:28672
    ds_read_b128 a[152:155], v3 offset:28672
    v_mfma_f32_16x16x32_bf16 v[164:167], a[140:143], v[60:63], v[28:31]
    v_exp_f32 v183, v183
    v_mfma_f32_16x16x32_bf16 v[164:167], a[136:139], v[56:59], v[164:167]
    ds_read_b128 a[156:159], v4 offset:28672
    v_cvt_pk_bf16_f32 v247, v182, v183
    v_mfma_f32_16x16x32_bf16 v[164:167], a[132:135], v[52:55], v[164:167]
    v_exp_f32 v184, v184
    v_mfma_f32_16x16x32_bf16 v[164:167], a[128:131], v[48:51], v[164:167]
    ds_read_b64_tr_b16 a[194:195], v9 offset:4096
    ds_read_b64_tr_b16 a[196:197], v9 offset:8192
    v_mfma_f32_16x16x32_bf16 v[168:171], a[128:131], v[64:67], v[20:23]
    v_exp_f32 v185, v185
    v_mfma_f32_16x16x32_bf16 v[168:171], a[132:135], v[68:71], v[168:171]
    ds_read_b64_tr_b16 a[198:199], v9 offset:12288
    v_cvt_pk_bf16_f32 v250, v184, v185
    v_mfma_f32_16x16x32_bf16 v[168:171], a[136:139], v[72:75], v[168:171]
    v_exp_f32 v186, v186
    v_mfma_f32_16x16x32_bf16 v[168:171], a[140:143], v[76:79], v[168:171]
    ds_read_b64_tr_b16 a[200:201], v10 offset:0
    ds_read_b64_tr_b16 a[202:203], v10 offset:4096
    v_mfma_f32_16x16x32_bf16 v[172:175], a[140:143], v[92:95], v[124:127]
    v_exp_f32 v187, v187
    v_mfma_f32_16x16x32_bf16 v[172:175], a[136:139], v[88:91], v[172:175]
    ds_read_b64_tr_b16 a[204:205], v10 offset:8192
    v_cvt_pk_bf16_f32 v251, v186, v187
    v_mfma_f32_16x16x32_bf16 v[172:175], a[132:135], v[84:87], v[172:175]
    v_exp_f32 v188, v188
    v_mfma_f32_16x16x32_bf16 v[172:175], a[128:131], v[80:83], v[172:175]
    ds_read_b64_tr_b16 a[206:207], v10 offset:12288
    s_waitcnt lgkmcnt(7)
    v_mfma_f32_16x16x32_bf16 v[176:179], a[144:147], v[32:35], v[24:27]
    v_exp_f32 v189, v189
    v_mfma_f32_16x16x32_bf16 v[176:179], a[148:151], v[36:39], v[176:179]
    ds_read_b64_tr_b16 a[208:209], v11 offset:0
    v_cvt_pk_bf16_f32 v254, v188, v189
    v_mfma_f32_16x16x32_bf16 v[176:179], a[152:155], v[40:43], v[176:179]
    v_exp_f32 v190, v190
    v_mfma_f32_16x16x32_bf16 v[176:179], a[156:159], v[44:47], v[176:179]
    ds_read_b64_tr_b16 a[210:211], v11 offset:4096
    v_mfma_f32_16x16x32_bf16 v[180:183], a[156:159], v[60:63], v[28:31]
    v_exp_f32 v191, v191
    v_mfma_f32_16x16x32_bf16 v[180:183], a[152:155], v[56:59], v[180:183]
    ds_read_b64_tr_b16 a[212:213], v11 offset:8192
    v_cvt_pk_bf16_f32 v255, v190, v191
    v_mfma_f32_16x16x32_bf16 v[180:183], a[148:151], v[52:55], v[180:183]
    v_mfma_f32_16x16x32_bf16 v[180:183], a[144:147], v[48:51], v[180:183]
    ds_read_b64_tr_b16 a[214:215], v11 offset:12288
    v_mfma_f32_16x16x32_bf16 v[184:187], a[144:147], v[64:67], v[20:23]
    buffer_load_dword v112, v103, s[16:19], s31 offen offset:3072
    v_mfma_f32_16x16x32_bf16 v[184:187], a[148:151], v[68:71], v[184:187]
    ds_read_b64_tr_b16 a[216:217], v12 offset:0
    v_mfma_f32_16x16x32_bf16 v[184:187], a[152:155], v[72:75], v[184:187]
    s_add_u32 s31, s31, 131072
    v_mfma_f32_16x16x32_bf16 v[184:187], a[156:159], v[76:79], v[184:187]
    ds_read_b64_tr_b16 a[218:219], v12 offset:4096
    v_mfma_f32_16x16x32_bf16 v[188:191], a[156:159], v[92:95], v[124:127]
    s_cmp_eq_u32 s27, 0
    s_cselect_b32 s31, s12, s31
    v_mfma_f32_16x16x32_bf16 v[188:191], a[152:155], v[88:91], v[188:191]
    ds_read_b64_tr_b16 a[220:221], v12 offset:8192
    v_mfma_f32_16x16x32_bf16 v[188:191], a[148:151], v[84:87], v[188:191]
    v_exp_f32 v128, v128
    v_mfma_f32_16x16x32_bf16 v[188:191], a[144:147], v[80:83], v[188:191]
    ds_read_b64_tr_b16 a[222:223], v12 offset:12288
    v_mfma_f32_16x16x32_bf16 a[0:3], a[160:163], v[224:227], a[0:3]
    v_exp_f32 v129, v129
    v_mfma_f32_16x16x32_bf16 a[0:3], a[164:167], v[240:243], a[0:3]
    v_cvt_pk_bf16_f32 v192, v128, v129
    v_mfma_f32_16x16x32_bf16 a[4:7], a[164:167], v[244:247], a[4:7]
    v_exp_f32 v130, v130
    v_mfma_f32_16x16x32_bf16 a[4:7], a[160:163], v[228:231], a[4:7]
    ds_read_b128 a[128:131], v1 offset:32768
    s_add_u32 m0, s26, 98304
    v_mfma_f32_16x16x32_bf16 a[8:11], a[160:163], v[232:235], a[8:11]
    v_exp_f32 v131, v131
    v_mfma_f32_16x16x32_bf16 a[8:11], a[164:167], v[248:251], a[8:11]
    buffer_load_dwordx4 v17, s[8:11], s25 offen offset:0 nt lds
    v_cvt_pk_bf16_f32 v193, v130, v131
    v_mfma_f32_16x16x32_bf16 a[12:15], a[164:167], v[252:255], a[12:15]
    v_exp_f32 v132, v132
    v_mfma_f32_16x16x32_bf16 a[12:15], a[160:163], v[236:239], a[12:15]
    s_cmp_eq_u32 s27, 1
    s_cselect_b32 s31, s13, s31
    v_mfma_f32_16x16x32_bf16 a[28:31], a[168:171], v[236:239], a[28:31]
    v_exp_f32 v133, v133
    v_mfma_f32_16x16x32_bf16 a[28:31], a[172:175], v[252:255], a[28:31]
    v_cvt_pk_bf16_f32 v196, v132, v133
    v_mfma_f32_16x16x32_bf16 a[24:27], a[172:175], v[248:251], a[24:27]
    v_exp_f32 v134, v134
    v_mfma_f32_16x16x32_bf16 a[24:27], a[168:171], v[232:235], a[24:27]
    ds_read_b128 a[132:135], v2 offset:32768
    v_mfma_f32_16x16x32_bf16 a[20:23], a[168:171], v[228:231], a[20:23]
    v_exp_f32 v135, v135
    v_mfma_f32_16x16x32_bf16 a[20:23], a[172:175], v[244:247], a[20:23]
    buffer_load_dwordx4 v18, s[8:11], s25 offen offset:1024 nt lds
    v_cvt_pk_bf16_f32 v197, v134, v135
    v_mfma_f32_16x16x32_bf16 a[16:19], a[172:175], v[240:243], a[16:19]
    v_exp_f32 v136, v136
    v_mfma_f32_16x16x32_bf16 a[16:19], a[168:171], v[224:227], a[16:19]
    s_cmp_eq_u32 s27, 2
    s_cselect_b32 s31, s14, s31
    v_mfma_f32_16x16x32_bf16 a[32:35], a[176:179], v[224:227], a[32:35]
    v_exp_f32 v137, v137
    v_mfma_f32_16x16x32_bf16 a[32:35], a[180:183], v[240:243], a[32:35]
    v_cvt_pk_bf16_f32 v200, v136, v137
    v_mfma_f32_16x16x32_bf16 a[36:39], a[180:183], v[244:247], a[36:39]
    v_exp_f32 v138, v138
    v_mfma_f32_16x16x32_bf16 a[36:39], a[176:179], v[228:231], a[36:39]
    ds_read_b128 a[136:139], v3 offset:32768
    v_mfma_f32_16x16x32_bf16 a[40:43], a[176:179], v[232:235], a[40:43]
    v_exp_f32 v139, v139
    v_mfma_f32_16x16x32_bf16 a[40:43], a[180:183], v[248:251], a[40:43]
    buffer_load_dwordx4 v17, s[8:11], s25 offen offset:2048 nt lds
    v_cvt_pk_bf16_f32 v201, v138, v139
    v_mfma_f32_16x16x32_bf16 a[44:47], a[180:183], v[252:255], a[44:47]
    v_exp_f32 v140, v140
    v_mfma_f32_16x16x32_bf16 a[44:47], a[176:179], v[236:239], a[44:47]
    v_mfma_f32_16x16x32_bf16 a[60:63], a[184:187], v[236:239], a[60:63]
    v_exp_f32 v141, v141
    v_mfma_f32_16x16x32_bf16 a[60:63], a[188:191], v[252:255], a[60:63]
    v_cvt_pk_bf16_f32 v204, v140, v141
    v_mfma_f32_16x16x32_bf16 a[56:59], a[188:191], v[248:251], a[56:59]
    v_exp_f32 v142, v142
    v_mfma_f32_16x16x32_bf16 a[56:59], a[184:187], v[232:235], a[56:59]
    ds_read_b128 a[140:143], v4 offset:32768
    s_waitcnt lgkmcnt(4)
    v_mfma_f32_16x16x32_bf16 a[52:55], a[184:187], v[228:231], a[52:55]
    v_exp_f32 v143, v143
    v_mfma_f32_16x16x32_bf16 a[52:55], a[188:191], v[244:247], a[52:55]
    buffer_load_dwordx4 v18, s[8:11], s25 offen offset:3072 nt lds
    v_cvt_pk_bf16_f32 v205, v142, v143
    v_mfma_f32_16x16x32_bf16 a[48:51], a[188:191], v[240:243], a[48:51]
    v_exp_f32 v144, v144
    v_mfma_f32_16x16x32_bf16 a[48:51], a[184:187], v[224:227], a[48:51]
    s_add_u32 s25, s25, 16384
    v_mfma_f32_16x16x32_bf16 a[64:67], a[192:195], v[224:227], a[64:67]
    v_exp_f32 v145, v145
    v_mfma_f32_16x16x32_bf16 a[64:67], a[196:199], v[240:243], a[64:67]
    v_cvt_pk_bf16_f32 v194, v144, v145
    v_mfma_f32_16x16x32_bf16 a[68:71], a[196:199], v[244:247], a[68:71]
    v_exp_f32 v146, v146
    v_mfma_f32_16x16x32_bf16 a[68:71], a[192:195], v[228:231], a[68:71]
    ds_read_b128 a[144:147], v1 offset:36864
    s_add_u32 m0, s26, 0
    v_mfma_f32_16x16x32_bf16 a[72:75], a[192:195], v[232:235], a[72:75]
    v_exp_f32 v147, v147
    v_mfma_f32_16x16x32_bf16 a[72:75], a[196:199], v[248:251], a[72:75]
    buffer_load_dwordx4 v13, s[4:7], s24 offen offset:0 nt lds
    v_cvt_pk_bf16_f32 v195, v146, v147
    v_mfma_f32_16x16x32_bf16 a[76:79], a[196:199], v[252:255], a[76:79]
    v_exp_f32 v148, v148
    v_mfma_f32_16x16x32_bf16 a[76:79], a[192:195], v[236:239], a[76:79]
    v_mfma_f32_16x16x32_bf16 a[92:95], a[200:203], v[236:239], a[92:95]
    v_exp_f32 v149, v149
    v_mfma_f32_16x16x32_bf16 a[92:95], a[204:207], v[252:255], a[92:95]
    v_cvt_pk_bf16_f32 v198, v148, v149
    v_mfma_f32_16x16x32_bf16 a[88:91], a[204:207], v[248:251], a[88:91]
    v_exp_f32 v150, v150
    v_mfma_f32_16x16x32_bf16 a[88:91], a[200:203], v[232:235], a[88:91]
    ds_read_b128 a[148:151], v2 offset:36864
    v_mfma_f32_16x16x32_bf16 a[84:87], a[200:203], v[228:231], a[84:87]
    v_exp_f32 v151, v151
    v_mfma_f32_16x16x32_bf16 a[84:87], a[204:207], v[244:247], a[84:87]
    buffer_load_dwordx4 v14, s[4:7], s24 offen offset:1024 nt lds
    v_cvt_pk_bf16_f32 v199, v150, v151
    v_mfma_f32_16x16x32_bf16 a[80:83], a[204:207], v[240:243], a[80:83]
    v_exp_f32 v152, v152
    v_mfma_f32_16x16x32_bf16 a[80:83], a[200:203], v[224:227], a[80:83]
    v_mfma_f32_16x16x32_bf16 a[96:99], a[208:211], v[224:227], a[96:99]
    v_exp_f32 v153, v153
    v_mfma_f32_16x16x32_bf16 a[96:99], a[212:215], v[240:243], a[96:99]
    v_cvt_pk_bf16_f32 v202, v152, v153
    v_mfma_f32_16x16x32_bf16 a[100:103], a[212:215], v[244:247], a[100:103]
    v_exp_f32 v154, v154
    v_mfma_f32_16x16x32_bf16 a[100:103], a[208:211], v[228:231], a[100:103]
    ds_read_b128 a[152:155], v3 offset:36864
    v_mfma_f32_16x16x32_bf16 a[104:107], a[208:211], v[232:235], a[104:107]
    v_exp_f32 v155, v155
    v_mfma_f32_16x16x32_bf16 a[104:107], a[212:215], v[248:251], a[104:107]
    buffer_load_dwordx4 v15, s[4:7], s24 offen offset:2048 nt lds
    v_cvt_pk_bf16_f32 v203, v154, v155
    v_mfma_f32_16x16x32_bf16 a[108:111], a[212:215], v[252:255], a[108:111]
    v_exp_f32 v156, v156
    v_mfma_f32_16x16x32_bf16 a[108:111], a[208:211], v[236:239], a[108:111]
    v_mfma_f32_16x16x32_bf16 a[124:127], a[216:219], v[236:239], a[124:127]
    v_exp_f32 v157, v157
    v_mfma_f32_16x16x32_bf16 a[124:127], a[220:223], v[252:255], a[124:127]
    v_cvt_pk_bf16_f32 v206, v156, v157
    v_mfma_f32_16x16x32_bf16 a[120:123], a[220:223], v[248:251], a[120:123]
    v_exp_f32 v158, v158
    v_mfma_f32_16x16x32_bf16 a[120:123], a[216:219], v[232:235], a[120:123]
    ds_read_b128 a[156:159], v4 offset:36864
    v_mfma_f32_16x16x32_bf16 a[116:119], a[216:219], v[228:231], a[116:119]
    v_exp_f32 v159, v159
    v_mfma_f32_16x16x32_bf16 a[116:119], a[220:223], v[244:247], a[116:119]
    buffer_load_dwordx4 v16, s[4:7], s24 offen offset:3072 nt lds
    v_cvt_pk_bf16_f32 v207, v158, v159
    v_mfma_f32_16x16x32_bf16 a[112:115], a[220:223], v[240:243], a[112:115]
    v_exp_f32 v160, v160
    v_mfma_f32_16x16x32_bf16 a[112:115], a[216:219], v[224:227], a[112:115]
    s_add_u32 s24, s24, 16384
    v_mfma_f32_16x16x32_bf16 a[224:227], a[240:243], v[224:227], a[224:227]
    v_exp_f32 v161, v161
    v_mfma_f32_16x16x32_bf16 a[224:227], a[240:243], v[240:243], a[224:227]
    v_cvt_pk_bf16_f32 v208, v160, v161
    v_mfma_f32_16x16x32_bf16 a[228:231], a[240:243], v[244:247], a[228:231]
    v_exp_f32 v162, v162
    v_mfma_f32_16x16x32_bf16 a[228:231], a[240:243], v[228:231], a[228:231]
    s_waitcnt vmcnt(9) lgkmcnt(4)
    v_mfma_f32_16x16x32_bf16 a[232:235], a[240:243], v[232:235], a[232:235]
    v_exp_f32 v163, v163
    s_add_u32 s27, s27, 1
    v_mfma_f32_16x16x32_bf16 a[232:235], a[240:243], v[248:251], a[232:235]
    v_cvt_pk_bf16_f32 v209, v162, v163
    v_mfma_f32_16x16x32_bf16 a[236:239], a[240:243], v[252:255], a[236:239]
    v_exp_f32 v164, v164
    v_mfma_f32_16x16x32_bf16 a[236:239], a[240:243], v[236:239], a[236:239]
    s_barrier
    s_cmp_lt_u32 s27, 7
    s_cbranch_scc1 L_attn_loop
L_tail:
    v_mfma_f32_16x16x32_bf16 v[128:131], a[128:131], v[32:35], v[24:27]
    v_exp_f32 v165, v165
    v_mfma_f32_16x16x32_bf16 v[128:131], a[132:135], v[36:39], v[128:131]
    ds_read_b64_tr_b16 a[160:161], v5 offset:16384
    v_cvt_pk_bf16_f32 v212, v164, v165
    v_mfma_f32_16x16x32_bf16 v[128:131], a[136:139], v[40:43], v[128:131]
    v_exp_f32 v166, v166
    v_mfma_f32_16x16x32_bf16 v[128:131], a[140:143], v[44:47], v[128:131]
    ds_read_b64_tr_b16 a[162:163], v5 offset:20480
    ds_read_b64_tr_b16 a[164:165], v5 offset:24576
    v_mfma_f32_16x16x32_bf16 v[132:135], a[140:143], v[60:63], v[28:31]
    v_exp_f32 v167, v167
    v_mfma_f32_16x16x32_bf16 v[132:135], a[136:139], v[56:59], v[132:135]
    ds_read_b64_tr_b16 a[166:167], v5 offset:28672
    v_cvt_pk_bf16_f32 v213, v166, v167
    v_mfma_f32_16x16x32_bf16 v[132:135], a[132:135], v[52:55], v[132:135]
    v_exp_f32 v168, v168
    v_mfma_f32_16x16x32_bf16 v[132:135], a[128:131], v[48:51], v[132:135]
    ds_read_b64_tr_b16 a[168:169], v6 offset:16384
    ds_read_b64_tr_b16 a[170:171], v6 offset:20480
    v_mfma_f32_16x16x32_bf16 v[136:139], a[128:131], v[64:67], v[20:23]
    v_exp_f32 v169, v169
    v_mfma_f32_16x16x32_bf16 v[136:139], a[132:135], v[68:71], v[136:139]
    ds_read_b64_tr_b16 a[172:173], v6 offset:24576
    v_cvt_pk_bf16_f32 v216, v168, v169
    v_mfma_f32_16x16x32_bf16 v[136:139], a[136:139], v[72:75], v[136:139]
    v_exp_f32 v170, v170
    v_mfma_f32_16x16x32_bf16 v[136:139], a[140:143], v[76:79], v[136:139]
    ds_read_b64_tr_b16 a[174:175], v6 offset:28672
    ds_read_b64_tr_b16 a[176:177], v7 offset:16384
    v_mfma_f32_16x16x32_bf16 v[140:143], a[140:143], v[92:95], v[124:127]
    v_exp_f32 v171, v171
    v_mfma_f32_16x16x32_bf16 v[140:143], a[136:139], v[88:91], v[140:143]
    ds_read_b64_tr_b16 a[178:179], v7 offset:20480
    v_cvt_pk_bf16_f32 v217, v170, v171
    v_mfma_f32_16x16x32_bf16 v[140:143], a[132:135], v[84:87], v[140:143]
    v_exp_f32 v172, v172
    v_mfma_f32_16x16x32_bf16 v[140:143], a[128:131], v[80:83], v[140:143]
    s_waitcnt lgkmcnt(10)
    ds_read_b64_tr_b16 a[180:181], v7 offset:24576
    s_lshr_b32 s32, s2, 3
    v_mfma_f32_16x16x32_bf16 v[144:147], a[144:147], v[32:35], v[24:27]
    v_exp_f32 v173, v173
    v_mfma_f32_16x16x32_bf16 v[144:147], a[148:151], v[36:39], v[144:147]
    ds_read_b128 a[128:131], v1 offset:40960
    v_cvt_pk_bf16_f32 v220, v172, v173
    v_mfma_f32_16x16x32_bf16 v[144:147], a[152:155], v[40:43], v[144:147]
    v_exp_f32 v174, v174
    v_mfma_f32_16x16x32_bf16 v[144:147], a[156:159], v[44:47], v[144:147]
    ds_read_b128 a[132:135], v2 offset:40960
    ds_read_b128 a[136:139], v3 offset:40960
    v_mfma_f32_16x16x32_bf16 v[148:151], a[156:159], v[60:63], v[28:31]
    v_exp_f32 v175, v175
    v_mfma_f32_16x16x32_bf16 v[148:151], a[152:155], v[56:59], v[148:151]
    ds_read_b128 a[140:143], v4 offset:40960
    v_cvt_pk_bf16_f32 v221, v174, v175
    v_mfma_f32_16x16x32_bf16 v[148:151], a[148:151], v[52:55], v[148:151]
    v_exp_f32 v176, v176
    v_mfma_f32_16x16x32_bf16 v[148:151], a[144:147], v[48:51], v[148:151]
    ds_read_b64_tr_b16 a[182:183], v7 offset:28672
    ds_read_b64_tr_b16 a[184:185], v8 offset:16384
    v_mfma_f32_16x16x32_bf16 v[152:155], a[144:147], v[64:67], v[20:23]
    v_exp_f32 v177, v177
    v_mfma_f32_16x16x32_bf16 v[152:155], a[148:151], v[68:71], v[152:155]
    ds_read_b64_tr_b16 a[186:187], v8 offset:20480
    v_cvt_pk_bf16_f32 v210, v176, v177
    v_mfma_f32_16x16x32_bf16 v[152:155], a[152:155], v[72:75], v[152:155]
    v_exp_f32 v178, v178
    v_mfma_f32_16x16x32_bf16 v[152:155], a[156:159], v[76:79], v[152:155]
    ds_read_b64_tr_b16 a[188:189], v8 offset:24576
    s_lshl_b32 s32, s32, 15
    v_mfma_f32_16x16x32_bf16 v[156:159], a[156:159], v[92:95], v[124:127]
    v_exp_f32 v179, v179
    v_mfma_f32_16x16x32_bf16 v[156:159], a[152:155], v[88:91], v[156:159]
    ds_read_b64_tr_b16 a[190:191], v8 offset:28672
    v_cvt_pk_bf16_f32 v211, v178, v179
    v_mfma_f32_16x16x32_bf16 v[156:159], a[148:151], v[84:87], v[156:159]
    v_exp_f32 v180, v180
    v_mfma_f32_16x16x32_bf16 v[156:159], a[144:147], v[80:83], v[156:159]
    ds_read_b64_tr_b16 a[192:193], v9 offset:16384
    s_waitcnt lgkmcnt(6)
    v_mfma_f32_16x16x32_bf16 v[160:163], a[128:131], v[32:35], v[24:27]
    v_exp_f32 v181, v181
    v_mfma_f32_16x16x32_bf16 v[160:163], a[132:135], v[36:39], v[160:163]
    ds_read_b128 a[144:147], v1 offset:45056
    v_cvt_pk_bf16_f32 v214, v180, v181
    v_mfma_f32_16x16x32_bf16 v[160:163], a[136:139], v[40:43], v[160:163]
    v_exp_f32 v182, v182
    v_mfma_f32_16x16x32_bf16 v[160:163], a[140:143], v[44:47], v[160:163]
    ds_read_b128 a[148:151], v2 offset:45056
    ds_read_b128 a[152:155], v3 offset:45056
    v_mfma_f32_16x16x32_bf16 v[164:167], a[140:143], v[60:63], v[28:31]
    v_exp_f32 v183, v183
    v_mfma_f32_16x16x32_bf16 v[164:167], a[136:139], v[56:59], v[164:167]
    ds_read_b128 a[156:159], v4 offset:45056
    v_cvt_pk_bf16_f32 v215, v182, v183
    v_mfma_f32_16x16x32_bf16 v[164:167], a[132:135], v[52:55], v[164:167]
    v_exp_f32 v184, v184
    v_mfma_f32_16x16x32_bf16 v[164:167], a[128:131], v[48:51], v[164:167]
    ds_read_b64_tr_b16 a[194:195], v9 offset:20480
    ds_read_b64_tr_b16 a[196:197], v9 offset:24576
    v_mfma_f32_16x16x32_bf16 v[168:171], a[128:131], v[64:67], v[20:23]
    v_exp_f32 v185, v185
    v_mfma_f32_16x16x32_bf16 v[168:171], a[132:135], v[68:71], v[168:171]
    ds_read_b64_tr_b16 a[198:199], v9 offset:28672
    v_cvt_pk_bf16_f32 v218, v184, v185
    v_mfma_f32_16x16x32_bf16 v[168:171], a[136:139], v[72:75], v[168:171]
    v_exp_f32 v186, v186
    v_mfma_f32_16x16x32_bf16 v[168:171], a[140:143], v[76:79], v[168:171]
    ds_read_b64_tr_b16 a[200:201], v10 offset:16384
    ds_read_b64_tr_b16 a[202:203], v10 offset:20480
    v_mfma_f32_16x16x32_bf16 v[172:175], a[140:143], v[92:95], v[124:127]
    v_exp_f32 v187, v187
    v_mfma_f32_16x16x32_bf16 v[172:175], a[136:139], v[88:91], v[172:175]
    ds_read_b64_tr_b16 a[204:205], v10 offset:24576
    v_cvt_pk_bf16_f32 v219, v186, v187
    v_mfma_f32_16x16x32_bf16 v[172:175], a[132:135], v[84:87], v[172:175]
    v_exp_f32 v188, v188
    v_mfma_f32_16x16x32_bf16 v[172:175], a[128:131], v[80:83], v[172:175]
    ds_read_b64_tr_b16 a[206:207], v10 offset:28672
    s_waitcnt lgkmcnt(7)
    v_mfma_f32_16x16x32_bf16 v[176:179], a[144:147], v[32:35], v[24:27]
    v_exp_f32 v189, v189
    v_mfma_f32_16x16x32_bf16 v[176:179], a[148:151], v[36:39], v[176:179]
    ds_read_b64_tr_b16 a[208:209], v11 offset:16384
    v_cvt_pk_bf16_f32 v222, v188, v189
    v_mfma_f32_16x16x32_bf16 v[176:179], a[152:155], v[40:43], v[176:179]
    v_exp_f32 v190, v190
    v_mfma_f32_16x16x32_bf16 v[176:179], a[156:159], v[44:47], v[176:179]
    ds_read_b64_tr_b16 a[210:211], v11 offset:20480
    s_bfe_u32 s34, s2, 0x20001
    v_mfma_f32_16x16x32_bf16 v[180:183], a[156:159], v[60:63], v[28:31]
    v_exp_f32 v191, v191
    v_mfma_f32_16x16x32_bf16 v[180:183], a[152:155], v[56:59], v[180:183]
    ds_read_b64_tr_b16 a[212:213], v11 offset:24576
    v_cvt_pk_bf16_f32 v223, v190, v191
    v_mfma_f32_16x16x32_bf16 v[180:183], a[148:151], v[52:55], v[180:183]
    s_lshl_b32 s34, s34, 20
    s_add_u32 s32, s32, s34
    v_mfma_f32_16x16x32_bf16 v[180:183], a[144:147], v[48:51], v[180:183]
    ds_read_b64_tr_b16 a[214:215], v11 offset:28672
    s_cmp_eq_u32 s38, 0
    s_cselect_b32 s45, s32, 0x7000000
    v_mfma_f32_16x16x32_bf16 v[184:187], a[144:147], v[64:67], v[20:23]
    buffer_load_dword v112, v113, s[48:51], s45 offen
    s_add_u32 s45, s45, 4096
    v_mfma_f32_16x16x32_bf16 v[184:187], a[148:151], v[68:71], v[184:187]
    ds_read_b64_tr_b16 a[216:217], v12 offset:16384
    v_mfma_f32_16x16x32_bf16 v[184:187], a[152:155], v[72:75], v[184:187]
    buffer_load_dword v112, v113, s[48:51], s45 offen
    s_add_u32 s45, s45, 4096
    v_mfma_f32_16x16x32_bf16 v[184:187], a[156:159], v[76:79], v[184:187]
    ds_read_b64_tr_b16 a[218:219], v12 offset:20480
    v_mfma_f32_16x16x32_bf16 v[188:191], a[156:159], v[92:95], v[124:127]
    v_mfma_f32_16x16x32_bf16 v[188:191], a[152:155], v[88:91], v[188:191]
    ds_read_b64_tr_b16 a[220:221], v12 offset:24576
    v_mfma_f32_16x16x32_bf16 v[188:191], a[148:151], v[84:87], v[188:191]
    v_exp_f32 v128, v128
    v_mfma_f32_16x16x32_bf16 v[188:191], a[144:147], v[80:83], v[188:191]
    ds_read_b64_tr_b16 a[222:223], v12 offset:28672
    v_mfma_f32_16x16x32_bf16 a[0:3], a[160:163], v[192:195], a[0:3]
    v_exp_f32 v129, v129
    v_mfma_f32_16x16x32_bf16 a[0:3], a[164:167], v[208:211], a[0:3]
    v_cvt_pk_bf16_f32 v224, v128, v129
    v_mfma_f32_16x16x32_bf16 a[4:7], a[164:167], v[212:215], a[4:7]
    v_exp_f32 v130, v130
    v_mfma_f32_16x16x32_bf16 a[4:7], a[160:163], v[196:199], a[4:7]
    ds_read_b128 a[128:131], v1 offset:49152
    s_add_u32 m0, s26, 114688
    v_mfma_f32_16x16x32_bf16 a[8:11], a[160:163], v[200:203], a[8:11]
    v_exp_f32 v131, v131
    v_mfma_f32_16x16x32_bf16 a[8:11], a[164:167], v[216:219], a[8:11]
    buffer_load_dwordx4 v17, s[8:11], s25 offen offset:0 nt lds
    v_cvt_pk_bf16_f32 v225, v130, v131
    v_mfma_f32_16x16x32_bf16 a[12:15], a[164:167], v[220:223], a[12:15]
    v_exp_f32 v132, v132
    v_mfma_f32_16x16x32_bf16 a[12:15], a[160:163], v[204:207], a[12:15]
    buffer_load_dword v112, v113, s[48:51], s45 offen
    s_add_u32 s45, s45, 4096
    v_mfma_f32_16x16x32_bf16 a[28:31], a[168:171], v[204:207], a[28:31]
    v_exp_f32 v133, v133
    v_mfma_f32_16x16x32_bf16 a[28:31], a[172:175], v[220:223], a[28:31]
    v_cvt_pk_bf16_f32 v228, v132, v133
    v_mfma_f32_16x16x32_bf16 a[24:27], a[172:175], v[216:219], a[24:27]
    v_exp_f32 v134, v134
    v_mfma_f32_16x16x32_bf16 a[24:27], a[168:171], v[200:203], a[24:27]
    ds_read_b128 a[132:135], v2 offset:49152
    v_mfma_f32_16x16x32_bf16 a[20:23], a[168:171], v[196:199], a[20:23]
    v_exp_f32 v135, v135
    v_mfma_f32_16x16x32_bf16 a[20:23], a[172:175], v[212:215], a[20:23]
    buffer_load_dwordx4 v18, s[8:11], s25 offen offset:1024 nt lds
    v_cvt_pk_bf16_f32 v229, v134, v135
    v_mfma_f32_16x16x32_bf16 a[16:19], a[172:175], v[208:211], a[16:19]
    v_exp_f32 v136, v136
    v_mfma_f32_16x16x32_bf16 a[16:19], a[168:171], v[192:195], a[16:19]
    buffer_load_dword v112, v113, s[48:51], s45 offen
    s_add_u32 s45, s45, 4096
    v_mfma_f32_16x16x32_bf16 a[32:35], a[176:179], v[192:195], a[32:35]
    v_exp_f32 v137, v137
    v_mfma_f32_16x16x32_bf16 a[32:35], a[180:183], v[208:211], a[32:35]
    v_cvt_pk_bf16_f32 v232, v136, v137
    v_mfma_f32_16x16x32_bf16 a[36:39], a[180:183], v[212:215], a[36:39]
    v_exp_f32 v138, v138
    v_mfma_f32_16x16x32_bf16 a[36:39], a[176:179], v[196:199], a[36:39]
    ds_read_b128 a[136:139], v3 offset:49152
    v_mfma_f32_16x16x32_bf16 a[40:43], a[176:179], v[200:203], a[40:43]
    v_exp_f32 v139, v139
    v_mfma_f32_16x16x32_bf16 a[40:43], a[180:183], v[216:219], a[40:43]
    buffer_load_dwordx4 v17, s[8:11], s25 offen offset:2048 nt lds
    v_cvt_pk_bf16_f32 v233, v138, v139
    v_mfma_f32_16x16x32_bf16 a[44:47], a[180:183], v[220:223], a[44:47]
    v_exp_f32 v140, v140
    v_mfma_f32_16x16x32_bf16 a[44:47], a[176:179], v[204:207], a[44:47]
    buffer_load_dword v112, v113, s[48:51], s45 offen
    s_add_u32 s45, s45, 4096
    v_mfma_f32_16x16x32_bf16 a[60:63], a[184:187], v[204:207], a[60:63]
    v_exp_f32 v141, v141
    v_mfma_f32_16x16x32_bf16 a[60:63], a[188:191], v[220:223], a[60:63]
    v_cvt_pk_bf16_f32 v236, v140, v141
    v_mfma_f32_16x16x32_bf16 a[56:59], a[188:191], v[216:219], a[56:59]
    v_exp_f32 v142, v142
    v_mfma_f32_16x16x32_bf16 a[56:59], a[184:187], v[200:203], a[56:59]
    ds_read_b128 a[140:143], v4 offset:49152
    s_waitcnt lgkmcnt(4)
    v_mfma_f32_16x16x32_bf16 a[52:55], a[184:187], v[196:199], a[52:55]
    v_exp_f32 v143, v143
    v_mfma_f32_16x16x32_bf16 a[52:55], a[188:191], v[212:215], a[52:55]
    buffer_load_dwordx4 v18, s[8:11], s25 offen offset:3072 nt lds
    v_cvt_pk_bf16_f32 v237, v142, v143
    v_mfma_f32_16x16x32_bf16 a[48:51], a[188:191], v[208:211], a[48:51]
    v_exp_f32 v144, v144
    v_mfma_f32_16x16x32_bf16 a[48:51], a[184:187], v[192:195], a[48:51]
    s_add_u32 s25, s25, 16384
    v_mfma_f32_16x16x32_bf16 a[64:67], a[192:195], v[192:195], a[64:67]
    v_exp_f32 v145, v145
    v_mfma_f32_16x16x32_bf16 a[64:67], a[196:199], v[208:211], a[64:67]
    v_cvt_pk_bf16_f32 v226, v144, v145
    v_mfma_f32_16x16x32_bf16 a[68:71], a[196:199], v[212:215], a[68:71]
    v_exp_f32 v146, v146
    v_mfma_f32_16x16x32_bf16 a[68:71], a[192:195], v[196:199], a[68:71]
    ds_read_b128 a[144:147], v1 offset:53248
    s_add_u32 m0, s26, 0
    v_mfma_f32_16x16x32_bf16 a[72:75], a[192:195], v[200:203], a[72:75]
    v_exp_f32 v147, v147
    v_mfma_f32_16x16x32_bf16 a[72:75], a[196:199], v[216:219], a[72:75]
    buffer_load_dwordx4 v108, s[40:43], s44 offen offset:0 lds
    v_cvt_pk_bf16_f32 v227, v146, v147
    v_mfma_f32_16x16x32_bf16 a[76:79], a[196:199], v[220:223], a[76:79]
    v_exp_f32 v148, v148
    v_mfma_f32_16x16x32_bf16 a[76:79], a[192:195], v[204:207], a[76:79]
    buffer_load_dword v112, v113, s[48:51], s45 offen
    s_add_u32 s45, s45, 4096
    v_mfma_f32_16x16x32_bf16 a[92:95], a[200:203], v[204:207], a[92:95]
    v_exp_f32 v149, v149
    v_mfma_f32_16x16x32_bf16 a[92:95], a[204:207], v[220:223], a[92:95]
    v_cvt_pk_bf16_f32 v230, v148, v149
    v_mfma_f32_16x16x32_bf16 a[88:91], a[204:207], v[216:219], a[88:91]
    v_exp_f32 v150, v150
    v_mfma_f32_16x16x32_bf16 a[88:91], a[200:203], v[200:203], a[88:91]
    ds_read_b128 a[148:151], v2 offset:53248
    v_mfma_f32_16x16x32_bf16 a[84:87], a[200:203], v[196:199], a[84:87]
    v_exp_f32 v151, v151
    v_mfma_f32_16x16x32_bf16 a[84:87], a[204:207], v[212:215], a[84:87]
    buffer_load_dwordx4 v109, s[40:43], s44 offen offset:1024 lds
    v_cvt_pk_bf16_f32 v231, v150, v151
    v_mfma_f32_16x16x32_bf16 a[80:83], a[204:207], v[208:211], a[80:83]
    v_exp_f32 v152, v152
    v_mfma_f32_16x16x32_bf16 a[80:83], a[200:203], v[192:195], a[80:83]
    buffer_load_dword v112, v113, s[48:51], s45 offen
    s_add_u32 s45, s45, 4096
    v_mfma_f32_16x16x32_bf16 a[96:99], a[208:211], v[192:195], a[96:99]
    v_exp_f32 v153, v153
    v_mfma_f32_16x16x32_bf16 a[96:99], a[212:215], v[208:211], a[96:99]
    v_cvt_pk_bf16_f32 v234, v152, v153
    v_mfma_f32_16x16x32_bf16 a[100:103], a[212:215], v[212:215], a[100:103]
    v_exp_f32 v154, v154
    v_mfma_f32_16x16x32_bf16 a[100:103], a[208:211], v[196:199], a[100:103]
    ds_read_b128 a[152:155], v3 offset:53248
    v_mfma_f32_16x16x32_bf16 a[104:107], a[208:211], v[200:203], a[104:107]
    v_exp_f32 v155, v155
    v_mfma_f32_16x16x32_bf16 a[104:107], a[212:215], v[216:219], a[104:107]
    buffer_load_dwordx4 v110, s[40:43], s44 offen offset:2048 lds
    v_cvt_pk_bf16_f32 v235, v154, v155
    v_mfma_f32_16x16x32_bf16 a[108:111], a[212:215], v[220:223], a[108:111]
    v_exp_f32 v156, v156
    v_mfma_f32_16x16x32_bf16 a[108:111], a[208:211], v[204:207], a[108:111]
    buffer_load_dword v112, v113, s[48:51], s45 offen
    s_add_u32 s45, s45, 4096
    v_mfma_f32_16x16x32_bf16 a[124:127], a[216:219], v[204:207], a[124:127]
    v_exp_f32 v157, v157
    v_mfma_f32_16x16x32_bf16 a[124:127], a[220:223], v[220:223], a[124:127]
    v_cvt_pk_bf16_f32 v238, v156, v157
    v_mfma_f32_16x16x32_bf16 a[120:123], a[220:223], v[216:219], a[120:123]
    v_exp_f32 v158, v158
    v_mfma_f32_16x16x32_bf16 a[120:123], a[216:219], v[200:203], a[120:123]
    ds_read_b128 a[156:159], v4 offset:53248
    v_mfma_f32_16x16x32_bf16 a[116:119], a[216:219], v[196:199], a[116:119]
    v_exp_f32 v159, v159
    v_mfma_f32_16x16x32_bf16 a[116:119], a[220:223], v[212:215], a[116:119]
    buffer_load_dwordx4 v111, s[40:43], s44 offen offset:3072 lds
    v_cvt_pk_bf16_f32 v239, v158, v159
    v_mfma_f32_16x16x32_bf16 a[112:115], a[220:223], v[208:211], a[112:115]
    v_exp_f32 v160, v160
    v_mfma_f32_16x16x32_bf16 a[112:115], a[216:219], v[192:195], a[112:115]
    s_add_u32 s44, s44, 65536
    s_and_b32 s44, s44, 0xfffff
    v_mfma_f32_16x16x32_bf16 a[224:227], a[240:243], v[192:195], a[224:227]
    v_exp_f32 v161, v161
    v_mfma_f32_16x16x32_bf16 a[224:227], a[240:243], v[208:211], a[224:227]
    v_cvt_pk_bf16_f32 v240, v160, v161
    v_mfma_f32_16x16x32_bf16 a[228:231], a[240:243], v[212:215], a[228:231]
    v_exp_f32 v162, v162
    v_mfma_f32_16x16x32_bf16 a[228:231], a[240:243], v[196:199], a[228:231]
    s_waitcnt vmcnt(20) lgkmcnt(4)
    v_mfma_f32_16x16x32_bf16 a[232:235], a[240:243], v[200:203], a[232:235]
    v_exp_f32 v163, v163
    v_mfma_f32_16x16x32_bf16 a[232:235], a[240:243], v[216:219], a[232:235]
    v_cvt_pk_bf16_f32 v241, v162, v163
    v_mfma_f32_16x16x32_bf16 a[236:239], a[240:243], v[220:223], a[236:239]
    v_exp_f32 v164, v164
    v_mfma_f32_16x16x32_bf16 a[236:239], a[240:243], v[204:207], a[236:239]
    s_barrier
    v_mfma_f32_16x16x32_bf16 v[128:131], a[128:131], v[32:35], v[24:27]
    v_exp_f32 v165, v165
    v_mfma_f32_16x16x32_bf16 v[128:131], a[132:135], v[36:39], v[128:131]
    ds_read_b64_tr_b16 a[160:161], v5 offset:32768
    v_cvt_pk_bf16_f32 v244, v164, v165
    v_mfma_f32_16x16x32_bf16 v[128:131], a[136:139], v[40:43], v[128:131]
    v_exp_f32 v166, v166
    v_mfma_f32_16x16x32_bf16 v[128:131], a[140:143], v[44:47], v[128:131]
    ds_read_b64_tr_b16 a[162:163], v5 offset:36864
    ds_read_b64_tr_b16 a[164:165], v5 offset:40960
    v_mfma_f32_16x16x32_bf16 v[132:135], a[140:143], v[60:63], v[28:31]
    v_exp_f32 v167, v167
    v_mfma_f32_16x16x32_bf16 v[132:135], a[136:139], v[56:59], v[132:135]
    ds_read_b64_tr_b16 a[166:167], v5 offset:45056
    v_cvt_pk_bf16_f32 v245, v166, v167
    v_mfma_f32_16x16x32_bf16 v[132:135], a[132:135], v[52:55], v[132:135]
    v_exp_f32 v168, v168
    v_mfma_f32_16x16x32_bf16 v[132:135], a[128:131], v[48:51], v[132:135]
    ds_read_b64_tr_b16 a[168:169], v6 offset:32768
    ds_read_b64_tr_b16 a[170:171], v6 offset:36864
    v_mfma_f32_16x16x32_bf16 v[136:139], a[128:131], v[64:67], v[20:23]
    v_exp_f32 v169, v169
    v_mfma_f32_16x16x32_bf16 v[136:139], a[132:135], v[68:71], v[136:139]
    ds_read_b64_tr_b16 a[172:173], v6 offset:40960
    v_cvt_pk_bf16_f32 v248, v168, v169
    v_mfma_f32_16x16x32_bf16 v[136:139], a[136:139], v[72:75], v[136:139]
    v_exp_f32 v170, v170
    v_mfma_f32_16x16x32_bf16 v[136:139], a[140:143], v[76:79], v[136:139]
    ds_read_b64_tr_b16 a[174:175], v6 offset:45056
    ds_read_b64_tr_b16 a[176:177], v7 offset:32768
    v_mfma_f32_16x16x32_bf16 v[140:143], a[140:143], v[92:95], v[124:127]
    v_exp_f32 v171, v171
    v_mfma_f32_16x16x32_bf16 v[140:143], a[136:139], v[88:91], v[140:143]
    ds_read_b64_tr_b16 a[178:179], v7 offset:36864
    v_cvt_pk_bf16_f32 v249, v170, v171
    v_mfma_f32_16x16x32_bf16 v[140:143], a[132:135], v[84:87], v[140:143]
    v_exp_f32 v172, v172
    v_mfma_f32_16x16x32_bf16 v[140:143], a[128:131], v[80:83], v[140:143]
    s_waitcnt lgkmcnt(10)
    ds_read_b64_tr_b16 a[180:181], v7 offset:40960
    v_and_b32 v114, 63, v0
    v_mfma_f32_16x16x32_bf16 v[144:147], a[144:147], v[32:35], v[24:27]
    v_exp_f32 v173, v173
    v_mfma_f32_16x16x32_bf16 v[144:147], a[148:151], v[36:39], v[144:147]
    ds_read_b128 a[128:131], v1 offset:57344
    v_cvt_pk_bf16_f32 v252, v172, v173
    v_mfma_f32_16x16x32_bf16 v[144:147], a[152:155], v[40:43], v[144:147]
    v_exp_f32 v174, v174
    v_mfma_f32_16x16x32_bf16 v[144:147], a[156:159], v[44:47], v[144:147]
    ds_read_b128 a[132:135], v2 offset:57344
    ds_read_b128 a[136:139], v3 offset:57344
    v_mfma_f32_16x16x32_bf16 v[148:151], a[156:159], v[60:63], v[28:31]
    v_exp_f32 v175, v175
    v_mfma_f32_16x16x32_bf16 v[148:151], a[152:155], v[56:59], v[148:151]
    ds_read_b128 a[140:143], v4 offset:57344
    v_cvt_pk_bf16_f32 v253, v174, v175
    v_mfma_f32_16x16x32_bf16 v[148:151], a[148:151], v[52:55], v[148:151]
    v_exp_f32 v176, v176
    v_mfma_f32_16x16x32_bf16 v[148:151], a[144:147], v[48:51], v[148:151]
    ds_read_b64_tr_b16 a[182:183], v7 offset:45056
    ds_read_b64_tr_b16 a[184:185], v8 offset:32768
    v_mfma_f32_16x16x32_bf16 v[152:155], a[144:147], v[64:67], v[20:23]
    v_exp_f32 v177, v177
    v_mfma_f32_16x16x32_bf16 v[152:155], a[148:151], v[68:71], v[152:155]
    ds_read_b64_tr_b16 a[186:187], v8 offset:36864
    v_cvt_pk_bf16_f32 v242, v176, v177
    v_mfma_f32_16x16x32_bf16 v[152:155], a[152:155], v[72:75], v[152:155]
    v_exp_f32 v178, v178
    v_mfma_f32_16x16x32_bf16 v[152:155], a[156:159], v[76:79], v[152:155]
    ds_read_b64_tr_b16 a[188:189], v8 offset:40960
    v_lshrrev_b32 v115, 6, v0
    v_mfma_f32_16x16x32_bf16 v[156:159], a[156:159], v[92:95], v[124:127]
    v_exp_f32 v179, v179
    v_mfma_f32_16x16x32_bf16 v[156:159], a[152:155], v[88:91], v[156:159]
    ds_read_b64_tr_b16 a[190:191], v8 offset:45056
    v_cvt_pk_bf16_f32 v243, v178, v179
    v_mfma_f32_16x16x32_bf16 v[156:159], a[148:151], v[84:87], v[156:159]
    v_exp_f32 v180, v180
    v_mfma_f32_16x16x32_bf16 v[156:159], a[144:147], v[80:83], v[156:159]
    ds_read_b64_tr_b16 a[192:193], v9 offset:32768
    s_waitcnt lgkmcnt(6)
    v_mfma_f32_16x16x32_bf16 v[160:163], a[128:131], v[32:35], v[24:27]
    v_exp_f32 v181, v181
    v_mfma_f32_16x16x32_bf16 v[160:163], a[132:135], v[36:39], v[160:163]
    ds_read_b128 a[144:147], v1 offset:61440
    v_cvt_pk_bf16_f32 v246, v180, v181
    v_mfma_f32_16x16x32_bf16 v[160:163], a[136:139], v[40:43], v[160:163]
    v_exp_f32 v182, v182
    v_mfma_f32_16x16x32_bf16 v[160:163], a[140:143], v[44:47], v[160:163]
    ds_read_b128 a[148:151], v2 offset:61440
    ds_read_b128 a[152:155], v3 offset:61440
    v_mfma_f32_16x16x32_bf16 v[164:167], a[140:143], v[60:63], v[28:31]
    v_exp_f32 v183, v183
    v_mfma_f32_16x16x32_bf16 v[164:167], a[136:139], v[56:59], v[164:167]
    ds_read_b128 a[156:159], v4 offset:61440
    v_cvt_pk_bf16_f32 v247, v182, v183
    v_mfma_f32_16x16x32_bf16 v[164:167], a[132:135], v[52:55], v[164:167]
    v_exp_f32 v184, v184
    v_mfma_f32_16x16x32_bf16 v[164:167], a[128:131], v[48:51], v[164:167]
    ds_read_b64_tr_b16 a[194:195], v9 offset:36864
    ds_read_b64_tr_b16 a[196:197], v9 offset:40960
    v_mfma_f32_16x16x32_bf16 v[168:171], a[128:131], v[64:67], v[20:23]
    v_exp_f32 v185, v185
    v_mfma_f32_16x16x32_bf16 v[168:171], a[132:135], v[68:71], v[168:171]
    ds_read_b64_tr_b16 a[198:199], v9 offset:45056
    v_cvt_pk_bf16_f32 v250, v184, v185
    v_mfma_f32_16x16x32_bf16 v[168:171], a[136:139], v[72:75], v[168:171]
    v_exp_f32 v186, v186
    v_mfma_f32_16x16x32_bf16 v[168:171], a[140:143], v[76:79], v[168:171]
    ds_read_b64_tr_b16 a[200:201], v10 offset:32768
    ds_read_b64_tr_b16 a[202:203], v10 offset:36864
    v_mfma_f32_16x16x32_bf16 v[172:175], a[140:143], v[92:95], v[124:127]
    v_exp_f32 v187, v187
    v_mfma_f32_16x16x32_bf16 v[172:175], a[136:139], v[88:91], v[172:175]
    ds_read_b64_tr_b16 a[204:205], v10 offset:40960
    v_cvt_pk_bf16_f32 v251, v186, v187
    v_mfma_f32_16x16x32_bf16 v[172:175], a[132:135], v[84:87], v[172:175]
    v_exp_f32 v188, v188
    v_mfma_f32_16x16x32_bf16 v[172:175], a[128:131], v[80:83], v[172:175]
    ds_read_b64_tr_b16 a[206:207], v10 offset:45056
    s_waitcnt lgkmcnt(7)
    v_mfma_f32_16x16x32_bf16 v[176:179], a[144:147], v[32:35], v[24:27]
    v_exp_f32 v189, v189
    v_mfma_f32_16x16x32_bf16 v[176:179], a[148:151], v[36:39], v[176:179]
    ds_read_b64_tr_b16 a[208:209], v11 offset:32768
    v_cvt_pk_bf16_f32 v254, v188, v189
    v_mfma_f32_16x16x32_bf16 v[176:179], a[152:155], v[40:43], v[176:179]
    v_exp_f32 v190, v190
    v_mfma_f32_16x16x32_bf16 v[176:179], a[156:159], v[44:47], v[176:179]
    ds_read_b64_tr_b16 a[210:211], v11 offset:36864
    v_lshlrev_b32 v122, 4, v114
    v_mfma_f32_16x16x32_bf16 v[180:183], a[156:159], v[60:63], v[28:31]
    v_exp_f32 v191, v191
    v_mfma_f32_16x16x32_bf16 v[180:183], a[152:155], v[56:59], v[180:183]
    ds_read_b64_tr_b16 a[212:213], v11 offset:40960
    v_cvt_pk_bf16_f32 v255, v190, v191
    v_mfma_f32_16x16x32_bf16 v[180:183], a[148:151], v[52:55], v[180:183]
    s_mov_b32 s15, 16384
    buffer_load_dwordx4 a[244:247], v122, s[52:55], s15 offen sc1
    v_mfma_f32_16x16x32_bf16 v[180:183], a[144:147], v[48:51], v[180:183]
    ds_read_b64_tr_b16 a[214:215], v11 offset:45056
    v_lshlrev_b32 v107, 3, v114
    v_mfma_f32_16x16x32_bf16 v[184:187], a[144:147], v[64:67], v[20:23]
    s_mov_b32 s14, 17408
    v_mfma_f32_16x16x32_bf16 v[184:187], a[148:151], v[68:71], v[184:187]
    ds_read_b64_tr_b16 a[216:217], v12 offset:32768
    buffer_load_dwordx2 a[248:249], v107, s[52:55], s14 offen sc1
    v_mfma_f32_16x16x32_bf16 v[184:187], a[152:155], v[72:75], v[184:187]
    v_and_b32 v120, 31, v114
    v_mfma_f32_16x16x32_bf16 v[184:187], a[156:159], v[76:79], v[184:187]
    ds_read_b64_tr_b16 a[218:219], v12 offset:36864
    v_lshlrev_b32 v123, 2, v120
    s_waitcnt vmcnt(9)
    v_mfma_f32_16x16x32_bf16 v[188:191], a[156:159], v[92:95], v[124:127]
    v_and_b32 v121, 1, v115
    v_lshlrev_b32 v120, 7, v121
    v_mfma_f32_16x16x32_bf16 v[188:191], a[152:155], v[88:91], v[188:191]
    ds_read_b64_tr_b16 a[220:221], v12 offset:40960
    v_xor_b32 v120, v120, v5
    v_mfma_f32_16x16x32_bf16 v[188:191], a[148:151], v[84:87], v[188:191]
    v_exp_f32 v128, v128
    v_mfma_f32_16x16x32_bf16 v[188:191], a[144:147], v[80:83], v[188:191]
    ds_read_b64_tr_b16 a[222:223], v12 offset:45056
    v_exp_f32 v129, v129
    s_barrier
    v_mfma_f32_16x16x32_bf16 a[0:3], a[160:163], v[224:227], a[0:3]
    v_exp_f32 v130, v130
    v_cvt_pk_bf16_f32 v192, v128, v129
    v_mfma_f32_16x16x32_bf16 a[0:3], a[164:167], v[240:243], a[0:3]
    v_exp_f32 v131, v131
    v_mfma_f32_16x16x32_bf16 a[4:7], a[164:167], v[244:247], a[4:7]
    v_exp_f32 v132, v132
    v_cvt_pk_bf16_f32 v193, v130, v131
    v_mfma_f32_16x16x32_bf16 a[4:7], a[160:163], v[228:231], a[4:7]
    v_exp_f32 v133, v133
    s_add_u32 m0, s26, 131072
    v_mfma_f32_16x16x32_bf16 a[8:11], a[160:163], v[232:235], a[8:11]
    v_exp_f32 v134, v134
    v_cvt_pk_bf16_f32 v196, v132, v133
    v_mfma_f32_16x16x32_bf16 a[8:11], a[164:167], v[248:251], a[8:11]
    buffer_load_dwordx4 v108, s[40:43], s44 offen offset:0 lds
    v_exp_f32 v135, v135
    v_mfma_f32_16x16x32_bf16 a[12:15], a[164:167], v[252:255], a[12:15]
    v_exp_f32 v136, v136
    v_cvt_pk_bf16_f32 v197, v134, v135
    v_mfma_f32_16x16x32_bf16 a[12:15], a[160:163], v[236:239], a[12:15]
    v_exp_f32 v137, v137
    v_mfma_f32_16x16x32_bf16 a[28:31], a[168:171], v[236:239], a[28:31]
    ds_read_b64_tr_b16 a[160:161], v5 offset:49152
    v_exp_f32 v138, v138
    v_cvt_pk_bf16_f32 v200, v136, v137
    v_mfma_f32_16x16x32_bf16 a[28:31], a[172:175], v[252:255], a[28:31]
    v_exp_f32 v139, v139
    v_mfma_f32_16x16x32_bf16 a[24:27], a[172:175], v[248:251], a[24:27]
    ds_read_b64_tr_b16 a[162:163], v5 offset:53248
    v_exp_f32 v140, v140
    v_cvt_pk_bf16_f32 v201, v138, v139
    v_mfma_f32_16x16x32_bf16 a[24:27], a[168:171], v[232:235], a[24:27]
    v_exp_f32 v141, v141
    v_mfma_f32_16x16x32_bf16 a[20:23], a[168:171], v[228:231], a[20:23]
    ds_read_b64_tr_b16 a[164:165], v5 offset:57344
    v_exp_f32 v142, v142
    v_cvt_pk_bf16_f32 v204, v140, v141
    v_mfma_f32_16x16x32_bf16 a[20:23], a[172:175], v[244:247], a[20:23]
    buffer_load_dwordx4 v109, s[40:43], s44 offen offset:1024 lds
    v_exp_f32 v143, v143
    v_mfma_f32_16x16x32_bf16 a[16:19], a[172:175], v[240:243], a[16:19]
    ds_read_b64_tr_b16 a[166:167], v5 offset:61440
    v_exp_f32 v144, v144
    v_cvt_pk_bf16_f32 v205, v142, v143
    v_mfma_f32_16x16x32_bf16 a[16:19], a[168:171], v[224:227], a[16:19]
    v_exp_f32 v145, v145
    v_mfma_f32_16x16x32_bf16 a[32:35], a[176:179], v[224:227], a[32:35]
    ds_read_b64_tr_b16 a[168:169], v6 offset:49152
    v_exp_f32 v146, v146
    v_cvt_pk_bf16_f32 v194, v144, v145
    v_mfma_f32_16x16x32_bf16 a[32:35], a[180:183], v[240:243], a[32:35]
    v_exp_f32 v147, v147
    v_mfma_f32_16x16x32_bf16 a[36:39], a[180:183], v[244:247], a[36:39]
    ds_read_b64_tr_b16 a[170:171], v6 offset:53248
    v_exp_f32 v148, v148
    v_cvt_pk_bf16_f32 v195, v146, v147
    v_mfma_f32_16x16x32_bf16 a[36:39], a[176:179], v[228:231], a[36:39]
    v_exp_f32 v149, v149
    v_mfma_f32_16x16x32_bf16 a[40:43], a[176:179], v[232:235], a[40:43]
    ds_read_b64_tr_b16 a[172:173], v6 offset:57344
    v_exp_f32 v150, v150
    v_cvt_pk_bf16_f32 v198, v148, v149
    v_mfma_f32_16x16x32_bf16 a[40:43], a[180:183], v[248:251], a[40:43]
    buffer_load_dwordx4 v110, s[40:43], s44 offen offset:2048 lds
    v_exp_f32 v151, v151
    v_mfma_f32_16x16x32_bf16 a[44:47], a[180:183], v[252:255], a[44:47]
    ds_read_b64_tr_b16 a[174:175], v6 offset:61440
    v_exp_f32 v152, v152
    v_cvt_pk_bf16_f32 v199, v150, v151
    v_mfma_f32_16x16x32_bf16 a[44:47], a[176:179], v[236:239], a[44:47]
    v_exp_f32 v153, v153
    v_mfma_f32_16x16x32_bf16 a[60:63], a[184:187], v[236:239], a[60:63]
    ds_read_b64_tr_b16 a[176:177], v7 offset:49152
    v_exp_f32 v154, v154
    v_cvt_pk_bf16_f32 v202, v152, v153
    v_mfma_f32_16x16x32_bf16 a[60:63], a[188:191], v[252:255], a[60:63]
    v_exp_f32 v155, v155
    v_mfma_f32_16x16x32_bf16 a[56:59], a[188:191], v[248:251], a[56:59]
    ds_read_b64_tr_b16 a[178:179], v7 offset:53248
    v_exp_f32 v156, v156
    v_cvt_pk_bf16_f32 v203, v154, v155
    v_mfma_f32_16x16x32_bf16 a[56:59], a[184:187], v[232:235], a[56:59]
    v_exp_f32 v157, v157
    s_waitcnt lgkmcnt(10)
    v_mfma_f32_16x16x32_bf16 a[52:55], a[184:187], v[228:231], a[52:55]
    ds_read_b64_tr_b16 a[180:181], v7 offset:57344
    v_exp_f32 v158, v158
    v_cvt_pk_bf16_f32 v206, v156, v157
    v_mfma_f32_16x16x32_bf16 a[52:55], a[188:191], v[244:247], a[52:55]
    buffer_load_dwordx4 v111, s[40:43], s44 offen offset:3072 lds
    v_exp_f32 v159, v159
    v_mfma_f32_16x16x32_bf16 a[48:51], a[188:191], v[240:243], a[48:51]
    ds_read_b64_tr_b16 a[182:183], v7 offset:61440
    v_exp_f32 v160, v160
    v_cvt_pk_bf16_f32 v207, v158, v159
    v_mfma_f32_16x16x32_bf16 a[48:51], a[184:187], v[224:227], a[48:51]
    v_exp_f32 v161, v161
    s_add_u32 s44, s44, 65536
    s_and_b32 s44, s44, 0xfffff
    v_mfma_f32_16x16x32_bf16 a[64:67], a[192:195], v[224:227], a[64:67]
    ds_read_b64_tr_b16 a[184:185], v8 offset:49152
    v_exp_f32 v162, v162
    v_cvt_pk_bf16_f32 v208, v160, v161
    v_mfma_f32_16x16x32_bf16 a[64:67], a[196:199], v[240:243], a[64:67]
    v_exp_f32 v163, v163
    v_mfma_f32_16x16x32_bf16 a[68:71], a[196:199], v[244:247], a[68:71]
    ds_read_b64_tr_b16 a[186:187], v8 offset:53248
    v_exp_f32 v164, v164
    v_cvt_pk_bf16_f32 v209, v162, v163
    v_mfma_f32_16x16x32_bf16 a[68:71], a[192:195], v[228:231], a[68:71]
    v_exp_f32 v165, v165
    s_add_u32 m0, s26, 16384
    v_mfma_f32_16x16x32_bf16 a[72:75], a[192:195], v[232:235], a[72:75]
    ds_read_b64_tr_b16 a[188:189], v8 offset:57344
    v_exp_f32 v166, v166
    v_cvt_pk_bf16_f32 v212, v164, v165
    v_mfma_f32_16x16x32_bf16 a[72:75], a[196:199], v[248:251], a[72:75]
    buffer_load_dwordx4 v108, s[40:43], s44 offen offset:0 lds
    v_exp_f32 v167, v167
    v_mfma_f32_16x16x32_bf16 a[76:79], a[196:199], v[252:255], a[76:79]
    ds_read_b64_tr_b16 a[190:191], v8 offset:61440
    v_exp_f32 v168, v168
    v_cvt_pk_bf16_f32 v213, v166, v167
    v_mfma_f32_16x16x32_bf16 a[76:79], a[192:195], v[236:239], a[76:79]
    v_exp_f32 v169, v169
    v_mfma_f32_16x16x32_bf16 a[92:95], a[200:203], v[236:239], a[92:95]
    ds_read_b64_tr_b16 a[192:193], v9 offset:49152
    v_exp_f32 v170, v170
    v_cvt_pk_bf16_f32 v216, v168, v169
    v_mfma_f32_16x16x32_bf16 a[92:95], a[204:207], v[252:255], a[92:95]
    v_exp_f32 v171, v171
    v_mfma_f32_16x16x32_bf16 a[88:91], a[204:207], v[248:251], a[88:91]
    ds_read_b64_tr_b16 a[194:195], v9 offset:53248
    v_exp_f32 v172, v172
    v_cvt_pk_bf16_f32 v217, v170, v171
    v_mfma_f32_16x16x32_bf16 a[88:91], a[200:203], v[232:235], a[88:91]
    v_exp_f32 v173, v173
    v_mfma_f32_16x16x32_bf16 a[84:87], a[200:203], v[228:231], a[84:87]
    ds_read_b64_tr_b16 a[196:197], v9 offset:57344
    v_exp_f32 v174, v174
    v_cvt_pk_bf16_f32 v220, v172, v173
    v_mfma_f32_16x16x32_bf16 a[84:87], a[204:207], v[244:247], a[84:87]
    buffer_load_dwordx4 v109, s[40:43], s44 offen offset:1024 lds
    v_exp_f32 v175, v175
    v_mfma_f32_16x16x32_bf16 a[80:83], a[204:207], v[240:243], a[80:83]
    ds_read_b64_tr_b16 a[198:199], v9 offset:61440
    v_exp_f32 v176, v176
    v_cvt_pk_bf16_f32 v221, v174, v175
    v_mfma_f32_16x16x32_bf16 a[80:83], a[200:203], v[224:227], a[80:83]
    v_exp_f32 v177, v177
    v_mfma_f32_16x16x32_bf16 a[96:99], a[208:211], v[224:227], a[96:99]
    ds_read_b64_tr_b16 a[200:201], v10 offset:49152
    v_exp_f32 v178, v178
    v_cvt_pk_bf16_f32 v210, v176, v177
    v_mfma_f32_16x16x32_bf16 a[96:99], a[212:215], v[240:243], a[96:99]
    v_exp_f32 v179, v179
    v_mfma_f32_16x16x32_bf16 a[100:103], a[212:215], v[244:247], a[100:103]
    ds_read_b64_tr_b16 a[202:203], v10 offset:53248
    v_exp_f32 v180, v180
    v_cvt_pk_bf16_f32 v211, v178, v179
    v_mfma_f32_16x16x32_bf16 a[100:103], a[208:211], v[228:231], a[100:103]
    v_exp_f32 v181, v181
    v_mfma_f32_16x16x32_bf16 a[104:107], a[208:211], v[232:235], a[104:107]
    ds_read_b64_tr_b16 a[204:205], v10 offset:57344
    v_exp_f32 v182, v182
    v_cvt_pk_bf16_f32 v214, v180, v181
    v_mfma_f32_16x16x32_bf16 a[104:107], a[212:215], v[248:251], a[104:107]
    buffer_load_dwordx4 v110, s[40:43], s44 offen offset:2048 lds
    v_exp_f32 v183, v183
    v_mfma_f32_16x16x32_bf16 a[108:111], a[212:215], v[252:255], a[108:111]
    ds_read_b64_tr_b16 a[206:207], v10 offset:61440
    v_exp_f32 v184, v184
    v_cvt_pk_bf16_f32 v215, v182, v183
    v_mfma_f32_16x16x32_bf16 a[108:111], a[208:211], v[236:239], a[108:111]
    v_exp_f32 v185, v185
    v_mfma_f32_16x16x32_bf16 a[124:127], a[216:219], v[236:239], a[124:127]
    ds_read_b64_tr_b16 a[208:209], v11 offset:49152
    v_exp_f32 v186, v186
    v_cvt_pk_bf16_f32 v218, v184, v185
    v_mfma_f32_16x16x32_bf16 a[124:127], a[220:223], v[252:255], a[124:127]
    v_exp_f32 v187, v187
    v_mfma_f32_16x16x32_bf16 a[120:123], a[220:223], v[248:251], a[120:123]
    ds_read_b64_tr_b16 a[210:211], v11 offset:53248
    v_exp_f32 v188, v188
    v_cvt_pk_bf16_f32 v219, v186, v187
    v_mfma_f32_16x16x32_bf16 a[120:123], a[216:219], v[232:235], a[120:123]
    v_exp_f32 v189, v189
    v_mfma_f32_16x16x32_bf16 a[116:119], a[216:219], v[228:231], a[116:119]
    ds_read_b64_tr_b16 a[212:213], v11 offset:57344
    v_exp_f32 v190, v190
    v_cvt_pk_bf16_f32 v222, v188, v189
    v_mfma_f32_16x16x32_bf16 a[116:119], a[220:223], v[244:247], a[116:119]
    buffer_load_dwordx4 v111, s[40:43], s44 offen offset:3072 lds
    v_exp_f32 v191, v191
    v_mfma_f32_16x16x32_bf16 a[112:115], a[220:223], v[240:243], a[112:115]
    ds_read_b64_tr_b16 a[214:215], v11 offset:61440
    v_cvt_pk_bf16_f32 v223, v190, v191
    v_mfma_f32_16x16x32_bf16 a[112:115], a[216:219], v[224:227], a[112:115]
    s_add_u32 s44, s44, 65536
    s_and_b32 s44, s44, 0xfffff
    v_mfma_f32_16x16x32_bf16 a[224:227], a[240:243], v[224:227], a[224:227]
    ds_read_b64_tr_b16 a[216:217], v12 offset:49152
    v_mfma_f32_16x16x32_bf16 a[224:227], a[240:243], v[240:243], a[224:227]
    v_mfma_f32_16x16x32_bf16 a[228:231], a[240:243], v[244:247], a[228:231]
    ds_read_b64_tr_b16 a[218:219], v12 offset:53248
    v_mfma_f32_16x16x32_bf16 a[228:231], a[240:243], v[228:231], a[228:231]
    v_mfma_f32_16x16x32_bf16 a[232:235], a[240:243], v[232:235], a[232:235]
    ds_read_b64_tr_b16 a[220:221], v12 offset:57344
    v_mfma_f32_16x16x32_bf16 a[232:235], a[240:243], v[248:251], a[232:235]
    v_mfma_f32_16x16x32_bf16 a[236:239], a[240:243], v[252:255], a[236:239]
    ds_read_b64_tr_b16 a[222:223], v12 offset:61440
    v_mfma_f32_16x16x32_bf16 a[236:239], a[240:243], v[236:239], a[236:239]
    v_mfma_f32_16x16x32_bf16 a[224:227], a[240:243], v[192:195], a[224:227]
    v_mfma_f32_16x16x32_bf16 a[224:227], a[240:243], v[208:211], a[224:227]
    v_mfma_f32_16x16x32_bf16 a[228:231], a[240:243], v[212:215], a[228:231]
    v_subrev_u32 v102, 0x10000, v120
    v_mfma_f32_16x16x32_bf16 a[228:231], a[240:243], v[196:199], a[228:231]
    s_add_u32 m0, s26, 147456
    v_mfma_f32_16x16x32_bf16 a[232:235], a[240:243], v[200:203], a[232:235]
    v_xor_b32 v103, 32, v102
    v_mfma_f32_16x16x32_bf16 a[232:235], a[240:243], v[216:219], a[232:235]
    buffer_load_dwordx4 v108, s[40:43], s44 offen offset:0 lds
    v_mfma_f32_16x16x32_bf16 a[236:239], a[240:243], v[220:223], a[236:239]
    v_xor_b32 v104, 64, v102
    v_mfma_f32_16x16x32_bf16 a[236:239], a[240:243], v[204:207], a[236:239]
    s_waitcnt lgkmcnt(15)
    v_mfma_f32_16x16x32_bf16 a[12:15], a[160:163], v[204:207], a[12:15]
    v_xor_b32 v105, 96, v102
    v_mfma_f32_16x16x32_bf16 a[12:15], a[164:167], v[220:223], a[12:15]
    v_mfma_f32_16x16x32_bf16 a[8:11], a[164:167], v[216:219], a[8:11]
    v_add_u32 v96, 0x20000, v102
    v_mfma_f32_16x16x32_bf16 a[8:11], a[160:163], v[200:203], a[8:11]
    v_mfma_f32_16x16x32_bf16 a[4:7], a[160:163], v[196:199], a[4:7]
    v_add_u32 v97, 0x20000, v103
    v_mfma_f32_16x16x32_bf16 a[4:7], a[164:167], v[212:215], a[4:7]
    buffer_load_dwordx4 v109, s[40:43], s44 offen offset:1024 lds
    v_mfma_f32_16x16x32_bf16 a[0:3], a[164:167], v[208:211], a[0:3]
    v_add_u32 v98, 0x20000, v104
    v_mfma_f32_16x16x32_bf16 a[0:3], a[160:163], v[192:195], a[0:3]
    v_mfma_f32_16x16x32_bf16 a[16:19], a[168:171], v[192:195], a[16:19]
    v_add_u32 v99, 0x20000, v105
    v_mfma_f32_16x16x32_bf16 a[16:19], a[172:175], v[208:211], a[16:19]
    v_mfma_f32_16x16x32_bf16 a[20:23], a[172:175], v[212:215], a[20:23]
    v_lshrrev_b32 v120, 1, v115
    v_mfma_f32_16x16x32_bf16 a[20:23], a[168:171], v[196:199], a[20:23]
    v_mfma_f32_16x16x32_bf16 a[24:27], a[168:171], v[200:203], a[24:27]
    v_lshl_add_u32 v100, v120, 13, v122
    v_mfma_f32_16x16x32_bf16 a[24:27], a[172:175], v[216:219], a[24:27]
    buffer_load_dwordx4 v110, s[40:43], s44 offen offset:2048 lds
    v_mfma_f32_16x16x32_bf16 a[28:31], a[172:175], v[220:223], a[28:31]
    v_add_u32 v106, 0x10000, v100
    v_mfma_f32_16x16x32_bf16 a[28:31], a[168:171], v[204:207], a[28:31]
    v_mfma_f32_16x16x32_bf16 a[44:47], a[176:179], v[204:207], a[44:47]
    v_lshl_add_u32 v116, v115, 18, v122
    v_mfma_f32_16x16x32_bf16 a[44:47], a[180:183], v[220:223], a[44:47]
    v_mfma_f32_16x16x32_bf16 a[40:43], a[180:183], v[216:219], a[40:43]
    v_add_u32 v117, 129024, v116
    v_mfma_f32_16x16x32_bf16 a[40:43], a[176:179], v[200:203], a[40:43]
    v_mfma_f32_16x16x32_bf16 a[36:39], a[176:179], v[196:199], a[36:39]
    v_lshl_add_u32 v100, v120, 16, v122
    v_mfma_f32_16x16x32_bf16 a[36:39], a[180:183], v[212:215], a[36:39]
    buffer_load_dwordx4 v111, s[40:43], s44 offen offset:3072 lds
    v_mfma_f32_16x16x32_bf16 a[32:35], a[180:183], v[208:211], a[32:35]
    v_lshl_add_u32 v118, v121, 11, v100
    v_accvgpr_read_b32 v241, a224
    v_accvgpr_read_b32 v243, a228
    v_mfma_f32_16x16x32_bf16 a[32:35], a[176:179], v[192:195], a[32:35]
    s_add_u32 s44, s44, 65536
    s_and_b32 s44, s44, 0xfffff
    v_accvgpr_read_b32 v245, a232
    v_accvgpr_read_b32 v247, a236
    v_mfma_f32_16x16x32_bf16 a[48:51], a[184:187], v[192:195], a[48:51]
    v_add_u32 v119, 32768, v118
    s_mov_b32 s31, 131072
    v_mov_b32 v250, 0
    v_mfma_f32_16x16x32_bf16 a[48:51], a[188:191], v[208:211], a[48:51]
    v_mov_b32 v251, 0
    v_rcp_f32 v240, v241
    v_mfma_f32_16x16x32_bf16 a[52:55], a[188:191], v[212:215], a[52:55]
    v_rcp_f32 v242, v243
    v_rcp_f32 v244, v245
    v_mfma_f32_16x16x32_bf16 a[52:55], a[184:187], v[196:199], a[52:55]
    s_add_u32 m0, s26, 32768
    v_rcp_f32 v246, v247
    v_max3_f32 v248, v241, v243, v245
    v_mfma_f32_16x16x32_bf16 a[56:59], a[184:187], v[200:203], a[56:59]
    v_add_f32 v249, v241, v243
    v_max_f32 v248, v248, v247
    v_mfma_f32_16x16x32_bf16 a[56:59], a[188:191], v[216:219], a[56:59]
    buffer_load_dwordx4 v108, s[40:43], s44 offen offset:0 lds
    v_add_f32 v249, v249, v245
    v_mul_f32 v248, 0x43800000, v248
    v_mfma_f32_16x16x32_bf16 a[60:63], a[188:191], v[220:223], a[60:63]
    v_add_f32 v249, v249, v247
    v_mul_f32 v248, 0, v248
    v_mfma_f32_16x16x32_bf16 a[60:63], a[184:187], v[204:207], a[60:63]
    v_mul_f32 v249, 0, v249
    v_mov_b32 v241, v240
    s_waitcnt lgkmcnt(12)
    v_mfma_f32_16x16x32_bf16 a[76:79], a[192:195], v[204:207], a[76:79]
    v_mov_b32 v243, v242
    v_mov_b32 v245, v244
    v_mfma_f32_16x16x32_bf16 a[76:79], a[196:199], v[220:223], a[76:79]
    v_mov_b32 v247, v246
    s_lshr_b32 s33, s38, 1
    v_mfma_f32_16x16x32_bf16 a[72:75], a[196:199], v[216:219], a[72:75]
    s_xor_b32 s33, s33, s46
    s_and_b32 s33, s33, 1
    v_mfma_f32_16x16x32_bf16 a[72:75], a[192:195], v[200:203], a[72:75]
    s_lshl_b32 s33, s33, 2
    s_and_b32 s34, s38, 1
    v_mfma_f32_16x16x32_bf16 a[68:71], a[192:195], v[196:199], a[68:71]
    s_add_u32 s33, s33, s34
    s_lshl_b32 s33, s33, 13
    v_mfma_f32_16x16x32_bf16 a[68:71], a[196:199], v[212:215], a[68:71]
    buffer_load_dwordx4 v109, s[40:43], s44 offen offset:1024 lds
    s_add_u32 s33, s33, 65536
    v_and_b32 v252, 63, v0
    v_mfma_f32_16x16x32_bf16 a[64:67], a[196:199], v[208:211], a[64:67]
    v_lshl_add_u32 v252, v252, 4, s33
    v_accvgpr_read_b32 v128, a0
    v_mfma_f32_16x16x32_bf16 a[64:67], a[192:195], v[192:195], a[64:67]
    v_accvgpr_read_b32 v129, a1
    v_accvgpr_read_b32 v130, a2
    s_waitcnt lgkmcnt(8)
    v_mfma_f32_16x16x32_bf16 a[80:83], a[200:203], v[192:195], a[80:83]
    v_accvgpr_read_b32 v131, a3
    v_accvgpr_read_b32 v132, a16
    v_mfma_f32_16x16x32_bf16 a[80:83], a[204:207], v[208:211], a[80:83]
    v_accvgpr_read_b32 v133, a17
    v_accvgpr_read_b32 v134, a18
    v_mfma_f32_16x16x32_bf16 a[84:87], a[204:207], v[212:215], a[84:87]
    v_accvgpr_read_b32 v135, a19
    v_accvgpr_read_b32 v136, a4
    v_mfma_f32_16x16x32_bf16 a[84:87], a[200:203], v[196:199], a[84:87]
    v_accvgpr_read_b32 v137, a5
    v_accvgpr_read_b32 v138, a6
    v_mfma_f32_16x16x32_bf16 a[88:91], a[200:203], v[200:203], a[88:91]
    v_accvgpr_read_b32 v139, a7
    v_accvgpr_read_b32 v140, a20
    v_mfma_f32_16x16x32_bf16 a[88:91], a[204:207], v[216:219], a[88:91]
    buffer_load_dwordx4 v110, s[40:43], s44 offen offset:2048 lds
    v_accvgpr_read_b32 v141, a21
    v_accvgpr_read_b32 v142, a22
    v_mfma_f32_16x16x32_bf16 a[92:95], a[204:207], v[220:223], a[92:95]
    v_accvgpr_read_b32 v143, a23
    v_accvgpr_read_b32 v144, a8
    v_mfma_f32_16x16x32_bf16 a[92:95], a[200:203], v[204:207], a[92:95]
    v_accvgpr_read_b32 v145, a9
    v_accvgpr_read_b32 v146, a10
    s_waitcnt lgkmcnt(4)
    v_mfma_f32_16x16x32_bf16 a[108:111], a[208:211], v[204:207], a[108:111]
    v_accvgpr_read_b32 v147, a11
    v_accvgpr_read_b32 v148, a24
    v_mfma_f32_16x16x32_bf16 a[108:111], a[212:215], v[220:223], a[108:111]
    v_accvgpr_read_b32 v149, a25
    v_accvgpr_read_b32 v150, a26
    v_mfma_f32_16x16x32_bf16 a[104:107], a[212:215], v[216:219], a[104:107]
    v_accvgpr_read_b32 v151, a27
    v_accvgpr_read_b32 v152, a12
    v_mfma_f32_16x16x32_bf16 a[104:107], a[208:211], v[200:203], a[104:107]
    v_accvgpr_read_b32 v153, a13
    v_accvgpr_read_b32 v154, a14
    v_mfma_f32_16x16x32_bf16 a[100:103], a[208:211], v[196:199], a[100:103]
    v_accvgpr_read_b32 v155, a15
    v_accvgpr_read_b32 v156, a28
    v_mfma_f32_16x16x32_bf16 a[100:103], a[212:215], v[212:215], a[100:103]
    buffer_load_dwordx4 v111, s[40:43], s44 offen offset:3072 lds
    v_accvgpr_read_b32 v157, a29
    v_accvgpr_read_b32 v158, a30
    v_mfma_f32_16x16x32_bf16 a[96:99], a[212:215], v[208:211], a[96:99]
    v_accvgpr_read_b32 v159, a31
    v_mul_f32 v128, v128, v240
    v_mfma_f32_16x16x32_bf16 a[96:99], a[208:211], v[192:195], a[96:99]
    s_add_u32 s44, s44, 65536
    s_and_b32 s44, s44, 0xfffff
    v_mul_f32 v129, v129, v240
    v_mul_f32 v130, v130, v240
    s_waitcnt lgkmcnt(0)
    v_mfma_f32_16x16x32_bf16 a[112:115], a[216:219], v[192:195], a[112:115]
    v_mul_f32 v131, v131, v240
    v_mul_f32 v132, v132, v240
    v_mfma_f32_16x16x32_bf16 a[112:115], a[220:223], v[208:211], a[112:115]
    v_mul_f32 v133, v133, v240
    v_mul_f32 v134, v134, v240
    v_mfma_f32_16x16x32_bf16 a[116:119], a[220:223], v[212:215], a[116:119]
    v_mul_f32 v135, v135, v240
    v_mul_f32 v136, v136, v242
    v_mfma_f32_16x16x32_bf16 a[116:119], a[216:219], v[196:199], a[116:119]
    v_mul_f32 v137, v137, v242
    v_mul_f32 v138, v138, v242
    v_mfma_f32_16x16x32_bf16 a[120:123], a[216:219], v[200:203], a[120:123]
    v_mul_f32 v139, v139, v242
    v_mul_f32 v140, v140, v242
    v_mfma_f32_16x16x32_bf16 a[120:123], a[220:223], v[216:219], a[120:123]
    v_mul_f32 v141, v141, v242
    v_mul_f32 v142, v142, v242
    v_mfma_f32_16x16x32_bf16 a[124:127], a[220:223], v[220:223], a[124:127]
    v_mul_f32 v143, v143, v242
    v_mul_f32 v144, v144, v244
    v_mfma_f32_16x16x32_bf16 a[124:127], a[216:219], v[204:207], a[124:127]
    v_mul_f32 v145, v145, v244
    v_mul_f32 v146, v146, v244
    v_mul_f32 v147, v147, v244
    v_mul_f32 v148, v148, v244
    v_mul_f32 v149, v149, v244
    v_mul_f32 v150, v150, v244
    v_mul_f32 v151, v151, v244
    v_mul_f32 v152, v152, v246
    v_mul_f32 v153, v153, v246
    v_mul_f32 v154, v154, v246
    v_mul_f32 v155, v155, v246
    v_mul_f32 v156, v156, v246
    v_mul_f32 v157, v157, v246
    v_mul_f32 v158, v158, v246
    v_mul_f32 v159, v159, v246
    v_cvt_pk_bf16_f32 v160, v128, v129
    v_cvt_pk_bf16_f32 v161, v130, v131
    v_cvt_pk_bf16_f32 v162, v132, v133
    v_cvt_pk_bf16_f32 v163, v134, v135
    buffer_store_dwordx4 v[160:163], v101, s[20:23], 0 offen offset:0
    ds_write_b128 v252, v[160:163] offset:0
    v_cvt_pk_bf16_f32 v164, v136, v137
    v_cvt_pk_bf16_f32 v165, v138, v139
    v_cvt_pk_bf16_f32 v166, v140, v141
    v_cvt_pk_bf16_f32 v167, v142, v143
    buffer_store_dwordx4 v[164:167], v101, s[20:23], s31 offen offset:0
    ds_write_b128 v252, v[164:167] offset:2048
    v_cvt_pk_bf16_f32 v168, v144, v145
    v_cvt_pk_bf16_f32 v169, v146, v147
    v_cvt_pk_bf16_f32 v170, v148, v149
    v_cvt_pk_bf16_f32 v171, v150, v151
    buffer_store_dwordx4 v[168:171], v19, s[20:23], 0 offen offset:0
    ds_write_b128 v252, v[168:171] offset:4096
    v_cvt_pk_bf16_f32 v172, v152, v153
    v_cvt_pk_bf16_f32 v173, v154, v155
    v_cvt_pk_bf16_f32 v174, v156, v157
    v_cvt_pk_bf16_f32 v175, v158, v159
    buffer_store_dwordx4 v[172:175], v19, s[20:23], s31 offen offset:0
    ds_write_b128 v252, v[172:175] offset:6144
    v_accvgpr_read_b32 v128, a32
    v_accvgpr_read_b32 v129, a33
    v_accvgpr_read_b32 v130, a34
    v_accvgpr_read_b32 v131, a35
    v_accvgpr_read_b32 v132, a48
    v_accvgpr_read_b32 v133, a49
    v_accvgpr_read_b32 v134, a50
    v_accvgpr_read_b32 v135, a51
    v_pk_mul_f32 v[128:129], v[128:129], v[240:241]
    v_pk_mul_f32 v[130:131], v[130:131], v[240:241]
    v_pk_mul_f32 v[132:133], v[132:133], v[240:241]
    v_pk_mul_f32 v[134:135], v[134:135], v[240:241]
    v_cvt_pk_bf16_f32 v176, v128, v129
    v_cvt_pk_bf16_f32 v177, v130, v131
    v_cvt_pk_bf16_f32 v178, v132, v133
    v_cvt_pk_bf16_f32 v179, v134, v135
    buffer_store_dwordx4 v[176:179], v101, s[20:23], 0 offen offset:1024
    ds_write_b128 v252, v[176:179] offset:1024
    v_accvgpr_read_b32 v136, a36
    v_accvgpr_read_b32 v137, a37
    v_accvgpr_read_b32 v138, a38
    v_accvgpr_read_b32 v139, a39
    v_accvgpr_read_b32 v140, a52
    v_accvgpr_read_b32 v141, a53
    v_accvgpr_read_b32 v142, a54
    v_accvgpr_read_b32 v143, a55
    v_pk_mul_f32 v[136:137], v[136:137], v[242:243]
    v_pk_mul_f32 v[138:139], v[138:139], v[242:243]
    v_pk_mul_f32 v[140:141], v[140:141], v[242:243]
    v_pk_mul_f32 v[142:143], v[142:143], v[242:243]
    v_cvt_pk_bf16_f32 v180, v136, v137
    v_cvt_pk_bf16_f32 v181, v138, v139
    v_cvt_pk_bf16_f32 v182, v140, v141
    v_cvt_pk_bf16_f32 v183, v142, v143
    buffer_store_dwordx4 v[180:183], v101, s[20:23], s31 offen offset:1024
    ds_write_b128 v252, v[180:183] offset:3072
    v_accvgpr_read_b32 v144, a40
    v_accvgpr_read_b32 v145, a41
    v_accvgpr_read_b32 v146, a42
    v_accvgpr_read_b32 v147, a43
    v_accvgpr_read_b32 v148, a56
    v_accvgpr_read_b32 v149, a57
    v_accvgpr_read_b32 v150, a58
    v_accvgpr_read_b32 v151, a59
    v_pk_mul_f32 v[144:145], v[144:145], v[244:245]
    v_pk_mul_f32 v[146:147], v[146:147], v[244:245]
    v_pk_mul_f32 v[148:149], v[148:149], v[244:245]
    v_pk_mul_f32 v[150:151], v[150:151], v[244:245]
    v_cvt_pk_bf16_f32 v184, v144, v145
    v_cvt_pk_bf16_f32 v185, v146, v147
    v_cvt_pk_bf16_f32 v186, v148, v149
    v_cvt_pk_bf16_f32 v187, v150, v151
    buffer_store_dwordx4 v[184:187], v19, s[20:23], 0 offen offset:1024
    ds_write_b128 v252, v[184:187] offset:5120
    v_accvgpr_read_b32 v152, a44
    v_accvgpr_read_b32 v153, a45
    v_accvgpr_read_b32 v154, a46
    v_accvgpr_read_b32 v155, a47
    v_accvgpr_read_b32 v156, a60
    v_accvgpr_read_b32 v157, a61
    v_accvgpr_read_b32 v158, a62
    v_accvgpr_read_b32 v159, a63
    v_pk_mul_f32 v[152:153], v[152:153], v[246:247]
    v_pk_mul_f32 v[154:155], v[154:155], v[246:247]
    v_pk_mul_f32 v[156:157], v[156:157], v[246:247]
    v_pk_mul_f32 v[158:159], v[158:159], v[246:247]
    v_cvt_pk_bf16_f32 v188, v152, v153
    v_cvt_pk_bf16_f32 v189, v154, v155
    v_cvt_pk_bf16_f32 v190, v156, v157
    v_cvt_pk_bf16_f32 v191, v158, v159
    buffer_store_dwordx4 v[188:191], v19, s[20:23], s31 offen offset:1024
    ds_write_b128 v252, v[188:191] offset:7168
    v_accvgpr_read_b32 v128, a64
    v_accvgpr_read_b32 v129, a65
    v_accvgpr_read_b32 v130, a66
    v_accvgpr_read_b32 v131, a67
    v_accvgpr_read_b32 v132, a80
    v_accvgpr_read_b32 v133, a81
    v_accvgpr_read_b32 v134, a82
    v_accvgpr_read_b32 v135, a83
    v_pk_mul_f32 v[128:129], v[128:129], v[240:241]
    v_pk_mul_f32 v[130:131], v[130:131], v[240:241]
    v_pk_mul_f32 v[132:133], v[132:133], v[240:241]
    v_pk_mul_f32 v[134:135], v[134:135], v[240:241]
    v_cvt_pk_bf16_f32 v192, v128, v129
    v_cvt_pk_bf16_f32 v193, v130, v131
    v_cvt_pk_bf16_f32 v194, v132, v133
    v_cvt_pk_bf16_f32 v195, v134, v135
    buffer_store_dwordx4 v[192:195], v101, s[20:23], 0 offen offset:2048
    ds_write_b128 v252, v[192:195] offset:16384
    v_accvgpr_read_b32 v136, a68
    v_accvgpr_read_b32 v137, a69
    v_accvgpr_read_b32 v138, a70
    v_accvgpr_read_b32 v139, a71
    v_accvgpr_read_b32 v140, a84
    v_accvgpr_read_b32 v141, a85
    v_accvgpr_read_b32 v142, a86
    v_accvgpr_read_b32 v143, a87
    v_pk_mul_f32 v[136:137], v[136:137], v[242:243]
    v_pk_mul_f32 v[138:139], v[138:139], v[242:243]
    v_pk_mul_f32 v[140:141], v[140:141], v[242:243]
    v_pk_mul_f32 v[142:143], v[142:143], v[242:243]
    v_cvt_pk_bf16_f32 v196, v136, v137
    v_cvt_pk_bf16_f32 v197, v138, v139
    v_cvt_pk_bf16_f32 v198, v140, v141
    v_cvt_pk_bf16_f32 v199, v142, v143
    buffer_store_dwordx4 v[196:199], v101, s[20:23], s31 offen offset:2048
    ds_write_b128 v252, v[196:199] offset:18432
    v_accvgpr_read_b32 v144, a72
    v_accvgpr_read_b32 v145, a73
    v_accvgpr_read_b32 v146, a74
    v_accvgpr_read_b32 v147, a75
    v_accvgpr_read_b32 v148, a88
    v_accvgpr_read_b32 v149, a89
    v_accvgpr_read_b32 v150, a90
    v_accvgpr_read_b32 v151, a91
    v_pk_mul_f32 v[144:145], v[144:145], v[244:245]
    v_pk_mul_f32 v[146:147], v[146:147], v[244:245]
    v_pk_mul_f32 v[148:149], v[148:149], v[244:245]
    v_pk_mul_f32 v[150:151], v[150:151], v[244:245]
    v_cvt_pk_bf16_f32 v200, v144, v145
    v_cvt_pk_bf16_f32 v201, v146, v147
    v_cvt_pk_bf16_f32 v202, v148, v149
    v_cvt_pk_bf16_f32 v203, v150, v151
    buffer_store_dwordx4 v[200:203], v19, s[20:23], 0 offen offset:2048
    ds_write_b128 v252, v[200:203] offset:20480
    v_accvgpr_read_b32 v152, a76
    v_accvgpr_read_b32 v153, a77
    v_accvgpr_read_b32 v154, a78
    v_accvgpr_read_b32 v155, a79
    v_accvgpr_read_b32 v156, a92
    v_accvgpr_read_b32 v157, a93
    v_accvgpr_read_b32 v158, a94
    v_accvgpr_read_b32 v159, a95
    v_pk_mul_f32 v[152:153], v[152:153], v[246:247]
    v_pk_mul_f32 v[154:155], v[154:155], v[246:247]
    v_pk_mul_f32 v[156:157], v[156:157], v[246:247]
    v_pk_mul_f32 v[158:159], v[158:159], v[246:247]
    v_cvt_pk_bf16_f32 v204, v152, v153
    v_cvt_pk_bf16_f32 v205, v154, v155
    v_cvt_pk_bf16_f32 v206, v156, v157
    v_cvt_pk_bf16_f32 v207, v158, v159
    buffer_store_dwordx4 v[204:207], v19, s[20:23], s31 offen offset:2048
    ds_write_b128 v252, v[204:207] offset:22528
    v_accvgpr_read_b32 v128, a96
    v_accvgpr_read_b32 v129, a97
    v_accvgpr_read_b32 v130, a98
    v_accvgpr_read_b32 v131, a99
    v_accvgpr_read_b32 v132, a112
    v_accvgpr_read_b32 v133, a113
    v_accvgpr_read_b32 v134, a114
    v_accvgpr_read_b32 v135, a115
    v_pk_mul_f32 v[128:129], v[128:129], v[240:241]
    v_pk_mul_f32 v[130:131], v[130:131], v[240:241]
    v_pk_mul_f32 v[132:133], v[132:133], v[240:241]
    v_pk_mul_f32 v[134:135], v[134:135], v[240:241]
    v_cvt_pk_bf16_f32 v208, v128, v129
    v_cvt_pk_bf16_f32 v209, v130, v131
    v_cvt_pk_bf16_f32 v210, v132, v133
    v_cvt_pk_bf16_f32 v211, v134, v135
    buffer_store_dwordx4 v[208:211], v101, s[20:23], 0 offen offset:3072
    ds_write_b128 v252, v[208:211] offset:17408
    v_accvgpr_read_b32 v136, a100
    v_accvgpr_read_b32 v137, a101
    v_accvgpr_read_b32 v138, a102
    v_accvgpr_read_b32 v139, a103
    v_accvgpr_read_b32 v140, a116
    v_accvgpr_read_b32 v141, a117
    v_accvgpr_read_b32 v142, a118
    v_accvgpr_read_b32 v143, a119
    v_pk_mul_f32 v[136:137], v[136:137], v[242:243]
    v_pk_mul_f32 v[138:139], v[138:139], v[242:243]
    v_pk_mul_f32 v[140:141], v[140:141], v[242:243]
    v_pk_mul_f32 v[142:143], v[142:143], v[242:243]
    v_cvt_pk_bf16_f32 v212, v136, v137
    v_cvt_pk_bf16_f32 v213, v138, v139
    v_cvt_pk_bf16_f32 v214, v140, v141
    v_cvt_pk_bf16_f32 v215, v142, v143
    buffer_store_dwordx4 v[212:215], v101, s[20:23], s31 offen offset:3072
    ds_write_b128 v252, v[212:215] offset:19456
    v_accvgpr_read_b32 v144, a104
    v_accvgpr_read_b32 v145, a105
    v_accvgpr_read_b32 v146, a106
    v_accvgpr_read_b32 v147, a107
    v_accvgpr_read_b32 v148, a120
    v_accvgpr_read_b32 v149, a121
    v_accvgpr_read_b32 v150, a122
    v_accvgpr_read_b32 v151, a123
    v_pk_mul_f32 v[144:145], v[144:145], v[244:245]
    v_pk_mul_f32 v[146:147], v[146:147], v[244:245]
    v_pk_mul_f32 v[148:149], v[148:149], v[244:245]
    v_pk_mul_f32 v[150:151], v[150:151], v[244:245]
    v_cvt_pk_bf16_f32 v216, v144, v145
    v_cvt_pk_bf16_f32 v217, v146, v147
    v_cvt_pk_bf16_f32 v218, v148, v149
    v_cvt_pk_bf16_f32 v219, v150, v151
    buffer_store_dwordx4 v[216:219], v19, s[20:23], 0 offen offset:3072
    ds_write_b128 v252, v[216:219] offset:21504
    v_accvgpr_read_b32 v152, a108
    v_accvgpr_read_b32 v153, a109
    v_accvgpr_read_b32 v154, a110
    v_accvgpr_read_b32 v155, a111
    v_accvgpr_read_b32 v156, a124
    v_accvgpr_read_b32 v157, a125
    v_accvgpr_read_b32 v158, a126
    v_accvgpr_read_b32 v159, a127
    v_pk_mul_f32 v[152:153], v[152:153], v[246:247]
    v_pk_mul_f32 v[154:155], v[154:155], v[246:247]
    v_pk_mul_f32 v[156:157], v[156:157], v[246:247]
    v_pk_mul_f32 v[158:159], v[158:159], v[246:247]
    v_cvt_pk_bf16_f32 v220, v152, v153
    v_cvt_pk_bf16_f32 v221, v154, v155
    v_cvt_pk_bf16_f32 v222, v156, v157
    v_cvt_pk_bf16_f32 v223, v158, v159
    buffer_store_dwordx4 v[220:223], v19, s[20:23], s31 offen offset:3072
    ds_write_b128 v252, v[220:223] offset:23552
    v_pk_fma_f16 v253, v160, v250, v250
    v_pk_fma_f16 v251, v161, v250, v250
    v_pk_fma_f16 v253, v162, v250, v253
    v_pk_fma_f16 v251, v163, v250, v251
    v_pk_fma_f16 v253, v164, v250, v253
    v_pk_fma_f16 v251, v165, v250, v251
    v_pk_fma_f16 v253, v166, v250, v253
    v_pk_fma_f16 v251, v167, v250, v251
    v_pk_fma_f16 v253, v168, v250, v253
    v_pk_fma_f16 v251, v169, v250, v251
    v_pk_fma_f16 v253, v170, v250, v253
    v_pk_fma_f16 v251, v171, v250, v251
    v_pk_fma_f16 v253, v172, v250, v253
    v_pk_fma_f16 v251, v173, v250, v251
    v_pk_fma_f16 v253, v174, v250, v253
    v_pk_fma_f16 v251, v175, v250, v251
    v_pk_fma_f16 v253, v176, v250, v253
    v_pk_fma_f16 v251, v177, v250, v251
    v_pk_fma_f16 v253, v178, v250, v253
    v_pk_fma_f16 v251, v179, v250, v251
    v_pk_fma_f16 v253, v180, v250, v253
    v_pk_fma_f16 v251, v181, v250, v251
    v_pk_fma_f16 v253, v182, v250, v253
    v_pk_fma_f16 v251, v183, v250, v251
    v_pk_fma_f16 v253, v184, v250, v253
    v_pk_fma_f16 v251, v185, v250, v251
    v_pk_fma_f16 v253, v186, v250, v253
    v_pk_fma_f16 v251, v187, v250, v251
    v_pk_fma_f16 v253, v188, v250, v253
    v_pk_fma_f16 v251, v189, v250, v251
    v_pk_fma_f16 v253, v190, v250, v253
    v_pk_fma_f16 v251, v191, v250, v251
    v_pk_fma_f16 v253, v192, v250, v253
    v_pk_fma_f16 v251, v193, v250, v251
    v_pk_fma_f16 v253, v194, v250, v253
    v_pk_fma_f16 v251, v195, v250, v251
    v_pk_fma_f16 v253, v196, v250, v253
    v_pk_fma_f16 v251, v197, v250, v251
    v_pk_fma_f16 v253, v198, v250, v253
    v_pk_fma_f16 v251, v199, v250, v251
    v_pk_fma_f16 v253, v200, v250, v253
    v_pk_fma_f16 v251, v201, v250, v251
    v_pk_fma_f16 v253, v202, v250, v253
    v_pk_fma_f16 v251, v203, v250, v251
    v_pk_fma_f16 v253, v204, v250, v253
    v_pk_fma_f16 v251, v205, v250, v251
    v_pk_fma_f16 v253, v206, v250, v253
    v_pk_fma_f16 v251, v207, v250, v251
    v_pk_fma_f16 v253, v208, v250, v253
    v_pk_fma_f16 v251, v209, v250, v251
    v_pk_fma_f16 v253, v210, v250, v253
    v_pk_fma_f16 v251, v211, v250, v251
    v_pk_fma_f16 v253, v212, v250, v253
    v_pk_fma_f16 v251, v213, v250, v251
    v_pk_fma_f16 v253, v214, v250, v253
    v_pk_fma_f16 v251, v215, v250, v251
    v_pk_fma_f16 v253, v216, v250, v253
    v_pk_fma_f16 v251, v217, v250, v251
    v_pk_fma_f16 v253, v218, v250, v253
    v_pk_fma_f16 v251, v219, v250, v251
    v_pk_fma_f16 v253, v220, v250, v253
    v_pk_fma_f16 v251, v221, v250, v251
    v_pk_fma_f16 v253, v222, v250, v253
    v_pk_fma_f16 v251, v223, v250, v251
    v_pk_add_f16 v251, v251, v253
    v_cvt_f32_f16 v253, v251
    v_lshrrev_b32 v251, 16, v251
    v_cvt_f32_f16 v251, v251
    v_add_f32 v248, v248, v253
    v_add_f32 v249, v249, v251
    v_add_f32 v248, v248, v249
    v_and_b32 v241, 63, v0
    v_cmp_u_f32 vcc, v248, v248
    s_lshl_b32 s33, s38, 2
    s_add_u32 s33, s33, 49152
    s_cmp_lg_u64 vcc, 0
    s_cselect_b32 s32, 1, 0
    v_lshl_add_u32 v242, v241, 12, s33
    v_mov_b32 v240, s32
    s_mov_b64 exec, 15
    ds_write_b32 v242, v240
    s_mov_b64 exec, -1
    s_add_u32 s33, s26, 49152
    v_mov_b32 v241, s33
    s_waitcnt vmcnt(28)
    s_waitcnt lgkmcnt(0)
    s_barrier
    ds_read_b128 v[244:247], v241
    s_waitcnt lgkmcnt(0)
    v_or3_b32 v244, v244, v245, v246
    v_or_b32 v244, v244, v247
    s_nop 0
    v_readfirstlane_b32 s32, v244
    s_nop 3
    s_andn2_b32 s32, s32, s28
    s_cmp_lg_u32 s32, 0
    s_cbranch_scc1 L_attn_fallback
    s_lshr_b32 s24, s46, 3
    s_and_b32 s27, s46, 1
    s_lshl_b32 s25, s47, 1
    s_add_u32 s25, s25, s27
    s_bfe_u32 s27, s46, 0x20001
    s_lshl_b32 s32, s47, 5
    s_add_u32 s32, s32, s46
    s_lshl_b32 s32, s32, 2
    s_add_u32 s32, s32, s38
    s_lshl_b32 s32, s32, 2
    s_and_b32 s33, s2, 7
    s_lshl_b32 s33, s33, 3
    s_lshl_b64 s[28:29], 0xff, s33
    v_accvgpr_read_b32 v24, a244
    v_accvgpr_read_b32 v25, a245
    v_accvgpr_read_b32 v26, a246
    v_accvgpr_read_b32 v27, a247
    v_accvgpr_read_b32 v28, a248
    v_accvgpr_read_b32 v29, a249
    s_mov_b32 s39, 0
L_poll_m2:
    v_subrev_u32 v30, s36, v24
    v_subrev_u32 v31, s36, v25
    v_subrev_u32 v32, s36, v26
    v_subrev_u32 v33, s36, v27
    v_xor_b32 v34, s36, v28
    v_xor_b32 v35, s36, v29
    v_max3_u32 v36, v30, v31, v32
    v_or_b32 v34, v34, v35
    v_max_u32 v36, v36, v33
    v_cmp_ne_u32 vcc, 0, v34
    v_cmp_lt_u32 s[34:35], 15, v36
    s_add_u32 s39, s39, 1
    s_or_b64 vcc, vcc, s[34:35]
    s_cbranch_vccz L_polled_m2
    s_cmp_ge_u32 s39, 0x40000
    s_cbranch_scc1 L_polled_m2
    s_mov_b32 s35, 16384
    buffer_load_dwordx4 v[24:27], v122, s[52:55], s35 offen sc1
    s_mov_b32 s35, 17408
    buffer_load_dwordx2 v[28:29], v107, s[52:55], s35 offen sc1
    s_waitcnt vmcnt(0)
    s_branch L_poll_m2
L_polled_m2:
    v_xor_b32 v30, s3, v24
    v_xor_b32 v31, s3, v25
    v_xor_b32 v32, s3, v26
    v_xor_b32 v33, s3, v27
    v_or3_b32 v30, v30, v31, v32
    v_or_b32 v30, v30, v33
    v_cmp_ne_u32 vcc, 0, v30
    s_and_b64 vcc, vcc, s[28:29]
    s_cselect_b32 s3, 0, 1
    s_waitcnt vmcnt(0)
    v_mov_b32 v127, s36
    s_cmp_lg_u32 s3, 0
    s_cbranch_scc1 L_sigl_a
    buffer_wbl2 sc1
    s_waitcnt vmcnt(0)
    s_mov_b64 exec, 1
    buffer_store_dword v127, off, s[52:55], s32 sc1
    s_branch L_sigd_a
L_sigl_a:
    s_mov_b64 exec, 1
    buffer_store_dword v127, off, s[52:55], s32
L_sigd_a:
    s_mov_b64 exec, -1
    ds_read_b64_tr_b16 a[128:129], v102 offset:0
    ds_read_b64_tr_b16 a[130:131], v102 offset:4096
    ds_read_b64_tr_b16 a[132:133], v102 offset:8192
    ds_read_b64_tr_b16 a[134:135], v102 offset:12288
    ds_read_b128 a[160:163], v106 offset:0
    ds_read_b128 a[164:167], v106 offset:1024
    ds_read_b128 a[168:171], v106 offset:2048
    ds_read_b128 a[172:175], v106 offset:3072
    ds_read_b128 a[176:179], v106 offset:4096
    ds_read_b128 a[180:183], v106 offset:5120
    ds_read_b128 a[184:187], v106 offset:6144
    ds_read_b128 a[188:191], v106 offset:7168
    ds_read_b64_tr_b16 a[136:137], v103 offset:0
    ds_read_b64_tr_b16 a[138:139], v103 offset:4096
    ds_read_b64_tr_b16 a[140:141], v103 offset:8192
    ds_read_b64_tr_b16 a[142:143], v103 offset:12288
    ds_read_b64_tr_b16 a[144:145], v104 offset:0
    ds_read_b64_tr_b16 a[146:147], v104 offset:4096
    ds_read_b64_tr_b16 a[148:149], v104 offset:8192
    ds_read_b64_tr_b16 a[150:151], v104 offset:12288
    ds_read_b64_tr_b16 a[152:153], v105 offset:0
    ds_read_b64_tr_b16 a[154:155], v105 offset:4096
    ds_read_b64_tr_b16 a[156:157], v105 offset:8192
    ds_read_b64_tr_b16 a[158:159], v105 offset:12288
    s_waitcnt lgkmcnt(15)
    v_mfma_f32_16x16x32_bf16 v[128:131], a[128:131], a[160:163], 0
    ds_read_b64_tr_b16 a[192:193], v96 offset:0
    s_lshl_b32 s32, s25, 20
    v_mfma_f32_16x16x32_bf16 v[128:131], a[132:135], a[164:167], v[128:131]
    ds_read_b64_tr_b16 a[194:195], v96 offset:4096
    s_lshl_b32 s33, s24, 15
    v_mfma_f32_16x16x32_bf16 v[144:147], a[132:135], a[172:175], 0
    ds_read_b64_tr_b16 a[196:197], v96 offset:8192
    s_add_u32 s32, s32, s33
    v_mfma_f32_16x16x32_bf16 v[144:147], a[128:131], a[168:171], v[144:147]
    ds_read_b64_tr_b16 a[198:199], v96 offset:12288
    s_add_u32 s32, s32, 4194304
    s_waitcnt lgkmcnt(15)
    v_mfma_f32_16x16x32_bf16 v[160:163], a[128:131], a[176:179], 0
    ds_read_b128 a[224:227], v106 offset:16384
    s_add_u32 s12, s56, s32
    s_addc_u32 s13, s57, 0
    v_mfma_f32_16x16x32_bf16 v[160:163], a[132:135], a[180:183], v[160:163]
    ds_read_b128 a[228:231], v106 offset:17408
    s_mov_b32 s14, 1048576
    v_mfma_f32_16x16x32_bf16 v[176:179], a[132:135], a[188:191], 0
    ds_read_b128 a[232:235], v106 offset:18432
    s_mov_b32 s15, 0x20000
    v_mfma_f32_16x16x32_bf16 v[176:179], a[128:131], a[184:187], v[176:179]
    ds_read_b128 a[236:239], v106 offset:19456
    s_add_u32 s23, s46, 1
    s_waitcnt lgkmcnt(15)
    v_mfma_f32_16x16x32_bf16 v[180:183], a[136:139], a[184:187], 0
    ds_read_b128 a[240:243], v106 offset:20480
    s_and_b32 s23, s23, 7
    v_mfma_f32_16x16x32_bf16 v[180:183], a[140:143], a[188:191], v[180:183]
    ds_read_b128 a[244:247], v106 offset:21504
    s_lshl_b32 s23, s23, 12
    v_mfma_f32_16x16x32_bf16 v[164:167], a[140:143], a[180:183], 0
    ds_read_b128 a[248:251], v106 offset:22528
    s_lshr_b32 s33, s25, 1
    v_mfma_f32_16x16x32_bf16 v[164:167], a[136:139], a[176:179], v[164:167]
    ds_read_b128 a[252:255], v106 offset:23552
    s_lshl_b32 s33, s33, 9
    v_mfma_f32_16x16x32_bf16 v[148:151], a[136:139], a[168:171], 0
    ds_read_b64_tr_b16 a[200:201], v97 offset:0
    s_lshl_b32 s34, s24, 7
    v_mfma_f32_16x16x32_bf16 v[148:151], a[140:143], a[172:175], v[148:151]
    ds_read_b64_tr_b16 a[202:203], v97 offset:4096
    s_add_u32 s33, s33, s34
    v_mfma_f32_16x16x32_bf16 v[132:135], a[140:143], a[164:167], 0
    ds_read_b64_tr_b16 a[204:205], v97 offset:8192
    v_mfma_f32_16x16x32_bf16 v[132:135], a[136:139], a[160:163], v[132:135]
    ds_read_b64_tr_b16 a[206:207], v97 offset:12288
    s_waitcnt lgkmcnt(15)
    v_mfma_f32_16x16x32_bf16 v[136:139], a[144:147], a[160:163], 0
    ds_read_b64_tr_b16 a[208:209], v98 offset:0
    v_mfma_f32_16x16x32_bf16 v[136:139], a[148:151], a[164:167], v[136:139]
    ds_read_b64_tr_b16 a[210:211], v98 offset:4096
    v_mfma_f32_16x16x32_bf16 v[152:155], a[148:151], a[172:175], 0
    ds_read_b64_tr_b16 a[212:213], v98 offset:8192
    v_mfma_f32_16x16x32_bf16 v[152:155], a[144:147], a[168:171], v[152:155]
    ds_read_b64_tr_b16 a[214:215], v98 offset:12288
    v_mfma_f32_16x16x32_bf16 v[168:171], a[144:147], a[176:179], 0
    ds_read_b64_tr_b16 a[216:217], v99 offset:0
    v_mfma_f32_16x16x32_bf16 v[168:171], a[148:151], a[180:183], v[168:171]
    ds_read_b64_tr_b16 a[218:219], v99 offset:4096
    v_mfma_f32_16x16x32_bf16 v[184:187], a[148:151], a[188:191], 0
    ds_read_b64_tr_b16 a[220:221], v99 offset:8192
    v_mfma_f32_16x16x32_bf16 v[184:187], a[144:147], a[184:187], v[184:187]
    ds_read_b64_tr_b16 a[222:223], v99 offset:12288
    v_mfma_f32_16x16x32_bf16 v[188:191], a[152:155], a[184:187], 0
    s_mov_b32 s39, 0
L_poll_a:
    buffer_load_dword v126, v123, s[52:55], s33 offen sc1
    s_add_u32 s39, s39, 1
    s_waitcnt vmcnt(0)
    v_cmp_ne_u32 vcc, s36, v126
    s_cmp_ge_u32 s39, 0x40000
    s_cbranch_scc1 L_polled_a
    s_cbranch_vccnz L_poll_a
L_polled_a:
    s_cmp_lg_u32 s3, 0
    s_cbranch_scc1 L_acq_a
    buffer_inv sc1
    s_waitcnt vmcnt(0)
L_acq_a:
    v_mfma_f32_16x16x32_bf16 v[188:191], a[156:159], a[188:191], v[188:191]
    s_add_u32 m0, s26, 98304
    v_mfma_f32_16x16x32_bf16 v[172:175], a[156:159], a[180:183], 0
    buffer_load_dwordx4 v116, s[12:15], s23 offen offset:0 sc1 lds
    v_mfma_f32_16x16x32_bf16 v[172:175], a[152:155], a[176:179], v[172:175]
    v_mfma_f32_16x16x32_bf16 v[156:159], a[152:155], a[168:171], 0
    buffer_load_dwordx4 v116, s[12:15], s23 offen offset:1024 sc1 lds
    v_mfma_f32_16x16x32_bf16 v[156:159], a[156:159], a[172:175], v[156:159]
    v_mfma_f32_16x16x32_bf16 v[140:143], a[156:159], a[164:167], 0
    buffer_load_dwordx4 v117, s[12:15], s23 offen offset:2048 sc1 lds
    v_mfma_f32_16x16x32_bf16 v[140:143], a[152:155], a[160:163], v[140:143]
    s_waitcnt lgkmcnt(15)
    v_mfma_f32_16x16x32_bf16 v[128:131], a[192:195], a[224:227], v[128:131]
    buffer_load_dwordx4 v117, s[12:15], s23 offen offset:3072 sc1 lds
    s_add_u32 s23, s23, 2048
    s_and_b32 s23, s23, 0x7fff
    v_mfma_f32_16x16x32_bf16 v[128:131], a[196:199], a[228:231], v[128:131]
    s_add_u32 m0, s26, 114688
    v_mfma_f32_16x16x32_bf16 v[144:147], a[196:199], a[236:239], v[144:147]
    buffer_load_dwordx4 v116, s[12:15], s23 offen offset:0 sc1 lds
    v_mfma_f32_16x16x32_bf16 v[144:147], a[192:195], a[232:235], v[144:147]
    s_waitcnt lgkmcnt(14)
    v_mfma_f32_16x16x32_bf16 v[160:163], a[192:195], a[240:243], v[160:163]
    buffer_load_dwordx4 v116, s[12:15], s23 offen offset:1024 sc1 lds
    v_mfma_f32_16x16x32_bf16 v[160:163], a[196:199], a[244:247], v[160:163]
    s_waitcnt lgkmcnt(12)
    v_mfma_f32_16x16x32_bf16 v[176:179], a[196:199], a[252:255], v[176:179]
    buffer_load_dwordx4 v117, s[12:15], s23 offen offset:2048 sc1 lds
    v_mfma_f32_16x16x32_bf16 v[176:179], a[192:195], a[248:251], v[176:179]
    s_waitcnt lgkmcnt(8)
    v_mfma_f32_16x16x32_bf16 v[180:183], a[200:203], a[248:251], v[180:183]
    buffer_load_dwordx4 v117, s[12:15], s23 offen offset:3072 sc1 lds
    s_add_u32 s23, s23, 2048
    s_and_b32 s23, s23, 0x7fff
    v_mfma_f32_16x16x32_bf16 v[180:183], a[204:207], a[252:255], v[180:183]
    s_add_u32 m0, s26, 49152
    v_mfma_f32_16x16x32_bf16 v[164:167], a[204:207], a[244:247], v[164:167]
    buffer_load_dwordx4 v108, s[40:43], s44 offen offset:0 lds
    v_mfma_f32_16x16x32_bf16 v[164:167], a[200:203], a[240:243], v[164:167]
    v_mfma_f32_16x16x32_bf16 v[148:151], a[200:203], a[232:235], v[148:151]
    buffer_load_dwordx4 v109, s[40:43], s44 offen offset:1024 lds
    v_mfma_f32_16x16x32_bf16 v[148:151], a[204:207], a[236:239], v[148:151]
    v_mfma_f32_16x16x32_bf16 v[132:135], a[204:207], a[228:231], v[132:135]
    buffer_load_dwordx4 v110, s[40:43], s44 offen offset:2048 lds
    v_mfma_f32_16x16x32_bf16 v[132:135], a[200:203], a[224:227], v[132:135]
    s_waitcnt lgkmcnt(4)
    v_mfma_f32_16x16x32_bf16 v[136:139], a[208:211], a[224:227], v[136:139]
    buffer_load_dwordx4 v111, s[40:43], s44 offen offset:3072 lds
    s_add_u32 s44, s44, 65536
    s_and_b32 s44, s44, 0xfffff
    v_mfma_f32_16x16x32_bf16 v[136:139], a[212:215], a[228:231], v[136:139]
    v_mfma_f32_16x16x32_bf16 v[152:155], a[212:215], a[236:239], v[152:155]
    v_mfma_f32_16x16x32_bf16 v[152:155], a[208:211], a[232:235], v[152:155]
    v_mfma_f32_16x16x32_bf16 v[168:171], a[208:211], a[240:243], v[168:171]
    v_mfma_f32_16x16x32_bf16 v[168:171], a[212:215], a[244:247], v[168:171]
    v_mfma_f32_16x16x32_bf16 v[184:187], a[212:215], a[252:255], v[184:187]
    v_mfma_f32_16x16x32_bf16 v[184:187], a[208:211], a[248:251], v[184:187]
    s_waitcnt lgkmcnt(0)
    v_mfma_f32_16x16x32_bf16 v[188:191], a[216:219], a[248:251], v[188:191]
    v_mfma_f32_16x16x32_bf16 v[188:191], a[220:223], a[252:255], v[188:191]
    v_mfma_f32_16x16x32_bf16 v[172:175], a[220:223], a[244:247], v[172:175]
    v_mfma_f32_16x16x32_bf16 v[172:175], a[216:219], a[240:243], v[172:175]
    v_mfma_f32_16x16x32_bf16 v[156:159], a[216:219], a[232:235], v[156:159]
    v_mfma_f32_16x16x32_bf16 v[156:159], a[220:223], a[236:239], v[156:159]
    v_mfma_f32_16x16x32_bf16 v[140:143], a[220:223], a[228:231], v[140:143]
    v_mfma_f32_16x16x32_bf16 v[140:143], a[216:219], a[224:227], v[140:143]
    s_barrier
    s_add_u32 m0, s26, 65536
    s_nop 0
    buffer_load_dwordx4 v116, s[12:15], s23 offen offset:0 sc1 lds
    buffer_load_dwordx4 v116, s[12:15], s23 offen offset:1024 sc1 lds
    buffer_load_dwordx4 v117, s[12:15], s23 offen offset:2048 sc1 lds
    buffer_load_dwordx4 v117, s[12:15], s23 offen offset:3072 sc1 lds
    s_add_u32 s23, s23, 2048
    s_and_b32 s23, s23, 0x7fff
    s_add_u32 m0, s26, 81920
    s_nop 0
    buffer_load_dwordx4 v116, s[12:15], s23 offen offset:0 sc1 lds
    buffer_load_dwordx4 v116, s[12:15], s23 offen offset:1024 sc1 lds
    buffer_load_dwordx4 v117, s[12:15], s23 offen offset:2048 sc1 lds
    buffer_load_dwordx4 v117, s[12:15], s23 offen offset:3072 sc1 lds
    s_add_u32 s23, s23, 2048
    s_and_b32 s23, s23, 0x7fff
    s_add_u32 m0, s26, 0
    s_nop 0
    buffer_load_dwordx4 v108, s[40:43], s44 offen offset:0 lds
    buffer_load_dwordx4 v109, s[40:43], s44 offen offset:1024 lds
    buffer_load_dwordx4 v110, s[40:43], s44 offen offset:2048 lds
    buffer_load_dwordx4 v111, s[40:43], s44 offen offset:3072 lds
    s_add_u32 s44, s44, 65536
    s_and_b32 s44, s44, 0xfffff
    s_add_u32 m0, s26, 131072
    s_nop 0
    buffer_load_dwordx4 v108, s[40:43], s44 offen offset:0 lds
    buffer_load_dwordx4 v109, s[40:43], s44 offen offset:1024 lds
    buffer_load_dwordx4 v110, s[40:43], s44 offen offset:2048 lds
    buffer_load_dwordx4 v111, s[40:43], s44 offen offset:3072 lds
    s_add_u32 s44, s44, 65536
    s_and_b32 s44, s44, 0xfffff
    s_waitcnt vmcnt(24)
    s_barrier
    ds_read_b64_tr_b16 a[128:129], v102 offset:16384
    ds_read_b64_tr_b16 a[130:131], v102 offset:20480
    ds_read_b64_tr_b16 a[132:133], v102 offset:24576
    ds_read_b64_tr_b16 a[134:135], v102 offset:28672
    ds_read_b128 a[160:163], v106 offset:32768
    ds_read_b128 a[164:167], v106 offset:33792
    ds_read_b128 a[168:171], v106 offset:34816
    ds_read_b128 a[172:175], v106 offset:35840
    ds_read_b128 a[176:179], v106 offset:36864
    ds_read_b128 a[180:183], v106 offset:37888
    ds_read_b128 a[184:187], v106 offset:38912
    ds_read_b128 a[188:191], v106 offset:39936
    ds_read_b64_tr_b16 a[136:137], v103 offset:16384
    ds_read_b64_tr_b16 a[138:139], v103 offset:20480
    ds_read_b64_tr_b16 a[140:141], v103 offset:24576
    ds_read_b64_tr_b16 a[142:143], v103 offset:28672
    ds_read_b64_tr_b16 a[144:145], v104 offset:16384
    ds_read_b64_tr_b16 a[146:147], v104 offset:20480
    ds_read_b64_tr_b16 a[148:149], v104 offset:24576
    ds_read_b64_tr_b16 a[150:151], v104 offset:28672
    ds_read_b64_tr_b16 a[152:153], v105 offset:16384
    ds_read_b64_tr_b16 a[154:155], v105 offset:20480
    ds_read_b64_tr_b16 a[156:157], v105 offset:24576
    ds_read_b64_tr_b16 a[158:159], v105 offset:28672
    s_waitcnt lgkmcnt(15)
    v_mfma_f32_16x16x32_bf16 v[128:131], a[128:131], a[160:163], v[128:131]
    v_mfma_f32_16x16x32_bf16 v[128:131], a[132:135], a[164:167], v[128:131]
    v_mfma_f32_16x16x32_bf16 v[144:147], a[132:135], a[172:175], v[144:147]
    v_mfma_f32_16x16x32_bf16 v[144:147], a[128:131], a[168:171], v[144:147]
    s_waitcnt lgkmcnt(14)
    v_mfma_f32_16x16x32_bf16 v[160:163], a[128:131], a[176:179], v[160:163]
    v_mfma_f32_16x16x32_bf16 v[160:163], a[132:135], a[180:183], v[160:163]
    s_waitcnt lgkmcnt(12)
    v_mfma_f32_16x16x32_bf16 v[176:179], a[132:135], a[188:191], v[176:179]
    v_mfma_f32_16x16x32_bf16 v[176:179], a[128:131], a[184:187], v[176:179]
    s_waitcnt lgkmcnt(0)
    s_waitcnt vmcnt(20)
    s_barrier
    v_mfma_f32_16x16x32_bf16 v[180:183], a[136:139], a[184:187], v[180:183]
    ds_read_b64_tr_b16 a[192:193], v96 offset:16384
    ds_read_b64_tr_b16 a[194:195], v96 offset:20480
    s_lshl_b32 s32, s24, 21
    s_add_u32 m0, s26, 16384
    v_mfma_f32_16x16x32_bf16 v[180:183], a[140:143], a[188:191], v[180:183]
    buffer_load_dwordx4 v108, s[40:43], s44 offen offset:0 lds
    ds_read_b64_tr_b16 a[196:197], v96 offset:24576
    v_mfma_f32_16x16x32_bf16 v[164:167], a[140:143], a[180:183], v[164:167]
    ds_read_b64_tr_b16 a[198:199], v96 offset:28672
    ds_read_b128 a[224:227], v106 offset:49152
    s_lshl_b32 s33, s25, 17
    v_mfma_f32_16x16x32_bf16 v[164:167], a[136:139], a[176:179], v[164:167]
    buffer_load_dwordx4 v109, s[40:43], s44 offen offset:1024 lds
    ds_read_b128 a[228:231], v106 offset:50176
    v_mfma_f32_16x16x32_bf16 v[148:151], a[136:139], a[168:171], v[148:151]
    ds_read_b128 a[232:235], v106 offset:51200
    ds_read_b128 a[236:239], v106 offset:52224
    s_add_u32 s32, s32, s33
    v_mfma_f32_16x16x32_bf16 v[148:151], a[140:143], a[172:175], v[148:151]
    ds_read_b128 a[240:243], v106 offset:53248
    v_mfma_f32_16x16x32_bf16 v[132:135], a[140:143], a[164:167], v[132:135]
    buffer_load_dwordx4 v110, s[40:43], s44 offen offset:2048 lds
    ds_read_b128 a[244:247], v106 offset:54272
    ds_read_b128 a[248:251], v106 offset:55296
    s_lshl_b32 s33, s27, 12
    v_mfma_f32_16x16x32_bf16 v[132:135], a[136:139], a[160:163], v[132:135]
    ds_read_b128 a[252:255], v106 offset:56320
    v_mfma_f32_16x16x32_bf16 v[136:139], a[144:147], a[160:163], v[136:139]
    ds_read_b64_tr_b16 a[200:201], v97 offset:16384
    ds_read_b64_tr_b16 a[202:203], v97 offset:20480
    s_add_u32 s32, s32, s33
    v_mfma_f32_16x16x32_bf16 v[136:139], a[148:151], a[164:167], v[136:139]
    buffer_load_dwordx4 v111, s[40:43], s44 offen offset:3072 lds
    ds_read_b64_tr_b16 a[204:205], v97 offset:24576
    s_add_u32 s44, s44, 65536
    s_and_b32 s44, s44, 0xfffff
    v_mfma_f32_16x16x32_bf16 v[152:155], a[148:151], a[172:175], v[152:155]
    ds_read_b64_tr_b16 a[206:207], v97 offset:28672
    ds_read_b64_tr_b16 a[208:209], v98 offset:16384
    s_add_u32 s32, s32, 50331648
    v_mfma_f32_16x16x32_bf16 v[152:155], a[144:147], a[168:171], v[152:155]
    ds_read_b64_tr_b16 a[210:211], v98 offset:20480
    s_add_u32 m0, s26, 98304
    v_mfma_f32_16x16x32_bf16 v[168:171], a[144:147], a[176:179], v[168:171]
    buffer_load_dwordx4 v116, s[12:15], s23 offen offset:0 sc1 lds
    ds_read_b64_tr_b16 a[212:213], v98 offset:24576
    ds_read_b64_tr_b16 a[214:215], v98 offset:28672
    s_add_u32 s16, s56, s32
    s_addc_u32 s17, s57, 0
    v_mfma_f32_16x16x32_bf16 v[168:171], a[148:151], a[180:183], v[168:171]
    ds_read_b64_tr_b16 a[216:217], v99 offset:16384
    v_mfma_f32_16x16x32_bf16 v[184:187], a[148:151], a[188:191], v[184:187]
    buffer_load_dwordx4 v116, s[12:15], s23 offen offset:1024 sc1 lds
    ds_read_b64_tr_b16 a[218:219], v99 offset:20480
    ds_read_b64_tr_b16 a[220:221], v99 offset:24576
    s_mov_b32 s18, 131072
    v_mfma_f32_16x16x32_bf16 v[184:187], a[144:147], a[184:187], v[184:187]
    ds_read_b64_tr_b16 a[222:223], v99 offset:28672
    v_mfma_f32_16x16x32_bf16 v[188:191], a[152:155], a[184:187], v[188:191]
    s_mov_b32 s19, 0x20000
    v_mfma_f32_16x16x32_bf16 v[188:191], a[156:159], a[188:191], v[188:191]
    buffer_load_dwordx4 v117, s[12:15], s23 offen offset:2048 sc1 lds
    v_mfma_f32_16x16x32_bf16 v[172:175], a[156:159], a[180:183], v[172:175]
    s_lshl_b32 s35, s25, 2
    v_mfma_f32_16x16x32_bf16 v[172:175], a[152:155], a[176:179], v[172:175]
    v_mfma_f32_16x16x32_bf16 v[156:159], a[152:155], a[168:171], v[156:159]
    buffer_load_dwordx4 v117, s[12:15], s23 offen offset:3072 sc1 lds
    s_add_u32 s35, s35, s27
    s_add_u32 s23, s23, 2048
    s_and_b32 s23, s23, 0x7fff
    v_mfma_f32_16x16x32_bf16 v[156:159], a[156:159], a[172:175], v[156:159]
    v_mfma_f32_16x16x32_bf16 v[140:143], a[156:159], a[164:167], v[140:143]
    s_lshl_b32 s35, s35, 2
    v_mfma_f32_16x16x32_bf16 v[140:143], a[152:155], a[160:163], v[140:143]
    s_waitcnt lgkmcnt(0)
    s_waitcnt vmcnt(20)
    s_barrier
    v_mfma_f32_16x16x32_bf16 v[128:131], a[192:195], a[224:227], v[128:131]
    ds_read_b64_tr_b16 a[128:129], v102 offset:32768
    s_add_u32 s35, s35, s24
    s_add_u32 m0, s26, 147456
    v_mfma_f32_16x16x32_bf16 v[128:131], a[196:199], a[228:231], v[128:131]
    buffer_load_dwordx4 v108, s[40:43], s44 offen offset:0 lds
    ds_read_b64_tr_b16 a[130:131], v102 offset:36864
    v_mfma_f32_16x16x32_bf16 v[144:147], a[196:199], a[236:239], v[144:147]
    ds_read_b64_tr_b16 a[132:133], v102 offset:40960
    s_lshl_b32 s35, s35, 7
    v_mfma_f32_16x16x32_bf16 v[144:147], a[192:195], a[232:235], v[144:147]
    ds_read_b64_tr_b16 a[134:135], v102 offset:45056
    v_mfma_f32_16x16x32_bf16 v[160:163], a[192:195], a[240:243], v[160:163]
    buffer_load_dwordx4 v109, s[40:43], s44 offen offset:1024 lds
    ds_read_b128 a[160:163], v106 offset:0
    s_add_u32 s31, s35, 51200
    v_mfma_f32_16x16x32_bf16 v[160:163], a[196:199], a[244:247], v[160:163]
    ds_read_b128 a[164:167], v106 offset:1024
    v_mfma_f32_16x16x32_bf16 v[176:179], a[196:199], a[252:255], v[176:179]
    ds_read_b128 a[168:171], v106 offset:2048
    v_and_b32 v113, 15, v114
    v_mfma_f32_16x16x32_bf16 v[176:179], a[192:195], a[248:251], v[176:179]
    ds_read_b128 a[172:175], v106 offset:3072
    v_mfma_f32_16x16x32_bf16 v[180:183], a[200:203], a[248:251], v[180:183]
    buffer_load_dwordx4 v110, s[40:43], s44 offen offset:2048 lds
    ds_read_b128 a[176:179], v106 offset:4096
    v_lshlrev_b32 v113, 7, v113
    v_mfma_f32_16x16x32_bf16 v[180:183], a[204:207], a[252:255], v[180:183]
    ds_read_b128 a[180:183], v106 offset:5120
    v_mfma_f32_16x16x32_bf16 v[164:167], a[204:207], a[244:247], v[164:167]
    ds_read_b128 a[184:187], v106 offset:6144
    s_mov_b32 s22, 16384
    v_mfma_f32_16x16x32_bf16 v[164:167], a[200:203], a[240:243], v[164:167]
    ds_read_b128 a[188:191], v106 offset:7168
    v_mfma_f32_16x16x32_bf16 v[148:151], a[200:203], a[232:235], v[148:151]
    buffer_load_dwordx4 v111, s[40:43], s44 offen offset:3072 lds
    ds_read_b64_tr_b16 a[136:137], v103 offset:32768
    v_lshlrev_b32 v124, 2, v114
    s_add_u32 s44, s44, 65536
    s_and_b32 s44, s44, 0xfffff
    v_mfma_f32_16x16x32_bf16 v[148:151], a[204:207], a[236:239], v[148:151]
    ds_read_b64_tr_b16 a[138:139], v103 offset:36864
    v_mfma_f32_16x16x32_bf16 v[132:135], a[204:207], a[228:231], v[132:135]
    ds_read_b64_tr_b16 a[140:141], v103 offset:40960
    s_lshr_b32 s47, s2, 4
    v_mfma_f32_16x16x32_bf16 v[132:135], a[200:203], a[224:227], v[132:135]
    ds_read_b64_tr_b16 a[142:143], v103 offset:45056
    s_add_u32 m0, s26, 114688
    v_mfma_f32_16x16x32_bf16 v[136:139], a[208:211], a[224:227], v[136:139]
    buffer_load_dwordx4 v116, s[12:15], s23 offen offset:0 sc1 lds
    ds_read_b64_tr_b16 a[144:145], v104 offset:32768
    s_and_b32 s46, s2, 7
    v_mfma_f32_16x16x32_bf16 v[136:139], a[212:215], a[228:231], v[136:139]
    ds_read_b64_tr_b16 a[146:147], v104 offset:36864
    v_mfma_f32_16x16x32_bf16 v[152:155], a[212:215], a[236:239], v[152:155]
    ds_read_b64_tr_b16 a[148:149], v104 offset:40960
    s_lshl_b32 s46, s46, 1
    v_mfma_f32_16x16x32_bf16 v[152:155], a[208:211], a[232:235], v[152:155]
    buffer_load_dwordx4 v116, s[12:15], s23 offen offset:1024 sc1 lds
    ds_read_b64_tr_b16 a[150:151], v104 offset:45056
    v_mfma_f32_16x16x32_bf16 v[168:171], a[208:211], a[240:243], v[168:171]
    ds_read_b64_tr_b16 a[152:153], v105 offset:32768
    s_bfe_u32 s34, s2, 0x10003
    v_mfma_f32_16x16x32_bf16 v[168:171], a[212:215], a[244:247], v[168:171]
    ds_read_b64_tr_b16 a[154:155], v105 offset:36864
    v_mfma_f32_16x16x32_bf16 v[184:187], a[212:215], a[252:255], v[184:187]
    ds_read_b64_tr_b16 a[156:157], v105 offset:40960
    s_add_u32 s46, s46, s34
    v_mfma_f32_16x16x32_bf16 v[184:187], a[208:211], a[248:251], v[184:187]
    buffer_load_dwordx4 v117, s[12:15], s23 offen offset:2048 sc1 lds
    ds_read_b64_tr_b16 a[158:159], v105 offset:45056
    v_mfma_f32_16x16x32_bf16 v[188:191], a[216:219], a[248:251], v[188:191]
    s_mul_i32 s29, s38, 7168
    v_mfma_f32_16x16x32_bf16 v[188:191], a[220:223], a[252:255], v[188:191]
    v_mfma_f32_16x16x32_bf16 v[172:175], a[220:223], a[244:247], v[172:175]
    v_lshl_add_u32 v4, v114, 4, s29
    v_mfma_f32_16x16x32_bf16 v[172:175], a[216:219], a[240:243], v[172:175]
    buffer_load_dwordx4 v117, s[12:15], s23 offen offset:3072 sc1 lds
    s_add_u32 s23, s23, 2048
    s_and_b32 s23, s23, 0x7fff
    v_mfma_f32_16x16x32_bf16 v[156:159], a[216:219], a[232:235], v[156:159]
    v_add_u32 v5, 4096, v4
    v_mfma_f32_16x16x32_bf16 v[156:159], a[220:223], a[236:239], v[156:159]
    v_mfma_f32_16x16x32_bf16 v[140:143], a[220:223], a[228:231], v[140:143]
    s_mul_i32 s34, s47, 229376
    v_mfma_f32_16x16x32_bf16 v[140:143], a[216:219], a[224:227], v[140:143]
    s_waitcnt lgkmcnt(0)
    s_waitcnt vmcnt(24)
    s_barrier
    v_mfma_f32_16x16x32_bf16 v[128:131], a[128:131], a[160:163], v[128:131]
    ds_read_b64_tr_b16 a[192:193], v102 offset:49152
    s_add_u32 s34, s34, 67108864
    s_add_u32 m0, s26, 32768
    v_mfma_f32_16x16x32_bf16 v[128:131], a[132:135], a[164:167], v[128:131]
    buffer_load_dwordx4 v108, s[40:43], s44 offen offset:0 lds
    ds_read_b64_tr_b16 a[194:195], v102 offset:53248
    v_mfma_f32_16x16x32_bf16 v[144:147], a[132:135], a[172:175], v[144:147]
    ds_read_b64_tr_b16 a[196:197], v102 offset:57344
    s_add_u32 s4, s56, s34
    s_addc_u32 s5, s57, 0
    v_mfma_f32_16x16x32_bf16 v[144:147], a[128:131], a[168:171], v[144:147]
    ds_read_b64_tr_b16 a[198:199], v102 offset:61440
    v_mfma_f32_16x16x32_bf16 v[160:163], a[128:131], a[176:179], v[160:163]
    buffer_load_dwordx4 v109, s[40:43], s44 offen offset:1024 lds
    ds_read_b128 a[224:227], v106 offset:16384
    s_mov_b32 s6, 229376
    v_mfma_f32_16x16x32_bf16 v[160:163], a[132:135], a[180:183], v[160:163]
    ds_read_b128 a[228:231], v106 offset:17408
    v_mfma_f32_16x16x32_bf16 v[176:179], a[132:135], a[188:191], v[176:179]
    ds_read_b128 a[232:235], v106 offset:18432
    s_mov_b32 s7, 0x20000
    v_mfma_f32_16x16x32_bf16 v[176:179], a[128:131], a[184:187], v[176:179]
    ds_read_b128 a[236:239], v106 offset:19456
    v_mfma_f32_16x16x32_bf16 v[180:183], a[136:139], a[184:187], v[180:183]
    buffer_load_dwordx4 v110, s[40:43], s44 offen offset:2048 lds
    ds_read_b128 a[240:243], v106 offset:20480
    s_mov_b32 s28, 0
    v_mfma_f32_16x16x32_bf16 v[180:183], a[140:143], a[188:191], v[180:183]
    ds_read_b128 a[244:247], v106 offset:21504
    v_mfma_f32_16x16x32_bf16 v[164:167], a[140:143], a[180:183], v[164:167]
    ds_read_b128 a[248:251], v106 offset:22528
    s_bfe_u32 s30, s2, 0x10003
    v_mfma_f32_16x16x32_bf16 v[164:167], a[136:139], a[176:179], v[164:167]
    ds_read_b128 a[252:255], v106 offset:23552
    v_mfma_f32_16x16x32_bf16 v[148:151], a[136:139], a[168:171], v[148:151]
    buffer_load_dwordx4 v111, s[40:43], s44 offen offset:3072 lds
    ds_read_b64_tr_b16 a[200:201], v103 offset:49152
    s_lshl_b32 s30, s30, 2
    s_add_u32 s44, s44, 65536
    s_and_b32 s44, s44, 0xfffff
    v_mfma_f32_16x16x32_bf16 v[148:151], a[140:143], a[172:175], v[148:151]
    ds_read_b64_tr_b16 a[202:203], v103 offset:53248
    v_mfma_f32_16x16x32_bf16 v[132:135], a[140:143], a[164:167], v[132:135]
    ds_read_b64_tr_b16 a[204:205], v103 offset:57344
    s_add_u32 s30, s30, s38
    v_mfma_f32_16x16x32_bf16 v[132:135], a[136:139], a[160:163], v[132:135]
    ds_read_b64_tr_b16 a[206:207], v103 offset:61440
    s_add_u32 m0, s26, 65536
    v_mfma_f32_16x16x32_bf16 v[136:139], a[144:147], a[160:163], v[136:139]
    buffer_load_dwordx4 v116, s[12:15], s23 offen offset:0 sc1 lds
    ds_read_b64_tr_b16 a[208:209], v104 offset:49152
    s_mul_i32 s30, s30, 14336
    v_mfma_f32_16x16x32_bf16 v[136:139], a[148:151], a[164:167], v[136:139]
    ds_read_b64_tr_b16 a[210:211], v104 offset:53248
    v_mfma_f32_16x16x32_bf16 v[152:155], a[148:151], a[172:175], v[152:155]
    ds_read_b64_tr_b16 a[212:213], v104 offset:57344
    v_and_b32 v100, 15, v114
    v_mfma_f32_16x16x32_bf16 v[152:155], a[144:147], a[168:171], v[152:155]
    buffer_load_dwordx4 v116, s[12:15], s23 offen offset:1024 sc1 lds
    ds_read_b64_tr_b16 a[214:215], v104 offset:61440
    v_mfma_f32_16x16x32_bf16 v[168:171], a[144:147], a[176:179], v[168:171]
    ds_read_b64_tr_b16 a[216:217], v105 offset:49152
    v_lshlrev_b32 v100, 7, v100
    v_mfma_f32_16x16x32_bf16 v[168:171], a[148:151], a[180:183], v[168:171]
    ds_read_b64_tr_b16 a[218:219], v105 offset:53248
    v_mfma_f32_16x16x32_bf16 v[184:187], a[148:151], a[188:191], v[184:187]
    ds_read_b64_tr_b16 a[220:221], v105 offset:57344
    v_lshrrev_b32 v12, 2, v114
    v_mfma_f32_16x16x32_bf16 v[184:187], a[144:147], a[184:187], v[184:187]
    buffer_load_dwordx4 v117, s[12:15], s23 offen offset:2048 sc1 lds
    ds_read_b64_tr_b16 a[222:223], v105 offset:61440
    v_mfma_f32_16x16x32_bf16 v[188:191], a[152:155], a[184:187], v[188:191]
    v_mul_u32_u24 v12, 224, v12
    v_mfma_f32_16x16x32_bf16 v[188:191], a[156:159], a[188:191], v[188:191]
    v_mfma_f32_16x16x32_bf16 v[172:175], a[156:159], a[180:183], v[172:175]
    v_and_b32 v13, 3, v114
    v_mfma_f32_16x16x32_bf16 v[172:175], a[152:155], a[176:179], v[172:175]
    buffer_load_dwordx4 v117, s[12:15], s23 offen offset:3072 sc1 lds
    s_add_u32 s23, s23, 2048
    s_and_b32 s23, s23, 0x7fff
    v_mfma_f32_16x16x32_bf16 v[156:159], a[152:155], a[168:171], v[156:159]
    v_lshl_add_u32 v1, v13, 3, v12
    v_mfma_f32_16x16x32_bf16 v[156:159], a[156:159], a[172:175], v[156:159]
    v_mfma_f32_16x16x32_bf16 v[140:143], a[156:159], a[164:167], v[140:143]
    v_add_u32 v2, 0x10000, v1
    v_mfma_f32_16x16x32_bf16 v[140:143], a[152:155], a[160:163], v[140:143]
    s_waitcnt lgkmcnt(0)
    s_waitcnt vmcnt(28)
    s_waitcnt vmcnt(16)
    s_barrier
    v_mfma_f32_16x16x32_bf16 v[128:131], a[192:195], a[224:227], v[128:131]
    ds_read_b64_tr_b16 a[128:129], v102 offset:0
    v_add_u32 v3, 0x20000, v1
    s_add_u32 m0, s26, 49152
    v_mfma_f32_16x16x32_bf16 v[128:131], a[196:199], a[228:231], v[128:131]
    buffer_load_dwordx4 v108, s[40:43], s44 offen offset:0 lds
    ds_read_b64_tr_b16 a[130:131], v102 offset:4096
    v_mfma_f32_16x16x32_bf16 v[144:147], a[196:199], a[236:239], v[144:147]
    ds_read_b64_tr_b16 a[132:133], v102 offset:8192
    v_lshlrev_b32 v12, 15, v115
    v_mfma_f32_16x16x32_bf16 v[144:147], a[192:195], a[232:235], v[144:147]
    ds_read_b64_tr_b16 a[134:135], v102 offset:12288
    v_mfma_f32_16x16x32_bf16 v[160:163], a[192:195], a[240:243], v[160:163]
    buffer_load_dwordx4 v109, s[40:43], s44 offen offset:1024 lds
    ds_read_b128 a[160:163], v106 offset:32768
    v_lshl_add_u32 v6, v114, 4, v12
    v_mfma_f32_16x16x32_bf16 v[160:163], a[196:199], a[244:247], v[160:163]
    ds_read_b128 a[164:167], v106 offset:33792
    v_mfma_f32_16x16x32_bf16 v[176:179], a[196:199], a[252:255], v[176:179]
    ds_read_b128 a[168:171], v106 offset:34816
    v_add_u32 v7, 16384, v6
    v_mfma_f32_16x16x32_bf16 v[176:179], a[192:195], a[248:251], v[176:179]
    ds_read_b128 a[172:175], v106 offset:35840
    v_mfma_f32_16x16x32_bf16 v[180:183], a[200:203], a[248:251], v[180:183]
    buffer_load_dwordx4 v110, s[40:43], s44 offen offset:2048 lds
    ds_read_b128 a[176:179], v106 offset:36864
    v_mul_u32_u24 v12, 112, v115
    v_mfma_f32_16x16x32_bf16 v[180:183], a[204:207], a[252:255], v[180:183]
    ds_read_b128 a[180:183], v106 offset:37888
    v_mfma_f32_16x16x32_bf16 v[164:167], a[204:207], a[244:247], v[164:167]
    ds_read_b128 a[184:187], v106 offset:38912
    v_lshlrev_b32 v12, 10, v12
    v_mfma_f32_16x16x32_bf16 v[164:167], a[200:203], a[240:243], v[164:167]
    ds_read_b128 a[188:191], v106 offset:39936
    v_mfma_f32_16x16x32_bf16 v[148:151], a[200:203], a[232:235], v[148:151]
    buffer_load_dwordx4 v111, s[40:43], s44 offen offset:3072 lds
    ds_read_b64_tr_b16 a[136:137], v103 offset:0
    v_and_b32 v13, 15, v114
    s_add_u32 s44, s44, 65536
    s_and_b32 s44, s44, 0xfffff
    v_mfma_f32_16x16x32_bf16 v[148:151], a[204:207], a[236:239], v[148:151]
    ds_read_b64_tr_b16 a[138:139], v103 offset:4096
    v_mfma_f32_16x16x32_bf16 v[132:135], a[204:207], a[228:231], v[132:135]
    ds_read_b64_tr_b16 a[140:141], v103 offset:8192
    v_lshl_add_u32 v12, v13, 5, v12
    v_mfma_f32_16x16x32_bf16 v[132:135], a[200:203], a[224:227], v[132:135]
    ds_read_b64_tr_b16 a[142:143], v103 offset:12288
    s_add_u32 m0, s26, 81920
    v_mfma_f32_16x16x32_bf16 v[136:139], a[208:211], a[224:227], v[136:139]
    buffer_load_dwordx4 v116, s[12:15], s23 offen offset:0 sc1 lds
    ds_read_b64_tr_b16 a[144:145], v104 offset:0
    v_lshrrev_b32 v13, 4, v114
    v_mfma_f32_16x16x32_bf16 v[136:139], a[212:215], a[228:231], v[136:139]
    ds_read_b64_tr_b16 a[146:147], v104 offset:4096
    v_mfma_f32_16x16x32_bf16 v[152:155], a[212:215], a[236:239], v[152:155]
    ds_read_b64_tr_b16 a[148:149], v104 offset:8192
    v_lshl_add_u32 v8, v13, 3, v12
    v_mfma_f32_16x16x32_bf16 v[152:155], a[208:211], a[232:235], v[152:155]
    buffer_load_dwordx4 v116, s[12:15], s23 offen offset:1024 sc1 lds
    ds_read_b64_tr_b16 a[150:151], v104 offset:12288
    v_mfma_f32_16x16x32_bf16 v[168:171], a[208:211], a[240:243], v[168:171]
    ds_read_b64_tr_b16 a[152:153], v105 offset:0
    v_add_u32 v9, 4096, v8
    v_mfma_f32_16x16x32_bf16 v[168:171], a[212:215], a[244:247], v[168:171]
    ds_read_b64_tr_b16 a[154:155], v105 offset:4096
    v_mfma_f32_16x16x32_bf16 v[184:187], a[212:215], a[252:255], v[184:187]
    ds_read_b64_tr_b16 a[156:157], v105 offset:8192
    s_and_b32 s20, s2, 7
    v_mfma_f32_16x16x32_bf16 v[184:187], a[208:211], a[248:251], v[184:187]
    buffer_load_dwordx4 v117, s[12:15], s23 offen offset:2048 sc1 lds
    ds_read_b64_tr_b16 a[158:159], v105 offset:12288
    v_mfma_f32_16x16x32_bf16 v[188:191], a[216:219], a[248:251], v[188:191]
    s_lshl_b32 s20, s20, 5
    v_mfma_f32_16x16x32_bf16 v[188:191], a[220:223], a[252:255], v[188:191]
    v_mfma_f32_16x16x32_bf16 v[172:175], a[220:223], a[244:247], v[172:175]
    s_lshr_b32 s34, s2, 3
    v_mfma_f32_16x16x32_bf16 v[172:175], a[216:219], a[240:243], v[172:175]
    buffer_load_dwordx4 v117, s[12:15], s23 offen offset:3072 sc1 lds
    s_add_u32 s23, s23, 2048
    s_and_b32 s23, s23, 0x7fff
    v_mfma_f32_16x16x32_bf16 v[156:159], a[216:219], a[232:235], v[156:159]
    s_add_u32 s20, s20, s34
    v_mfma_f32_16x16x32_bf16 v[156:159], a[220:223], a[236:239], v[156:159]
    v_mfma_f32_16x16x32_bf16 v[140:143], a[220:223], a[228:231], v[140:143]
    v_and_b32 v13, 7, v114
    v_mfma_f32_16x16x32_bf16 v[140:143], a[216:219], a[224:227], v[140:143]
    s_waitcnt lgkmcnt(0)
    s_waitcnt vmcnt(16)
    s_barrier
    v_mfma_f32_16x16x32_bf16 v[128:131], a[128:131], a[160:163], v[128:131]
    ds_read_b64_tr_b16 a[192:193], v96 offset:0
    v_bfe_u32 v14, v114, 3, 2
    s_add_u32 m0, s26, 0
    v_mfma_f32_16x16x32_bf16 v[128:131], a[132:135], a[164:167], v[128:131]
    buffer_load_dwordx4 v108, s[40:43], s44 offen offset:0 lds
    ds_read_b64_tr_b16 a[194:195], v96 offset:4096
    v_mfma_f32_16x16x32_bf16 v[144:147], a[132:135], a[172:175], v[144:147]
    ds_read_b64_tr_b16 a[196:197], v96 offset:8192
    v_lshrrev_b32 v15, 5, v114
    v_mfma_f32_16x16x32_bf16 v[144:147], a[128:131], a[168:171], v[144:147]
    ds_read_b64_tr_b16 a[198:199], v96 offset:12288
    v_mfma_f32_16x16x32_bf16 v[160:163], a[128:131], a[176:179], v[160:163]
    buffer_load_dwordx4 v109, s[40:43], s44 offen offset:1024 lds
    ds_read_b128 a[224:227], v106 offset:49152
    v_lshl_add_u32 v15, v115, 2, v15
    v_mfma_f32_16x16x32_bf16 v[160:163], a[132:135], a[180:183], v[160:163]
    ds_read_b128 a[228:231], v106 offset:50176
    v_mfma_f32_16x16x32_bf16 v[176:179], a[132:135], a[188:191], v[176:179]
    ds_read_b128 a[232:235], v106 offset:51200
    s_and_b32 s34, s20, 1
    v_mfma_f32_16x16x32_bf16 v[176:179], a[128:131], a[184:187], v[176:179]
    ds_read_b128 a[236:239], v106 offset:52224
    v_mfma_f32_16x16x32_bf16 v[180:183], a[136:139], a[184:187], v[180:183]
    buffer_load_dwordx4 v110, s[40:43], s44 offen offset:2048 lds
    ds_read_b128 a[240:243], v106 offset:53248
    s_lshl_b32 s34, s34, 3
    v_mfma_f32_16x16x32_bf16 v[180:183], a[140:143], a[188:191], v[180:183]
    ds_read_b128 a[244:247], v106 offset:54272
    v_mfma_f32_16x16x32_bf16 v[164:167], a[140:143], a[180:183], v[164:167]
    ds_read_b128 a[248:251], v106 offset:55296
    v_add_u32 v16, s34, v13
    v_mfma_f32_16x16x32_bf16 v[164:167], a[136:139], a[176:179], v[164:167]
    ds_read_b128 a[252:255], v106 offset:56320
    v_mfma_f32_16x16x32_bf16 v[148:151], a[136:139], a[168:171], v[148:151]
    buffer_load_dwordx4 v111, s[40:43], s44 offen offset:3072 lds
    ds_read_b64_tr_b16 a[200:201], v97 offset:0
    v_lshl_add_u32 v16, v14, 4, v16
    s_add_u32 s44, s44, 65536
    s_and_b32 s44, s44, 0xfffff
    v_mfma_f32_16x16x32_bf16 v[148:151], a[140:143], a[172:175], v[148:151]
    ds_read_b64_tr_b16 a[202:203], v97 offset:4096
    v_mfma_f32_16x16x32_bf16 v[132:135], a[140:143], a[164:167], v[132:135]
    ds_read_b64_tr_b16 a[204:205], v97 offset:8192
    v_lshlrev_b32 v16, 4, v16
    v_mfma_f32_16x16x32_bf16 v[132:135], a[136:139], a[160:163], v[132:135]
    ds_read_b64_tr_b16 a[206:207], v97 offset:12288
    s_add_u32 m0, s26, 98304
    v_mfma_f32_16x16x32_bf16 v[136:139], a[144:147], a[160:163], v[136:139]
    buffer_load_dwordx4 v116, s[12:15], s23 offen offset:0 sc1 lds
    ds_read_b64_tr_b16 a[208:209], v98 offset:0
    v_lshl_add_u32 v18, v15, 10, v16
    v_mfma_f32_16x16x32_bf16 v[136:139], a[148:151], a[164:167], v[136:139]
    ds_read_b64_tr_b16 a[210:211], v98 offset:4096
    v_mfma_f32_16x16x32_bf16 v[152:155], a[148:151], a[172:175], v[152:155]
    ds_read_b64_tr_b16 a[212:213], v98 offset:8192
    v_lshlrev_b32 v19, 6, v15
    v_mfma_f32_16x16x32_bf16 v[152:155], a[144:147], a[168:171], v[152:155]
    buffer_load_dwordx4 v116, s[12:15], s23 offen offset:1024 sc1 lds
    ds_read_b64_tr_b16 a[214:215], v98 offset:12288
    v_mfma_f32_16x16x32_bf16 v[168:171], a[144:147], a[176:179], v[168:171]
    ds_read_b64_tr_b16 a[216:217], v99 offset:0
    v_lshl_add_u32 v19, v14, 3, v19
    v_mfma_f32_16x16x32_bf16 v[168:171], a[148:151], a[180:183], v[168:171]
    ds_read_b64_tr_b16 a[218:219], v99 offset:4096
    v_mfma_f32_16x16x32_bf16 v[184:187], a[148:151], a[188:191], v[184:187]
    ds_read_b64_tr_b16 a[220:221], v99 offset:8192
    v_lshlrev_b32 v20, 1, v19
    v_mfma_f32_16x16x32_bf16 v[184:187], a[144:147], a[184:187], v[184:187]
    buffer_load_dwordx4 v117, s[12:15], s23 offen offset:2048 sc1 lds
    ds_read_b64_tr_b16 a[222:223], v99 offset:12288
    v_mfma_f32_16x16x32_bf16 v[188:191], a[152:155], a[184:187], v[188:191]
    s_lshl_b32 s34, s20, 3
    v_mfma_f32_16x16x32_bf16 v[188:191], a[156:159], a[188:191], v[188:191]
    v_mfma_f32_16x16x32_bf16 v[172:175], a[156:159], a[180:183], v[172:175]
    v_add_u32 v21, s34, v13
    v_mfma_f32_16x16x32_bf16 v[172:175], a[152:155], a[176:179], v[172:175]
    buffer_load_dwordx4 v117, s[12:15], s23 offen offset:3072 sc1 lds
    s_add_u32 s23, s23, 2048
    s_and_b32 s23, s23, 0x7fff
    v_mfma_f32_16x16x32_bf16 v[156:159], a[152:155], a[168:171], v[156:159]
    v_lshl_add_u32 v19, v21, 10, v19
    v_mfma_f32_16x16x32_bf16 v[156:159], a[156:159], a[172:175], v[156:159]
    v_mfma_f32_16x16x32_bf16 v[140:143], a[156:159], a[164:167], v[140:143]
    v_add_u32 v23, 4096, v20
    v_mfma_f32_16x16x32_bf16 v[140:143], a[152:155], a[160:163], v[140:143]
    s_waitcnt lgkmcnt(0)
    s_waitcnt vmcnt(16)
    s_barrier
    v_mfma_f32_16x16x32_bf16 v[128:131], a[192:195], a[224:227], v[128:131]
    ds_read_b64_tr_b16 a[128:129], v102 offset:16384
    v_add_u32 v21, 8192, v20
    s_add_u32 m0, s26, 131072
    v_mfma_f32_16x16x32_bf16 v[128:131], a[196:199], a[228:231], v[128:131]
    buffer_load_dwordx4 v108, s[40:43], s44 offen offset:0 lds
    ds_read_b64_tr_b16 a[130:131], v102 offset:20480
    v_mfma_f32_16x16x32_bf16 v[144:147], a[196:199], a[236:239], v[144:147]
    ds_read_b64_tr_b16 a[132:133], v102 offset:24576
    v_lshlrev_b32 v16, 3, v13
    v_mfma_f32_16x16x32_bf16 v[144:147], a[192:195], a[232:235], v[144:147]
    ds_read_b64_tr_b16 a[134:135], v102 offset:28672
    v_mfma_f32_16x16x32_bf16 v[160:163], a[192:195], a[240:243], v[160:163]
    buffer_load_dwordx4 v109, s[40:43], s44 offen offset:1024 lds
    ds_read_b128 a[160:163], v106 offset:0
    v_add_u32 v16, 28672, v16
    v_mfma_f32_16x16x32_bf16 v[160:163], a[196:199], a[244:247], v[160:163]
    ds_read_b128 a[164:167], v106 offset:1024
    v_mfma_f32_16x16x32_bf16 v[176:179], a[196:199], a[252:255], v[176:179]
    ds_read_b128 a[168:171], v106 offset:2048
    v_lshl_add_u32 v17, v115, 6, v16
    v_mfma_f32_16x16x32_bf16 v[176:179], a[192:195], a[248:251], v[176:179]
    ds_read_b128 a[172:175], v106 offset:3072
    v_mfma_f32_16x16x32_bf16 v[180:183], a[200:203], a[248:251], v[180:183]
    buffer_load_dwordx4 v110, s[40:43], s44 offen offset:2048 lds
    ds_read_b128 a[176:179], v106 offset:4096
    s_mov_b32 s8, s58
    v_mfma_f32_16x16x32_bf16 v[180:183], a[204:207], a[252:255], v[180:183]
    ds_read_b128 a[180:183], v106 offset:5120
    v_mfma_f32_16x16x32_bf16 v[164:167], a[204:207], a[244:247], v[164:167]
    ds_read_b128 a[184:187], v106 offset:6144
    s_mov_b32 s9, s59
    v_mfma_f32_16x16x32_bf16 v[164:167], a[200:203], a[240:243], v[164:167]
    ds_read_b128 a[188:191], v106 offset:7168
    v_mfma_f32_16x16x32_bf16 v[148:151], a[200:203], a[232:235], v[148:151]
    buffer_load_dwordx4 v111, s[40:43], s44 offen offset:3072 lds
    ds_read_b64_tr_b16 a[136:137], v103 offset:16384
    s_mov_b32 s10, 2097152
    s_add_u32 s44, s44, 65536
    s_and_b32 s44, s44, 0xfffff
    v_mfma_f32_16x16x32_bf16 v[148:151], a[204:207], a[236:239], v[148:151]
    ds_read_b64_tr_b16 a[138:139], v103 offset:20480
    v_mfma_f32_16x16x32_bf16 v[132:135], a[204:207], a[228:231], v[132:135]
    ds_read_b64_tr_b16 a[140:141], v103 offset:24576
    s_mov_b32 s11, 0x20000
    v_mfma_f32_16x16x32_bf16 v[132:135], a[200:203], a[224:227], v[132:135]
    ds_read_b64_tr_b16 a[142:143], v103 offset:28672
    s_add_u32 m0, s26, 114688
    v_mfma_f32_16x16x32_bf16 v[136:139], a[208:211], a[224:227], v[136:139]
    buffer_load_dwordx4 v116, s[12:15], s23 offen offset:0 sc1 lds
    ds_read_b64_tr_b16 a[144:145], v104 offset:16384
    s_mov_b32 s48, s56
    v_mfma_f32_16x16x32_bf16 v[136:139], a[212:215], a[228:231], v[136:139]
    ds_read_b64_tr_b16 a[146:147], v104 offset:20480
    v_mfma_f32_16x16x32_bf16 v[152:155], a[212:215], a[236:239], v[152:155]
    ds_read_b64_tr_b16 a[148:149], v104 offset:24576
    s_mov_b32 s49, s57
    v_mfma_f32_16x16x32_bf16 v[152:155], a[208:211], a[232:235], v[152:155]
    buffer_load_dwordx4 v116, s[12:15], s23 offen offset:1024 sc1 lds
    ds_read_b64_tr_b16 a[150:151], v104 offset:28672
    v_mfma_f32_16x16x32_bf16 v[168:171], a[208:211], a[240:243], v[168:171]
    ds_read_b64_tr_b16 a[152:153], v105 offset:16384
    s_mov_b32 s50, 12288
    v_mfma_f32_16x16x32_bf16 v[168:171], a[212:215], a[244:247], v[168:171]
    ds_read_b64_tr_b16 a[154:155], v105 offset:20480
    v_mfma_f32_16x16x32_bf16 v[184:187], a[212:215], a[252:255], v[184:187]
    ds_read_b64_tr_b16 a[156:157], v105 offset:24576
    s_mov_b32 s51, 0x20000
    v_mfma_f32_16x16x32_bf16 v[184:187], a[208:211], a[248:251], v[184:187]
    buffer_load_dwordx4 v117, s[12:15], s23 offen offset:2048 sc1 lds
    ds_read_b64_tr_b16 a[158:159], v105 offset:28672
    v_mfma_f32_16x16x32_bf16 v[188:191], a[216:219], a[248:251], v[188:191]
    v_mfma_f32_16x16x32_bf16 v[188:191], a[220:223], a[252:255], v[188:191]
    v_mfma_f32_16x16x32_bf16 v[172:175], a[220:223], a[244:247], v[172:175]
    buffer_load_dword v112, v100, s[4:7], s30 offen sc1
    s_add_u32 s30, s30, 2048
    v_mfma_f32_16x16x32_bf16 v[172:175], a[216:219], a[240:243], v[172:175]
    buffer_load_dwordx4 v117, s[12:15], s23 offen offset:3072 sc1 lds
    s_add_u32 s23, s23, 2048
    s_and_b32 s23, s23, 0x7fff
    v_mfma_f32_16x16x32_bf16 v[156:159], a[216:219], a[232:235], v[156:159]
    v_mfma_f32_16x16x32_bf16 v[156:159], a[220:223], a[236:239], v[156:159]
    v_mfma_f32_16x16x32_bf16 v[140:143], a[220:223], a[228:231], v[140:143]
    v_mfma_f32_16x16x32_bf16 v[140:143], a[216:219], a[224:227], v[140:143]
    s_waitcnt lgkmcnt(0)
    s_waitcnt vmcnt(17)
    s_barrier
    v_mfma_f32_16x16x32_bf16 v[128:131], a[128:131], a[160:163], v[128:131]
    ds_read_b64_tr_b16 a[192:193], v96 offset:16384
    s_add_u32 m0, s26, 16384
    v_mfma_f32_16x16x32_bf16 v[128:131], a[132:135], a[164:167], v[128:131]
    buffer_load_dwordx4 v108, s[40:43], s44 offen offset:0 lds
    ds_read_b64_tr_b16 a[194:195], v96 offset:20480
    v_mfma_f32_16x16x32_bf16 v[144:147], a[132:135], a[172:175], v[144:147]
    ds_read_b64_tr_b16 a[196:197], v96 offset:24576
    v_mfma_f32_16x16x32_bf16 v[144:147], a[128:131], a[168:171], v[144:147]
    ds_read_b64_tr_b16 a[198:199], v96 offset:28672
    v_mfma_f32_16x16x32_bf16 v[160:163], a[128:131], a[176:179], v[160:163]
    buffer_load_dwordx4 v109, s[40:43], s44 offen offset:1024 lds
    ds_read_b128 a[224:227], v106 offset:16384
    v_mfma_f32_16x16x32_bf16 v[160:163], a[132:135], a[180:183], v[160:163]
    ds_read_b128 a[228:231], v106 offset:17408
    v_mfma_f32_16x16x32_bf16 v[176:179], a[132:135], a[188:191], v[176:179]
    ds_read_b128 a[232:235], v106 offset:18432
    v_mfma_f32_16x16x32_bf16 v[176:179], a[128:131], a[184:187], v[176:179]
    ds_read_b128 a[236:239], v106 offset:19456
    v_mfma_f32_16x16x32_bf16 v[180:183], a[136:139], a[184:187], v[180:183]
    buffer_load_dwordx4 v110, s[40:43], s44 offen offset:2048 lds
    ds_read_b128 a[240:243], v106 offset:20480
    v_mfma_f32_16x16x32_bf16 v[180:183], a[140:143], a[188:191], v[180:183]
    ds_read_b128 a[244:247], v106 offset:21504
    v_mfma_f32_16x16x32_bf16 v[164:167], a[140:143], a[180:183], v[164:167]
    ds_read_b128 a[248:251], v106 offset:22528
    v_mfma_f32_16x16x32_bf16 v[164:167], a[136:139], a[176:179], v[164:167]
    ds_read_b128 a[252:255], v106 offset:23552
    v_mfma_f32_16x16x32_bf16 v[148:151], a[136:139], a[168:171], v[148:151]
    buffer_load_dwordx4 v111, s[40:43], s44 offen offset:3072 lds
    ds_read_b64_tr_b16 a[200:201], v97 offset:16384
    s_add_u32 s44, s44, 65536
    s_and_b32 s44, s44, 0xfffff
    v_mfma_f32_16x16x32_bf16 v[148:151], a[140:143], a[172:175], v[148:151]
    ds_read_b64_tr_b16 a[202:203], v97 offset:20480
    v_mfma_f32_16x16x32_bf16 v[132:135], a[140:143], a[164:167], v[132:135]
    ds_read_b64_tr_b16 a[204:205], v97 offset:24576
    v_mfma_f32_16x16x32_bf16 v[132:135], a[136:139], a[160:163], v[132:135]
    ds_read_b64_tr_b16 a[206:207], v97 offset:28672
    s_add_u32 m0, s26, 65536
    v_mfma_f32_16x16x32_bf16 v[136:139], a[144:147], a[160:163], v[136:139]
    buffer_load_dwordx4 v116, s[12:15], s23 offen offset:0 sc1 lds
    ds_read_b64_tr_b16 a[208:209], v98 offset:16384
    v_mfma_f32_16x16x32_bf16 v[136:139], a[148:151], a[164:167], v[136:139]
    ds_read_b64_tr_b16 a[210:211], v98 offset:20480
    v_mfma_f32_16x16x32_bf16 v[152:155], a[148:151], a[172:175], v[152:155]
    ds_read_b64_tr_b16 a[212:213], v98 offset:24576
    v_mfma_f32_16x16x32_bf16 v[152:155], a[144:147], a[168:171], v[152:155]
    buffer_load_dwordx4 v116, s[12:15], s23 offen offset:1024 sc1 lds
    ds_read_b64_tr_b16 a[214:215], v98 offset:28672
    v_mfma_f32_16x16x32_bf16 v[168:171], a[144:147], a[176:179], v[168:171]
    ds_read_b64_tr_b16 a[216:217], v99 offset:16384
    v_mfma_f32_16x16x32_bf16 v[168:171], a[148:151], a[180:183], v[168:171]
    ds_read_b64_tr_b16 a[218:219], v99 offset:20480
    v_mfma_f32_16x16x32_bf16 v[184:187], a[148:151], a[188:191], v[184:187]
    ds_read_b64_tr_b16 a[220:221], v99 offset:24576
    v_mfma_f32_16x16x32_bf16 v[184:187], a[144:147], a[184:187], v[184:187]
    buffer_load_dwordx4 v117, s[12:15], s23 offen offset:2048 sc1 lds
    ds_read_b64_tr_b16 a[222:223], v99 offset:28672
    v_mfma_f32_16x16x32_bf16 v[188:191], a[152:155], a[184:187], v[188:191]
    v_mfma_f32_16x16x32_bf16 v[188:191], a[156:159], a[188:191], v[188:191]
    v_mfma_f32_16x16x32_bf16 v[172:175], a[156:159], a[180:183], v[172:175]
    buffer_load_dword v112, v100, s[4:7], s30 offen sc1
    s_add_u32 s30, s30, 2048
    v_mfma_f32_16x16x32_bf16 v[172:175], a[152:155], a[176:179], v[172:175]
    buffer_load_dwordx4 v117, s[12:15], s23 offen offset:3072 sc1 lds
    s_add_u32 s23, s23, 2048
    s_and_b32 s23, s23, 0x7fff
    v_mfma_f32_16x16x32_bf16 v[156:159], a[152:155], a[168:171], v[156:159]
    v_mfma_f32_16x16x32_bf16 v[156:159], a[156:159], a[172:175], v[156:159]
    v_mfma_f32_16x16x32_bf16 v[140:143], a[156:159], a[164:167], v[140:143]
    v_mfma_f32_16x16x32_bf16 v[140:143], a[152:155], a[160:163], v[140:143]
    s_waitcnt lgkmcnt(0)
    s_waitcnt vmcnt(18)
    s_barrier
    v_mfma_f32_16x16x32_bf16 v[128:131], a[192:195], a[224:227], v[128:131]
    ds_read_b64_tr_b16 a[128:129], v102 offset:32768
    s_add_u32 m0, s26, 147456
    v_mfma_f32_16x16x32_bf16 v[128:131], a[196:199], a[228:231], v[128:131]
    buffer_load_dwordx4 v108, s[40:43], s44 offen offset:0 lds
    ds_read_b64_tr_b16 a[130:131], v102 offset:36864
    v_mfma_f32_16x16x32_bf16 v[144:147], a[196:199], a[236:239], v[144:147]
    ds_read_b64_tr_b16 a[132:133], v102 offset:40960
    v_mfma_f32_16x16x32_bf16 v[144:147], a[192:195], a[232:235], v[144:147]
    ds_read_b64_tr_b16 a[134:135], v102 offset:45056
    v_mfma_f32_16x16x32_bf16 v[160:163], a[192:195], a[240:243], v[160:163]
    buffer_load_dwordx4 v109, s[40:43], s44 offen offset:1024 lds
    ds_read_b128 a[160:163], v106 offset:32768
    v_mfma_f32_16x16x32_bf16 v[160:163], a[196:199], a[244:247], v[160:163]
    ds_read_b128 a[164:167], v106 offset:33792
    v_mfma_f32_16x16x32_bf16 v[176:179], a[196:199], a[252:255], v[176:179]
    ds_read_b128 a[168:171], v106 offset:34816
    v_mfma_f32_16x16x32_bf16 v[176:179], a[192:195], a[248:251], v[176:179]
    ds_read_b128 a[172:175], v106 offset:35840
    v_mfma_f32_16x16x32_bf16 v[180:183], a[200:203], a[248:251], v[180:183]
    buffer_load_dwordx4 v110, s[40:43], s44 offen offset:2048 lds
    ds_read_b128 a[176:179], v106 offset:36864
    v_mfma_f32_16x16x32_bf16 v[180:183], a[204:207], a[252:255], v[180:183]
    ds_read_b128 a[180:183], v106 offset:37888
    v_mfma_f32_16x16x32_bf16 v[164:167], a[204:207], a[244:247], v[164:167]
    ds_read_b128 a[184:187], v106 offset:38912
    v_mfma_f32_16x16x32_bf16 v[164:167], a[200:203], a[240:243], v[164:167]
    ds_read_b128 a[188:191], v106 offset:39936
    v_mfma_f32_16x16x32_bf16 v[148:151], a[200:203], a[232:235], v[148:151]
    buffer_load_dwordx4 v111, s[40:43], s44 offen offset:3072 lds
    ds_read_b64_tr_b16 a[136:137], v103 offset:32768
    s_add_u32 s44, s44, 65536
    s_and_b32 s44, s44, 0xfffff
    v_mfma_f32_16x16x32_bf16 v[148:151], a[204:207], a[236:239], v[148:151]
    ds_read_b64_tr_b16 a[138:139], v103 offset:36864
    v_mfma_f32_16x16x32_bf16 v[132:135], a[204:207], a[228:231], v[132:135]
    ds_read_b64_tr_b16 a[140:141], v103 offset:40960
    v_mfma_f32_16x16x32_bf16 v[132:135], a[200:203], a[224:227], v[132:135]
    ds_read_b64_tr_b16 a[142:143], v103 offset:45056
    s_add_u32 m0, s26, 81920
    v_mfma_f32_16x16x32_bf16 v[136:139], a[208:211], a[224:227], v[136:139]
    buffer_load_dwordx4 v116, s[12:15], s23 offen offset:0 sc1 lds
    ds_read_b64_tr_b16 a[144:145], v104 offset:32768
    v_mfma_f32_16x16x32_bf16 v[136:139], a[212:215], a[228:231], v[136:139]
    ds_read_b64_tr_b16 a[146:147], v104 offset:36864
    v_mfma_f32_16x16x32_bf16 v[152:155], a[212:215], a[236:239], v[152:155]
    ds_read_b64_tr_b16 a[148:149], v104 offset:40960
    v_mfma_f32_16x16x32_bf16 v[152:155], a[208:211], a[232:235], v[152:155]
    buffer_load_dwordx4 v116, s[12:15], s23 offen offset:1024 sc1 lds
    ds_read_b64_tr_b16 a[150:151], v104 offset:45056
    v_mfma_f32_16x16x32_bf16 v[168:171], a[208:211], a[240:243], v[168:171]
    ds_read_b64_tr_b16 a[152:153], v105 offset:32768
    v_mfma_f32_16x16x32_bf16 v[168:171], a[212:215], a[244:247], v[168:171]
    ds_read_b64_tr_b16 a[154:155], v105 offset:36864
    v_mfma_f32_16x16x32_bf16 v[184:187], a[212:215], a[252:255], v[184:187]
    ds_read_b64_tr_b16 a[156:157], v105 offset:40960
    v_mfma_f32_16x16x32_bf16 v[184:187], a[208:211], a[248:251], v[184:187]
    buffer_load_dwordx4 v117, s[12:15], s23 offen offset:2048 sc1 lds
    ds_read_b64_tr_b16 a[158:159], v105 offset:45056
    v_mfma_f32_16x16x32_bf16 v[188:191], a[216:219], a[248:251], v[188:191]
    v_mfma_f32_16x16x32_bf16 v[188:191], a[220:223], a[252:255], v[188:191]
    v_mfma_f32_16x16x32_bf16 v[172:175], a[220:223], a[244:247], v[172:175]
    buffer_load_dword v112, v100, s[4:7], s30 offen sc1
    s_add_u32 s30, s30, 2048
    v_mfma_f32_16x16x32_bf16 v[172:175], a[216:219], a[240:243], v[172:175]
    buffer_load_dwordx4 v117, s[12:15], s23 offen offset:3072 sc1 lds
    s_add_u32 s23, s23, 2048
    s_and_b32 s23, s23, 0x7fff
    v_mfma_f32_16x16x32_bf16 v[156:159], a[216:219], a[232:235], v[156:159]
    v_mfma_f32_16x16x32_bf16 v[156:159], a[220:223], a[236:239], v[156:159]
    v_mfma_f32_16x16x32_bf16 v[140:143], a[220:223], a[228:231], v[140:143]
    v_mfma_f32_16x16x32_bf16 v[140:143], a[216:219], a[224:227], v[140:143]
    s_waitcnt lgkmcnt(0)
    s_waitcnt vmcnt(18)
    s_barrier
    v_mfma_f32_16x16x32_bf16 v[128:131], a[128:131], a[160:163], v[128:131]
    ds_read_b64_tr_b16 a[192:193], v102 offset:49152
    s_add_u32 m0, s26, 98304
    v_mfma_f32_16x16x32_bf16 v[128:131], a[132:135], a[164:167], v[128:131]
    buffer_load_dwordx4 v116, s[12:15], s23 offen offset:0 sc1 lds
    ds_read_b64_tr_b16 a[194:195], v102 offset:53248
    v_mfma_f32_16x16x32_bf16 v[144:147], a[132:135], a[172:175], v[144:147]
    ds_read_b64_tr_b16 a[196:197], v102 offset:57344
    v_mfma_f32_16x16x32_bf16 v[144:147], a[128:131], a[168:171], v[144:147]
    ds_read_b64_tr_b16 a[198:199], v102 offset:61440
    v_mfma_f32_16x16x32_bf16 v[160:163], a[128:131], a[176:179], v[160:163]
    ds_read_b128 a[224:227], v106 offset:49152
    v_mfma_f32_16x16x32_bf16 v[160:163], a[132:135], a[180:183], v[160:163]
    ds_read_b128 a[228:231], v106 offset:50176
    v_mfma_f32_16x16x32_bf16 v[176:179], a[132:135], a[188:191], v[176:179]
    ds_read_b128 a[232:235], v106 offset:51200
    v_mfma_f32_16x16x32_bf16 v[176:179], a[128:131], a[184:187], v[176:179]
    ds_read_b128 a[236:239], v106 offset:52224
    v_mfma_f32_16x16x32_bf16 v[180:183], a[136:139], a[184:187], v[180:183]
    buffer_load_dwordx4 v116, s[12:15], s23 offen offset:1024 sc1 lds
    ds_read_b128 a[240:243], v106 offset:53248
    v_mfma_f32_16x16x32_bf16 v[180:183], a[140:143], a[188:191], v[180:183]
    ds_read_b128 a[244:247], v106 offset:54272
    v_mfma_f32_16x16x32_bf16 v[164:167], a[140:143], a[180:183], v[164:167]
    ds_read_b128 a[248:251], v106 offset:55296
    v_mfma_f32_16x16x32_bf16 v[164:167], a[136:139], a[176:179], v[164:167]
    ds_read_b128 a[252:255], v106 offset:56320
    v_mfma_f32_16x16x32_bf16 v[148:151], a[136:139], a[168:171], v[148:151]
    ds_read_b64_tr_b16 a[200:201], v103 offset:49152
    v_mfma_f32_16x16x32_bf16 v[148:151], a[140:143], a[172:175], v[148:151]
    ds_read_b64_tr_b16 a[202:203], v103 offset:53248
    v_mfma_f32_16x16x32_bf16 v[132:135], a[140:143], a[164:167], v[132:135]
    ds_read_b64_tr_b16 a[204:205], v103 offset:57344
    v_mfma_f32_16x16x32_bf16 v[132:135], a[136:139], a[160:163], v[132:135]
    ds_read_b64_tr_b16 a[206:207], v103 offset:61440
    v_mfma_f32_16x16x32_bf16 v[136:139], a[144:147], a[160:163], v[136:139]
    buffer_load_dwordx4 v117, s[12:15], s23 offen offset:2048 sc1 lds
    ds_read_b64_tr_b16 a[208:209], v104 offset:49152
    v_mfma_f32_16x16x32_bf16 v[136:139], a[148:151], a[164:167], v[136:139]
    ds_read_b64_tr_b16 a[210:211], v104 offset:53248
    v_mfma_f32_16x16x32_bf16 v[152:155], a[148:151], a[172:175], v[152:155]
    ds_read_b64_tr_b16 a[212:213], v104 offset:57344
    v_mfma_f32_16x16x32_bf16 v[152:155], a[144:147], a[168:171], v[152:155]
    ds_read_b64_tr_b16 a[214:215], v104 offset:61440
    v_mfma_f32_16x16x32_bf16 v[168:171], a[144:147], a[176:179], v[168:171]
    ds_read_b64_tr_b16 a[216:217], v105 offset:49152
    v_mfma_f32_16x16x32_bf16 v[168:171], a[148:151], a[180:183], v[168:171]
    ds_read_b64_tr_b16 a[218:219], v105 offset:53248
    v_mfma_f32_16x16x32_bf16 v[184:187], a[148:151], a[188:191], v[184:187]
    ds_read_b64_tr_b16 a[220:221], v105 offset:57344
    v_mfma_f32_16x16x32_bf16 v[184:187], a[144:147], a[184:187], v[184:187]
    buffer_load_dwordx4 v117, s[12:15], s23 offen offset:3072 sc1 lds
    ds_read_b64_tr_b16 a[222:223], v105 offset:61440
    s_add_u32 s23, s23, 2048
    s_and_b32 s23, s23, 0x7fff
    v_mfma_f32_16x16x32_bf16 v[188:191], a[152:155], a[184:187], v[188:191]
    v_mfma_f32_16x16x32_bf16 v[188:191], a[156:159], a[188:191], v[188:191]
    v_mfma_f32_16x16x32_bf16 v[172:175], a[156:159], a[180:183], v[172:175]
    buffer_load_dword v112, v100, s[4:7], s30 offen sc1
    s_add_u32 s30, s30, 2048
    v_mfma_f32_16x16x32_bf16 v[172:175], a[152:155], a[176:179], v[172:175]
    v_mfma_f32_16x16x32_bf16 v[156:159], a[152:155], a[168:171], v[156:159]
    v_mfma_f32_16x16x32_bf16 v[156:159], a[156:159], a[172:175], v[156:159]
    v_mfma_f32_16x16x32_bf16 v[140:143], a[156:159], a[164:167], v[140:143]
    v_mfma_f32_16x16x32_bf16 v[140:143], a[152:155], a[160:163], v[140:143]
    s_waitcnt lgkmcnt(0)
    s_waitcnt vmcnt(14)
    s_barrier
    v_mfma_f32_16x16x32_bf16 v[128:131], a[192:195], a[224:227], v[128:131]
    ds_read_b64_tr_b16 a[128:129], v102 offset:0
    s_add_u32 m0, s26, 114688
    v_mfma_f32_16x16x32_bf16 v[128:131], a[196:199], a[228:231], v[128:131]
    buffer_load_dwordx4 v116, s[12:15], s23 offen offset:0 sc1 lds
    ds_read_b64_tr_b16 a[130:131], v102 offset:4096
    v_mfma_f32_16x16x32_bf16 v[144:147], a[196:199], a[236:239], v[144:147]
    ds_read_b64_tr_b16 a[132:133], v102 offset:8192
    v_mfma_f32_16x16x32_bf16 v[144:147], a[192:195], a[232:235], v[144:147]
    ds_read_b64_tr_b16 a[134:135], v102 offset:12288
    v_mfma_f32_16x16x32_bf16 v[160:163], a[192:195], a[240:243], v[160:163]
    ds_read_b128 a[160:163], v106 offset:0
    v_mfma_f32_16x16x32_bf16 v[160:163], a[196:199], a[244:247], v[160:163]
    ds_read_b128 a[164:167], v106 offset:1024
    v_mfma_f32_16x16x32_bf16 v[176:179], a[196:199], a[252:255], v[176:179]
    ds_read_b128 a[168:171], v106 offset:2048
    v_mfma_f32_16x16x32_bf16 v[176:179], a[192:195], a[248:251], v[176:179]
    ds_read_b128 a[172:175], v106 offset:3072
    v_mfma_f32_16x16x32_bf16 v[180:183], a[200:203], a[248:251], v[180:183]
    buffer_load_dwordx4 v116, s[12:15], s23 offen offset:1024 sc1 lds
    ds_read_b128 a[176:179], v106 offset:4096
    v_mfma_f32_16x16x32_bf16 v[180:183], a[204:207], a[252:255], v[180:183]
    ds_read_b128 a[180:183], v106 offset:5120
    v_mfma_f32_16x16x32_bf16 v[164:167], a[204:207], a[244:247], v[164:167]
    ds_read_b128 a[184:187], v106 offset:6144
    v_mfma_f32_16x16x32_bf16 v[164:167], a[200:203], a[240:243], v[164:167]
    ds_read_b128 a[188:191], v106 offset:7168
    v_mfma_f32_16x16x32_bf16 v[148:151], a[200:203], a[232:235], v[148:151]
    ds_read_b64_tr_b16 a[136:137], v103 offset:0
    v_mfma_f32_16x16x32_bf16 v[148:151], a[204:207], a[236:239], v[148:151]
    ds_read_b64_tr_b16 a[138:139], v103 offset:4096
    v_mfma_f32_16x16x32_bf16 v[132:135], a[204:207], a[228:231], v[132:135]
    ds_read_b64_tr_b16 a[140:141], v103 offset:8192
    v_mfma_f32_16x16x32_bf16 v[132:135], a[200:203], a[224:227], v[132:135]
    ds_read_b64_tr_b16 a[142:143], v103 offset:12288
    v_mfma_f32_16x16x32_bf16 v[136:139], a[208:211], a[224:227], v[136:139]
    buffer_load_dwordx4 v117, s[12:15], s23 offen offset:2048 sc1 lds
    ds_read_b64_tr_b16 a[144:145], v104 offset:0
    v_mfma_f32_16x16x32_bf16 v[136:139], a[212:215], a[228:231], v[136:139]
    ds_read_b64_tr_b16 a[146:147], v104 offset:4096
    v_mfma_f32_16x16x32_bf16 v[152:155], a[212:215], a[236:239], v[152:155]
    ds_read_b64_tr_b16 a[148:149], v104 offset:8192
    v_mfma_f32_16x16x32_bf16 v[152:155], a[208:211], a[232:235], v[152:155]
    ds_read_b64_tr_b16 a[150:151], v104 offset:12288
    v_mfma_f32_16x16x32_bf16 v[168:171], a[208:211], a[240:243], v[168:171]
    ds_read_b64_tr_b16 a[152:153], v105 offset:0
    v_mfma_f32_16x16x32_bf16 v[168:171], a[212:215], a[244:247], v[168:171]
    ds_read_b64_tr_b16 a[154:155], v105 offset:4096
    v_mfma_f32_16x16x32_bf16 v[184:187], a[212:215], a[252:255], v[184:187]
    ds_read_b64_tr_b16 a[156:157], v105 offset:8192
    v_mfma_f32_16x16x32_bf16 v[184:187], a[208:211], a[248:251], v[184:187]
    buffer_load_dwordx4 v117, s[12:15], s23 offen offset:3072 sc1 lds
    ds_read_b64_tr_b16 a[158:159], v105 offset:12288
    s_add_u32 s23, s23, 2048
    s_and_b32 s23, s23, 0x7fff
    v_mfma_f32_16x16x32_bf16 v[188:191], a[216:219], a[248:251], v[188:191]
    v_mfma_f32_16x16x32_bf16 v[188:191], a[220:223], a[252:255], v[188:191]
    v_mfma_f32_16x16x32_bf16 v[172:175], a[220:223], a[244:247], v[172:175]
    buffer_load_dword v112, v100, s[4:7], s30 offen sc1
    s_add_u32 s30, s30, 2048
    v_mfma_f32_16x16x32_bf16 v[172:175], a[216:219], a[240:243], v[172:175]
    v_mfma_f32_16x16x32_bf16 v[156:159], a[216:219], a[232:235], v[156:159]
    v_mfma_f32_16x16x32_bf16 v[156:159], a[220:223], a[236:239], v[156:159]
    v_mfma_f32_16x16x32_bf16 v[140:143], a[220:223], a[228:231], v[140:143]
    v_mfma_f32_16x16x32_bf16 v[140:143], a[216:219], a[224:227], v[140:143]
    s_waitcnt lgkmcnt(0)
    s_waitcnt vmcnt(10)
    s_barrier
    v_mfma_f32_16x16x32_bf16 v[128:131], a[128:131], a[160:163], v[128:131]
    ds_read_b64_tr_b16 a[192:193], v96 offset:0
    v_mfma_f32_16x16x32_bf16 v[128:131], a[132:135], a[164:167], v[128:131]
    buffer_load_dwordx2 v[24:25], v19, s[8:11], 0 offen offset:0
    ds_read_b64_tr_b16 a[194:195], v96 offset:4096
    v_mfma_f32_16x16x32_bf16 v[144:147], a[132:135], a[172:175], v[144:147]
    buffer_load_dwordx2 v[26:27], v19, s[8:11], 0 offen offset:32
    ds_read_b64_tr_b16 a[196:197], v96 offset:8192
    v_mfma_f32_16x16x32_bf16 v[144:147], a[128:131], a[168:171], v[144:147]
    ds_read_b64_tr_b16 a[198:199], v96 offset:12288
    v_mfma_f32_16x16x32_bf16 v[160:163], a[128:131], a[176:179], v[160:163]
    buffer_load_dwordx2 v[28:29], v19, s[8:11], 0 offen offset:128
    ds_read_b128 a[224:227], v106 offset:16384
    v_mfma_f32_16x16x32_bf16 v[160:163], a[132:135], a[180:183], v[160:163]
    ds_read_b128 a[228:231], v106 offset:17408
    v_mfma_f32_16x16x32_bf16 v[176:179], a[132:135], a[188:191], v[176:179]
    buffer_load_dwordx2 v[30:31], v19, s[8:11], 0 offen offset:160
    ds_read_b128 a[232:235], v106 offset:18432
    v_mfma_f32_16x16x32_bf16 v[176:179], a[128:131], a[184:187], v[176:179]
    ds_read_b128 a[236:239], v106 offset:19456
    v_mfma_f32_16x16x32_bf16 v[180:183], a[136:139], a[184:187], v[180:183]
    buffer_load_dwordx4 v[32:35], v23, s[48:51], 0 offen offset:0 sc1
    ds_read_b128 a[240:243], v106 offset:20480
    v_mfma_f32_16x16x32_bf16 v[180:183], a[140:143], a[188:191], v[180:183]
    ds_read_b128 a[244:247], v106 offset:21504
    v_mfma_f32_16x16x32_bf16 v[164:167], a[140:143], a[180:183], v[164:167]
    buffer_load_dwordx4 v[36:39], v23, s[48:51], 0 offen offset:64 sc1
    ds_read_b128 a[248:251], v106 offset:22528
    v_mfma_f32_16x16x32_bf16 v[164:167], a[136:139], a[176:179], v[164:167]
    ds_read_b128 a[252:255], v106 offset:23552
    v_mfma_f32_16x16x32_bf16 v[148:151], a[136:139], a[168:171], v[148:151]
    buffer_load_dwordx4 v[40:43], v23, s[48:51], 0 offen offset:256 sc1
    ds_read_b64_tr_b16 a[200:201], v97 offset:0
    v_mfma_f32_16x16x32_bf16 v[148:151], a[140:143], a[172:175], v[148:151]
    ds_read_b64_tr_b16 a[202:203], v97 offset:4096
    v_mfma_f32_16x16x32_bf16 v[132:135], a[140:143], a[164:167], v[132:135]
    buffer_load_dwordx4 v[44:47], v23, s[48:51], 0 offen offset:320 sc1
    ds_read_b64_tr_b16 a[204:205], v97 offset:8192
    v_mfma_f32_16x16x32_bf16 v[132:135], a[136:139], a[160:163], v[132:135]
    ds_read_b64_tr_b16 a[206:207], v97 offset:12288
    v_mfma_f32_16x16x32_bf16 v[136:139], a[144:147], a[160:163], v[136:139]
    buffer_load_dwordx4 v[48:51], v23, s[48:51], 0 offen offset:2048 sc1
    ds_read_b64_tr_b16 a[208:209], v98 offset:0
    v_mfma_f32_16x16x32_bf16 v[136:139], a[148:151], a[164:167], v[136:139]
    ds_read_b64_tr_b16 a[210:211], v98 offset:4096
    v_mfma_f32_16x16x32_bf16 v[152:155], a[148:151], a[172:175], v[152:155]
    buffer_load_dwordx4 v[52:55], v23, s[48:51], 0 offen offset:2112 sc1
    ds_read_b64_tr_b16 a[212:213], v98 offset:8192
    v_mfma_f32_16x16x32_bf16 v[152:155], a[144:147], a[168:171], v[152:155]
    ds_read_b64_tr_b16 a[214:215], v98 offset:12288
    v_mfma_f32_16x16x32_bf16 v[168:171], a[144:147], a[176:179], v[168:171]
    buffer_load_dwordx4 v[56:59], v23, s[48:51], 0 offen offset:2304 sc1
    ds_read_b64_tr_b16 a[216:217], v99 offset:0
    v_mfma_f32_16x16x32_bf16 v[168:171], a[148:151], a[180:183], v[168:171]
    ds_read_b64_tr_b16 a[218:219], v99 offset:4096
    v_mfma_f32_16x16x32_bf16 v[184:187], a[148:151], a[188:191], v[184:187]
    buffer_load_dwordx4 v[60:63], v23, s[48:51], 0 offen offset:2368 sc1
    ds_read_b64_tr_b16 a[220:221], v99 offset:8192
    v_mfma_f32_16x16x32_bf16 v[184:187], a[144:147], a[184:187], v[184:187]
    ds_read_b64_tr_b16 a[222:223], v99 offset:12288
    v_mfma_f32_16x16x32_bf16 v[188:191], a[152:155], a[184:187], v[188:191]
    buffer_load_dwordx4 v[64:67], v21, s[48:51], 0 offen offset:0 sc1
    v_mfma_f32_16x16x32_bf16 v[188:191], a[156:159], a[188:191], v[188:191]
    v_mfma_f32_16x16x32_bf16 v[172:175], a[156:159], a[180:183], v[172:175]
    buffer_load_dwordx4 v[68:71], v21, s[48:51], 0 offen offset:64 sc1
    buffer_load_dword v112, v100, s[4:7], s30 offen sc1
    s_add_u32 s30, s30, 2048
    v_mfma_f32_16x16x32_bf16 v[172:175], a[152:155], a[176:179], v[172:175]
    v_mfma_f32_16x16x32_bf16 v[156:159], a[152:155], a[168:171], v[156:159]
    buffer_load_dwordx4 v[72:75], v21, s[48:51], 0 offen offset:256 sc1
    v_mfma_f32_16x16x32_bf16 v[156:159], a[156:159], a[172:175], v[156:159]
    v_mfma_f32_16x16x32_bf16 v[140:143], a[156:159], a[164:167], v[140:143]
    buffer_load_dwordx4 v[76:79], v21, s[48:51], 0 offen offset:320 sc1
    v_mfma_f32_16x16x32_bf16 v[140:143], a[152:155], a[160:163], v[140:143]
    s_waitcnt lgkmcnt(0)
    s_waitcnt vmcnt(23)
    s_barrier
    v_mfma_f32_16x16x32_bf16 v[128:131], a[192:195], a[224:227], v[128:131]
    ds_read_b64_tr_b16 a[128:129], v102 offset:16384
    v_mfma_f32_16x16x32_bf16 v[128:131], a[196:199], a[228:231], v[128:131]
    ds_read_b64_tr_b16 a[130:131], v102 offset:20480
    v_mfma_f32_16x16x32_bf16 v[144:147], a[196:199], a[236:239], v[144:147]
    ds_read_b64_tr_b16 a[132:133], v102 offset:24576
    v_mfma_f32_16x16x32_bf16 v[144:147], a[192:195], a[232:235], v[144:147]
    ds_read_b64_tr_b16 a[134:135], v102 offset:28672
    v_mfma_f32_16x16x32_bf16 v[160:163], a[192:195], a[240:243], v[160:163]
    ds_read_b128 a[160:163], v106 offset:32768
    v_mfma_f32_16x16x32_bf16 v[160:163], a[196:199], a[244:247], v[160:163]
    ds_read_b128 a[164:167], v106 offset:33792
    v_mfma_f32_16x16x32_bf16 v[176:179], a[196:199], a[252:255], v[176:179]
    ds_read_b128 a[168:171], v106 offset:34816
    v_mfma_f32_16x16x32_bf16 v[176:179], a[192:195], a[248:251], v[176:179]
    ds_read_b128 a[172:175], v106 offset:35840
    v_mfma_f32_16x16x32_bf16 v[180:183], a[200:203], a[248:251], v[180:183]
    ds_read_b128 a[176:179], v106 offset:36864
    v_mfma_f32_16x16x32_bf16 v[180:183], a[204:207], a[252:255], v[180:183]
    ds_read_b128 a[180:183], v106 offset:37888
    v_mfma_f32_16x16x32_bf16 v[164:167], a[204:207], a[244:247], v[164:167]
    ds_read_b128 a[184:187], v106 offset:38912
    v_mfma_f32_16x16x32_bf16 v[164:167], a[200:203], a[240:243], v[164:167]
    ds_read_b128 a[188:191], v106 offset:39936
    v_mfma_f32_16x16x32_bf16 v[148:151], a[200:203], a[232:235], v[148:151]
    ds_read_b64_tr_b16 a[136:137], v103 offset:16384
    v_mfma_f32_16x16x32_bf16 v[148:151], a[204:207], a[236:239], v[148:151]
    ds_read_b64_tr_b16 a[138:139], v103 offset:20480
    v_mfma_f32_16x16x32_bf16 v[132:135], a[204:207], a[228:231], v[132:135]
    ds_read_b64_tr_b16 a[140:141], v103 offset:24576
    v_mfma_f32_16x16x32_bf16 v[132:135], a[200:203], a[224:227], v[132:135]
    ds_read_b64_tr_b16 a[142:143], v103 offset:28672
    v_mfma_f32_16x16x32_bf16 v[136:139], a[208:211], a[224:227], v[136:139]
    ds_read_b64_tr_b16 a[144:145], v104 offset:16384
    v_mfma_f32_16x16x32_bf16 v[136:139], a[212:215], a[228:231], v[136:139]
    ds_read_b64_tr_b16 a[146:147], v104 offset:20480
    v_mfma_f32_16x16x32_bf16 v[152:155], a[212:215], a[236:239], v[152:155]
    ds_read_b64_tr_b16 a[148:149], v104 offset:24576
    v_mfma_f32_16x16x32_bf16 v[152:155], a[208:211], a[232:235], v[152:155]
    ds_read_b64_tr_b16 a[150:151], v104 offset:28672
    v_mfma_f32_16x16x32_bf16 v[168:171], a[208:211], a[240:243], v[168:171]
    ds_read_b64_tr_b16 a[152:153], v105 offset:16384
    v_mfma_f32_16x16x32_bf16 v[168:171], a[212:215], a[244:247], v[168:171]
    ds_read_b64_tr_b16 a[154:155], v105 offset:20480
    v_mfma_f32_16x16x32_bf16 v[184:187], a[212:215], a[252:255], v[184:187]
    ds_read_b64_tr_b16 a[156:157], v105 offset:24576
    v_mfma_f32_16x16x32_bf16 v[184:187], a[208:211], a[248:251], v[184:187]
    ds_read_b64_tr_b16 a[158:159], v105 offset:28672
    v_mfma_f32_16x16x32_bf16 v[188:191], a[216:219], a[248:251], v[188:191]
    v_mfma_f32_16x16x32_bf16 v[188:191], a[220:223], a[252:255], v[188:191]
    v_mfma_f32_16x16x32_bf16 v[172:175], a[220:223], a[244:247], v[172:175]
    buffer_load_dword v112, v100, s[4:7], s30 offen sc1
    s_add_u32 s30, s30, 2048
    v_mfma_f32_16x16x32_bf16 v[172:175], a[216:219], a[240:243], v[172:175]
    v_mfma_f32_16x16x32_bf16 v[156:159], a[216:219], a[232:235], v[156:159]
    v_mfma_f32_16x16x32_bf16 v[156:159], a[220:223], a[236:239], v[156:159]
    v_mfma_f32_16x16x32_bf16 v[140:143], a[220:223], a[228:231], v[140:143]
    v_mfma_f32_16x16x32_bf16 v[140:143], a[216:219], a[224:227], v[140:143]
    s_waitcnt lgkmcnt(0)
    s_waitcnt vmcnt(19)
    s_barrier
    v_mfma_f32_16x16x32_bf16 v[128:131], a[128:131], a[160:163], v[128:131]
    ds_read_b64_tr_b16 a[192:193], v96 offset:16384
    v_mfma_f32_16x16x32_bf16 v[128:131], a[132:135], a[164:167], v[128:131]
    ds_read_b64_tr_b16 a[194:195], v96 offset:20480
    v_mfma_f32_16x16x32_bf16 v[144:147], a[132:135], a[172:175], v[144:147]
    ds_read_b64_tr_b16 a[196:197], v96 offset:24576
    v_mfma_f32_16x16x32_bf16 v[144:147], a[128:131], a[168:171], v[144:147]
    ds_read_b64_tr_b16 a[198:199], v96 offset:28672
    v_mfma_f32_16x16x32_bf16 v[160:163], a[128:131], a[176:179], v[160:163]
    ds_read_b128 a[224:227], v106 offset:49152
    v_mfma_f32_16x16x32_bf16 v[160:163], a[132:135], a[180:183], v[160:163]
    ds_read_b128 a[228:231], v106 offset:50176
    v_mfma_f32_16x16x32_bf16 v[176:179], a[132:135], a[188:191], v[176:179]
    ds_read_b128 a[232:235], v106 offset:51200
    v_mfma_f32_16x16x32_bf16 v[176:179], a[128:131], a[184:187], v[176:179]
    ds_read_b128 a[236:239], v106 offset:52224
    v_mfma_f32_16x16x32_bf16 v[180:183], a[136:139], a[184:187], v[180:183]
    ds_read_b128 a[240:243], v106 offset:53248
    v_mfma_f32_16x16x32_bf16 v[180:183], a[140:143], a[188:191], v[180:183]
    ds_read_b128 a[244:247], v106 offset:54272
    v_mfma_f32_16x16x32_bf16 v[164:167], a[140:143], a[180:183], v[164:167]
    ds_read_b128 a[248:251], v106 offset:55296
    v_mfma_f32_16x16x32_bf16 v[164:167], a[136:139], a[176:179], v[164:167]
    ds_read_b128 a[252:255], v106 offset:56320
    v_mfma_f32_16x16x32_bf16 v[148:151], a[136:139], a[168:171], v[148:151]
    ds_read_b64_tr_b16 a[200:201], v97 offset:16384
    v_mfma_f32_16x16x32_bf16 v[148:151], a[140:143], a[172:175], v[148:151]
    ds_read_b64_tr_b16 a[202:203], v97 offset:20480
    v_mfma_f32_16x16x32_bf16 v[132:135], a[140:143], a[164:167], v[132:135]
    ds_read_b64_tr_b16 a[204:205], v97 offset:24576
    v_mfma_f32_16x16x32_bf16 v[132:135], a[136:139], a[160:163], v[132:135]
    ds_read_b64_tr_b16 a[206:207], v97 offset:28672
    v_mfma_f32_16x16x32_bf16 v[136:139], a[144:147], a[160:163], v[136:139]
    ds_read_b64_tr_b16 a[208:209], v98 offset:16384
    v_mfma_f32_16x16x32_bf16 v[136:139], a[148:151], a[164:167], v[136:139]
    ds_read_b64_tr_b16 a[210:211], v98 offset:20480
    v_mfma_f32_16x16x32_bf16 v[152:155], a[148:151], a[172:175], v[152:155]
    ds_read_b64_tr_b16 a[212:213], v98 offset:24576
    v_mfma_f32_16x16x32_bf16 v[152:155], a[144:147], a[168:171], v[152:155]
    ds_read_b64_tr_b16 a[214:215], v98 offset:28672
    v_mfma_f32_16x16x32_bf16 v[168:171], a[144:147], a[176:179], v[168:171]
    ds_read_b64_tr_b16 a[216:217], v99 offset:16384
    v_mfma_f32_16x16x32_bf16 v[168:171], a[148:151], a[180:183], v[168:171]
    ds_read_b64_tr_b16 a[218:219], v99 offset:20480
    v_mfma_f32_16x16x32_bf16 v[184:187], a[148:151], a[188:191], v[184:187]
    ds_read_b64_tr_b16 a[220:221], v99 offset:24576
    v_mfma_f32_16x16x32_bf16 v[184:187], a[144:147], a[184:187], v[184:187]
    ds_read_b64_tr_b16 a[222:223], v99 offset:28672
    v_mfma_f32_16x16x32_bf16 v[188:191], a[152:155], a[184:187], v[188:191]
    v_mfma_f32_16x16x32_bf16 v[188:191], a[156:159], a[188:191], v[188:191]
    v_mfma_f32_16x16x32_bf16 v[172:175], a[156:159], a[180:183], v[172:175]
    v_mfma_f32_16x16x32_bf16 v[172:175], a[152:155], a[176:179], v[172:175]
    v_mfma_f32_16x16x32_bf16 v[156:159], a[152:155], a[168:171], v[156:159]
    v_mfma_f32_16x16x32_bf16 v[156:159], a[156:159], a[172:175], v[156:159]
    v_mfma_f32_16x16x32_bf16 v[140:143], a[156:159], a[164:167], v[140:143]
    v_mfma_f32_16x16x32_bf16 v[140:143], a[152:155], a[160:163], v[140:143]
    s_waitcnt lgkmcnt(15)
    v_mfma_f32_16x16x32_bf16 v[128:131], a[192:195], a[224:227], v[128:131]
    v_mfma_f32_16x16x32_bf16 v[128:131], a[196:199], a[228:231], v[128:131]
    v_mfma_f32_16x16x32_bf16 v[144:147], a[196:199], a[236:239], v[144:147]
    v_mfma_f32_16x16x32_bf16 v[144:147], a[192:195], a[232:235], v[144:147]
    s_waitcnt lgkmcnt(14)
    v_mfma_f32_16x16x32_bf16 v[160:163], a[192:195], a[240:243], v[160:163]
    v_mfma_f32_16x16x32_bf16 v[160:163], a[196:199], a[244:247], v[160:163]
    s_waitcnt lgkmcnt(12)
    v_mfma_f32_16x16x32_bf16 v[176:179], a[196:199], a[252:255], v[176:179]
    v_mfma_f32_16x16x32_bf16 v[176:179], a[192:195], a[248:251], v[176:179]
    s_waitcnt lgkmcnt(8)
    v_mfma_f32_16x16x32_bf16 v[180:183], a[200:203], a[248:251], v[180:183]
    v_mfma_f32_16x16x32_bf16 v[180:183], a[204:207], a[252:255], v[180:183]
    v_mfma_f32_16x16x32_bf16 v[164:167], a[204:207], a[244:247], v[164:167]
    v_mfma_f32_16x16x32_bf16 v[164:167], a[200:203], a[240:243], v[164:167]
    v_mfma_f32_16x16x32_bf16 v[148:151], a[200:203], a[232:235], v[148:151]
    v_mfma_f32_16x16x32_bf16 v[148:151], a[204:207], a[236:239], v[148:151]
    v_mfma_f32_16x16x32_bf16 v[132:135], a[204:207], a[228:231], v[132:135]
    v_mfma_f32_16x16x32_bf16 v[132:135], a[200:203], a[224:227], v[132:135]
    s_waitcnt lgkmcnt(4)
    v_mfma_f32_16x16x32_bf16 v[136:139], a[208:211], a[224:227], v[136:139]
    v_mfma_f32_16x16x32_bf16 v[136:139], a[212:215], a[228:231], v[136:139]
    v_mfma_f32_16x16x32_bf16 v[152:155], a[212:215], a[236:239], v[152:155]
    v_mfma_f32_16x16x32_bf16 v[152:155], a[208:211], a[232:235], v[152:155]
    v_cvt_pk_bf16_f32 v204, v176, v177
    v_cvt_pk_bf16_f32 v205, v178, v179
    v_mfma_f32_16x16x32_bf16 v[168:171], a[208:211], a[240:243], v[168:171]
    v_cvt_pk_bf16_f32 v206, v180, v181
    v_cvt_pk_bf16_f32 v207, v182, v183
    v_mfma_f32_16x16x32_bf16 v[168:171], a[212:215], a[244:247], v[168:171]
    buffer_store_dwordx4 v[204:207], v119, s[16:19], s22 offen offset:0 sc1
    v_mfma_f32_16x16x32_bf16 v[184:187], a[212:215], a[252:255], v[184:187]
    v_cvt_pk_bf16_f32 v200, v160, v161
    v_cvt_pk_bf16_f32 v201, v162, v163
    v_mfma_f32_16x16x32_bf16 v[184:187], a[208:211], a[248:251], v[184:187]
    v_cvt_pk_bf16_f32 v202, v164, v165
    v_cvt_pk_bf16_f32 v203, v166, v167
    s_waitcnt lgkmcnt(0)
    v_mfma_f32_16x16x32_bf16 v[188:191], a[216:219], a[248:251], v[188:191]
    buffer_store_dwordx4 v[200:203], v119, s[16:19], 0 offen offset:0 sc1
    v_mfma_f32_16x16x32_bf16 v[188:191], a[220:223], a[252:255], v[188:191]
    v_cvt_pk_bf16_f32 v196, v144, v145
    v_cvt_pk_bf16_f32 v197, v146, v147
    v_mfma_f32_16x16x32_bf16 v[172:175], a[220:223], a[244:247], v[172:175]
    v_cvt_pk_bf16_f32 v198, v148, v149
    v_cvt_pk_bf16_f32 v199, v150, v151
    v_mfma_f32_16x16x32_bf16 v[172:175], a[216:219], a[240:243], v[172:175]
    buffer_store_dwordx4 v[196:199], v118, s[16:19], s22 offen offset:0 sc1
    v_mfma_f32_16x16x32_bf16 v[156:159], a[216:219], a[232:235], v[156:159]
    v_cvt_pk_bf16_f32 v192, v128, v129
    v_cvt_pk_bf16_f32 v193, v130, v131
    v_mfma_f32_16x16x32_bf16 v[156:159], a[220:223], a[236:239], v[156:159]
    v_cvt_pk_bf16_f32 v194, v132, v133
    v_cvt_pk_bf16_f32 v195, v134, v135
    v_mfma_f32_16x16x32_bf16 v[140:143], a[220:223], a[228:231], v[140:143]
    buffer_store_dwordx4 v[192:195], v118, s[16:19], 0 offen offset:0 sc1
    v_mfma_f32_16x16x32_bf16 v[140:143], a[216:219], a[224:227], v[140:143]
    s_nop 3
    v_cvt_pk_bf16_f32 v220, v184, v185
    v_cvt_pk_bf16_f32 v221, v186, v187
    v_cvt_pk_bf16_f32 v222, v188, v189
    v_cvt_pk_bf16_f32 v223, v190, v191
    buffer_store_dwordx4 v[220:223], v119, s[16:19], s22 offen offset:1024 sc1
    v_cvt_pk_bf16_f32 v216, v168, v169
    v_cvt_pk_bf16_f32 v217, v170, v171
    v_cvt_pk_bf16_f32 v218, v172, v173
    v_cvt_pk_bf16_f32 v219, v174, v175
    buffer_store_dwordx4 v[216:219], v119, s[16:19], 0 offen offset:1024 sc1
    v_cvt_pk_bf16_f32 v212, v152, v153
    v_cvt_pk_bf16_f32 v213, v154, v155
    v_cvt_pk_bf16_f32 v214, v156, v157
    v_cvt_pk_bf16_f32 v215, v158, v159
    buffer_store_dwordx4 v[212:215], v118, s[16:19], s22 offen offset:1024 sc1
    v_cvt_pk_bf16_f32 v208, v136, v137
    v_cvt_pk_bf16_f32 v209, v138, v139
    v_cvt_pk_bf16_f32 v210, v140, v141
    v_cvt_pk_bf16_f32 v211, v142, v143
    buffer_store_dwordx4 v[208:211], v118, s[16:19], 0 offen offset:1024 sc1
    s_lshr_b32 s21, s20, 1
    s_lshl_b32 s32, s21, 14
    s_add_u32 s33, s32, 50331648
    s_add_u32 s40, s56, s33
    s_addc_u32 s41, s57, 0
    s_mov_b32 s42, 6307840
    s_mov_b32 s43, 0x20000
    s_add_u32 s33, s32, 20971520
    s_add_u32 s12, s56, s33
    s_addc_u32 s13, s57, 0
    s_mov_b32 s14, 16384
    s_mov_b32 s15, 0x20000
    s_add_u32 s33, s32, 25165824
    s_add_u32 s24, s56, s33
    s_addc_u32 s25, s57, 0
    s_mov_b32 s26, 16384
    s_mov_b32 s27, 0x20000
    s_lshr_b32 s32, s20, 4
    s_lshl_b32 s32, s32, 11
    s_add_u32 s32, s32, 51200
    s_mov_b32 s33, 2097152
    s_mov_b32 s34, 4194304
    s_mov_b32 s35, 6291456
    s_waitcnt vmcnt(9)
    v_lshlrev_b32 v80, 16, v24
    v_and_b32 v81, 0xffff0000, v24
    v_lshlrev_b32 v82, 16, v25
    v_and_b32 v83, 0xffff0000, v25
    v_lshlrev_b32 v84, 16, v26
    v_and_b32 v85, 0xffff0000, v26
    v_lshlrev_b32 v86, 16, v27
    v_and_b32 v87, 0xffff0000, v27
    v_lshlrev_b32 v88, 16, v28
    v_and_b32 v89, 0xffff0000, v28
    v_lshlrev_b32 v90, 16, v29
    v_and_b32 v91, 0xffff0000, v29
    v_lshlrev_b32 v92, 16, v30
    v_and_b32 v93, 0xffff0000, v30
    v_lshlrev_b32 v94, 16, v31
    v_and_b32 v95, 0xffff0000, v31
    v_add_f32 v64, 1.0, v64
    v_add_f32 v65, 1.0, v65
    v_add_f32 v66, 1.0, v66
    v_add_f32 v67, 1.0, v67
    v_add_f32 v68, 1.0, v68
    v_add_f32 v69, 1.0, v69
    v_add_f32 v70, 1.0, v70
    v_add_f32 v71, 1.0, v71
    v_add_f32 v72, 1.0, v72
    v_add_f32 v73, 1.0, v73
    v_add_f32 v74, 1.0, v74
    v_add_f32 v75, 1.0, v75
    v_add_f32 v76, 1.0, v76
    v_add_f32 v77, 1.0, v77
    v_add_f32 v78, 1.0, v78
    v_add_f32 v79, 1.0, v79
    v_cvt_pk_bf16_f32 v24, v64, v65
    v_cvt_pk_bf16_f32 v25, v66, v67
    v_cvt_pk_bf16_f32 v26, v68, v69
    v_cvt_pk_bf16_f32 v27, v70, v71
    v_cvt_pk_bf16_f32 v28, v72, v73
    v_cvt_pk_bf16_f32 v29, v74, v75
    v_cvt_pk_bf16_f32 v30, v76, v77
    v_cvt_pk_bf16_f32 v31, v78, v79
    v_lshlrev_b32 v64, 16, v24
    v_and_b32 v65, 0xffff0000, v24
    v_lshlrev_b32 v66, 16, v25
    v_and_b32 v67, 0xffff0000, v25
    v_lshlrev_b32 v68, 16, v26
    v_and_b32 v69, 0xffff0000, v26
    v_lshlrev_b32 v70, 16, v27
    v_and_b32 v71, 0xffff0000, v27
    v_lshlrev_b32 v72, 16, v28
    v_and_b32 v73, 0xffff0000, v28
    v_lshlrev_b32 v74, 16, v29
    v_and_b32 v75, 0xffff0000, v29
    v_lshlrev_b32 v76, 16, v30
    v_and_b32 v77, 0xffff0000, v30
    v_lshlrev_b32 v78, 16, v31
    v_and_b32 v79, 0xffff0000, v31
    s_waitcnt vmcnt(0)
    s_barrier
    s_cmp_lg_u32 s38, 0
    s_cbranch_scc1 L_nosig_b
    v_mov_b32 v127, s36
    s_mov_b64 exec, 1
    buffer_store_dword v127, off, s[52:55], s31 sc1
    s_mov_b64 exec, -1
L_nosig_b:
    s_add_u32 m0, s29, 32768
    s_nop 0
    buffer_load_dwordx4 v4, s[4:7], s28 offen offset:0 sc1 lds
    buffer_load_dwordx4 v4, s[4:7], s28 offen offset:1024 sc1 lds
    buffer_load_dwordx4 v4, s[4:7], s28 offen offset:2048 sc1 lds
    buffer_load_dwordx4 v4, s[4:7], s28 offen offset:3072 sc1 lds
    s_add_u32 m0, s29, 36864
    s_nop 0
    buffer_load_dwordx4 v5, s[4:7], s28 offen offset:0 sc1 lds
    buffer_load_dwordx4 v5, s[4:7], s28 offen offset:1024 sc1 lds
    buffer_load_dwordx4 v5, s[4:7], s28 offen offset:2048 sc1 lds
    s_add_u32 s28, s28, 28672
    s_add_u32 m0, s29, 65536
    s_nop 0
    buffer_load_dwordx4 v4, s[4:7], s28 offen offset:0 sc1 lds
    buffer_load_dwordx4 v4, s[4:7], s28 offen offset:1024 sc1 lds
    buffer_load_dwordx4 v4, s[4:7], s28 offen offset:2048 sc1 lds
    buffer_load_dwordx4 v4, s[4:7], s28 offen offset:3072 sc1 lds
    s_add_u32 m0, s29, 69632
    s_nop 0
    buffer_load_dwordx4 v5, s[4:7], s28 offen offset:0 sc1 lds
    buffer_load_dwordx4 v5, s[4:7], s28 offen offset:1024 sc1 lds
    buffer_load_dwordx4 v5, s[4:7], s28 offen offset:2048 sc1 lds
    s_add_u32 s28, s28, 28672
    s_add_u32 m0, s29, 0
    s_nop 0
    buffer_load_dwordx4 v4, s[4:7], s28 offen offset:0 sc1 lds
    buffer_load_dwordx4 v4, s[4:7], s28 offen offset:1024 sc1 lds
    buffer_load_dwordx4 v4, s[4:7], s28 offen offset:2048 sc1 lds
    buffer_load_dwordx4 v4, s[4:7], s28 offen offset:3072 sc1 lds
    s_add_u32 m0, s29, 4096
    s_nop 0
    buffer_load_dwordx4 v5, s[4:7], s28 offen offset:0 sc1 lds
    buffer_load_dwordx4 v5, s[4:7], s28 offen offset:1024 sc1 lds
    buffer_load_dwordx4 v5, s[4:7], s28 offen offset:2048 sc1 lds
    s_add_u32 s28, s28, 28672
    s_add_u32 m0, s29, 131072
    s_nop 0
    buffer_load_dwordx4 v4, s[4:7], s28 offen offset:0 sc1 lds
    buffer_load_dwordx4 v4, s[4:7], s28 offen offset:1024 sc1 lds
    buffer_load_dwordx4 v4, s[4:7], s28 offen offset:2048 sc1 lds
    buffer_load_dwordx4 v4, s[4:7], s28 offen offset:3072 sc1 lds
    s_add_u32 m0, s29, 135168
    s_nop 0
    buffer_load_dwordx4 v5, s[4:7], s28 offen offset:0 sc1 lds
    buffer_load_dwordx4 v5, s[4:7], s28 offen offset:1024 sc1 lds
    buffer_load_dwordx4 v5, s[4:7], s28 offen offset:2048 sc1 lds
    s_add_u32 s28, s28, 28672
    s_lshl_b32 s31, s20, 2
    s_add_u32 s31, s31, s38
    s_lshl_b32 s31, s31, 2
    s_add_u32 s31, s31, 8192
    s_mov_b32 s39, 0
    s_branch L_pollgo_b
L_poll_b:
    s_sleep 4
L_pollgo_b:
    buffer_load_dword v126, v113, s[52:55], s32 offen sc1
    s_add_u32 s39, s39, 1
    s_waitcnt vmcnt(0)
    v_cmp_ne_u32 vcc, s36, v126
    s_cmp_ge_u32 s39, 0x40000
    s_cbranch_scc1 L_polled_b
    s_cbranch_vccnz L_poll_b
L_polled_b:
    buffer_load_dwordx4 v[224:227], v18, s[40:43], 0 offen offset:0 sc1
    buffer_load_dwordx4 v[228:231], v18, s[40:43], s33 offen offset:0 sc1
    buffer_load_dwordx4 v[232:235], v18, s[40:43], s34 offen offset:0 sc1
    buffer_load_dwordx4 v[236:239], v18, s[40:43], s35 offen offset:0 sc1
    buffer_load_dwordx4 v[240:243], v18, s[40:43], 0 offen offset:2048 sc1
    buffer_load_dwordx4 v[244:247], v18, s[40:43], s33 offen offset:2048 sc1
    buffer_load_dwordx4 v[248:251], v18, s[40:43], s34 offen offset:2048 sc1
    buffer_load_dwordx4 v[252:255], v18, s[40:43], s35 offen offset:2048 sc1
    s_waitcnt vmcnt(4)
    v_lshlrev_b32 v128, 16, v224
    v_and_b32 v129, 0xffff0000, v224
    v_lshlrev_b32 v130, 16, v225
    v_and_b32 v131, 0xffff0000, v225
    v_lshlrev_b32 v132, 16, v226
    v_and_b32 v133, 0xffff0000, v226
    v_lshlrev_b32 v134, 16, v227
    v_and_b32 v135, 0xffff0000, v227
    v_lshlrev_b32 v136, 16, v228
    v_and_b32 v137, 0xffff0000, v228
    v_lshlrev_b32 v138, 16, v229
    v_and_b32 v139, 0xffff0000, v229
    v_lshlrev_b32 v140, 16, v230
    v_and_b32 v141, 0xffff0000, v230
    v_lshlrev_b32 v142, 16, v231
    v_and_b32 v143, 0xffff0000, v231
    v_lshlrev_b32 v144, 16, v232
    v_and_b32 v145, 0xffff0000, v232
    v_lshlrev_b32 v146, 16, v233
    v_and_b32 v147, 0xffff0000, v233
    v_lshlrev_b32 v148, 16, v234
    v_and_b32 v149, 0xffff0000, v234
    v_lshlrev_b32 v150, 16, v235
    v_and_b32 v151, 0xffff0000, v235
    v_lshlrev_b32 v152, 16, v236
    v_and_b32 v153, 0xffff0000, v236
    v_lshlrev_b32 v154, 16, v237
    v_and_b32 v155, 0xffff0000, v237
    v_lshlrev_b32 v156, 16, v238
    v_and_b32 v157, 0xffff0000, v238
    v_lshlrev_b32 v158, 16, v239
    v_and_b32 v159, 0xffff0000, v239
    v_pk_add_f32 v[128:129], v[128:129], v[136:137]
    v_pk_add_f32 v[144:145], v[144:145], v[152:153]
    v_pk_add_f32 v[130:131], v[130:131], v[138:139]
    v_pk_add_f32 v[146:147], v[146:147], v[154:155]
    v_pk_add_f32 v[132:133], v[132:133], v[140:141]
    v_pk_add_f32 v[148:149], v[148:149], v[156:157]
    v_pk_add_f32 v[134:135], v[134:135], v[142:143]
    v_pk_add_f32 v[150:151], v[150:151], v[158:159]
    v_pk_add_f32 v[128:129], v[128:129], v[144:145]
    v_pk_add_f32 v[130:131], v[130:131], v[146:147]
    v_pk_add_f32 v[132:133], v[132:133], v[148:149]
    v_pk_add_f32 v[134:135], v[134:135], v[150:151]
    v_pk_fma_f32 v[80:81], v[32:33], v[128:129], v[80:81]
    v_pk_fma_f32 v[82:83], v[34:35], v[130:131], v[82:83]
    v_pk_fma_f32 v[84:85], v[36:37], v[132:133], v[84:85]
    v_pk_fma_f32 v[86:87], v[38:39], v[134:135], v[86:87]
    s_waitcnt vmcnt(0)
    v_lshlrev_b32 v160, 16, v240
    v_and_b32 v161, 0xffff0000, v240
    v_lshlrev_b32 v162, 16, v241
    v_and_b32 v163, 0xffff0000, v241
    v_lshlrev_b32 v164, 16, v242
    v_and_b32 v165, 0xffff0000, v242
    v_lshlrev_b32 v166, 16, v243
    v_and_b32 v167, 0xffff0000, v243
    v_lshlrev_b32 v168, 16, v244
    v_and_b32 v169, 0xffff0000, v244
    v_lshlrev_b32 v170, 16, v245
    v_and_b32 v171, 0xffff0000, v245
    v_lshlrev_b32 v172, 16, v246
    v_and_b32 v173, 0xffff0000, v246
    v_lshlrev_b32 v174, 16, v247
    v_and_b32 v175, 0xffff0000, v247
    v_lshlrev_b32 v176, 16, v248
    v_and_b32 v177, 0xffff0000, v248
    v_lshlrev_b32 v178, 16, v249
    v_and_b32 v179, 0xffff0000, v249
    v_lshlrev_b32 v180, 16, v250
    v_and_b32 v181, 0xffff0000, v250
    v_lshlrev_b32 v182, 16, v251
    v_and_b32 v183, 0xffff0000, v251
    v_lshlrev_b32 v184, 16, v252
    v_and_b32 v185, 0xffff0000, v252
    v_lshlrev_b32 v186, 16, v253
    v_and_b32 v187, 0xffff0000, v253
    v_lshlrev_b32 v188, 16, v254
    v_and_b32 v189, 0xffff0000, v254
    v_lshlrev_b32 v190, 16, v255
    v_and_b32 v191, 0xffff0000, v255
    v_pk_add_f32 v[160:161], v[160:161], v[168:169]
    v_pk_add_f32 v[176:177], v[176:177], v[184:185]
    v_pk_add_f32 v[162:163], v[162:163], v[170:171]
    v_pk_add_f32 v[178:179], v[178:179], v[186:187]
    v_pk_add_f32 v[164:165], v[164:165], v[172:173]
    v_pk_add_f32 v[180:181], v[180:181], v[188:189]
    v_pk_add_f32 v[166:167], v[166:167], v[174:175]
    v_pk_add_f32 v[182:183], v[182:183], v[190:191]
    v_pk_add_f32 v[160:161], v[160:161], v[176:177]
    v_pk_add_f32 v[162:163], v[162:163], v[178:179]
    v_pk_add_f32 v[164:165], v[164:165], v[180:181]
    v_pk_add_f32 v[166:167], v[166:167], v[182:183]
    v_pk_fma_f32 v[88:89], v[40:41], v[160:161], v[88:89]
    v_pk_fma_f32 v[90:91], v[42:43], v[162:163], v[90:91]
    v_pk_fma_f32 v[92:93], v[44:45], v[164:165], v[92:93]
    v_pk_fma_f32 v[94:95], v[46:47], v[166:167], v[94:95]
    v_cvt_pk_bf16_f32 v24, v80, v81
    v_cvt_pk_bf16_f32 v25, v82, v83
    v_cvt_pk_bf16_f32 v26, v84, v85
    v_cvt_pk_bf16_f32 v27, v86, v87
    v_cvt_pk_bf16_f32 v28, v88, v89
    v_cvt_pk_bf16_f32 v29, v90, v91
    v_cvt_pk_bf16_f32 v30, v92, v93
    v_cvt_pk_bf16_f32 v31, v94, v95
    v_lshlrev_b32 v80, 16, v24
    v_and_b32 v81, 0xffff0000, v24
    v_lshlrev_b32 v82, 16, v25
    v_and_b32 v83, 0xffff0000, v25
    v_lshlrev_b32 v84, 16, v26
    v_and_b32 v85, 0xffff0000, v26
    v_lshlrev_b32 v86, 16, v27
    v_and_b32 v87, 0xffff0000, v27
    v_lshlrev_b32 v88, 16, v28
    v_and_b32 v89, 0xffff0000, v28
    v_lshlrev_b32 v90, 16, v29
    v_and_b32 v91, 0xffff0000, v29
    v_lshlrev_b32 v92, 16, v30
    v_and_b32 v93, 0xffff0000, v30
    v_lshlrev_b32 v94, 16, v31
    v_and_b32 v95, 0xffff0000, v31
    v_pk_add_f32 v[96:97], v[80:81], v[82:83]
    v_pk_mul_f32 v[98:99], v[80:81], v[80:81]
    v_pk_fma_f32 v[98:99], v[82:83], v[82:83], v[98:99]
    v_pk_add_f32 v[96:97], v[96:97], v[84:85]
    v_pk_fma_f32 v[98:99], v[84:85], v[84:85], v[98:99]
    v_pk_add_f32 v[96:97], v[96:97], v[86:87]
    v_pk_fma_f32 v[98:99], v[86:87], v[86:87], v[98:99]
    v_pk_add_f32 v[96:97], v[96:97], v[88:89]
    v_pk_fma_f32 v[98:99], v[88:89], v[88:89], v[98:99]
    v_pk_add_f32 v[96:97], v[96:97], v[90:91]
    v_pk_fma_f32 v[98:99], v[90:91], v[90:91], v[98:99]
    v_pk_add_f32 v[96:97], v[96:97], v[92:93]
    v_pk_fma_f32 v[98:99], v[92:93], v[92:93], v[98:99]
    v_pk_add_f32 v[96:97], v[96:97], v[94:95]
    v_pk_fma_f32 v[98:99], v[94:95], v[94:95], v[98:99]
    v_add_f32 v96, v96, v97
    v_add_f32 v97, v98, v99
    s_nop 1
    v_add_f32_dpp v96, v96, v96 row_ror:8 row_mask:0xf bank_mask:0xf
    v_add_f32_dpp v97, v97, v97 row_ror:8 row_mask:0xf bank_mask:0xf
    v_mov_b32 v98, v96
    v_mov_b32 v99, v97
    s_nop 1
    v_permlane16_swap_b32 v96, v98
    v_permlane16_swap_b32 v97, v99
    v_add_f32 v96, v96, v98
    v_add_f32 v97, v97, v99
    v_mov_b32 v98, v96
    v_mov_b32 v99, v97
    s_nop 1
    v_permlane32_swap_b32 v96, v98
    v_permlane32_swap_b32 v97, v99
    v_add_f32 v96, v96, v98
    v_add_f32 v97, v97, v99
    ds_write_b64 v17, v[96:97]
    buffer_store_dwordx4 v[24:27], v18, s[12:15], 0 offen
    buffer_store_dwordx4 v[28:31], v18, s[12:15], 0 offen offset:2048
    s_waitcnt lgkmcnt(0)
    s_barrier
    ds_read_b64 v[128:129], v16 offset:0
    ds_read_b64 v[130:131], v16 offset:64
    ds_read_b64 v[132:133], v16 offset:128
    ds_read_b64 v[134:135], v16 offset:192
    s_waitcnt lgkmcnt(0)
    v_pk_add_f32 v[128:129], v[128:129], v[130:131]
    v_pk_add_f32 v[132:133], v[132:133], v[134:135]
    v_pk_add_f32 v[128:129], v[128:129], v[132:133]
    v_mul_f32 v128, 0xbb000000, v128
    v_mul_f32 v129, 0x3b000000, v129
    v_fma_f32 v129, -v128, v128, v129
    v_max_f32 v129, 0, v129
    v_add_f32 v129, 0x3727c5ac, v129
    v_rsq_f32 v130, v129
    v_mov_b32 v129, v128
    v_mov_b32 v131, v130
    v_pk_add_f32 v[80:81], v[80:81], v[128:129]
    v_pk_add_f32 v[82:83], v[82:83], v[128:129]
    v_pk_add_f32 v[84:85], v[84:85], v[128:129]
    v_pk_add_f32 v[86:87], v[86:87], v[128:129]
    v_pk_add_f32 v[88:89], v[88:89], v[128:129]
    v_pk_add_f32 v[90:91], v[90:91], v[128:129]
    v_pk_add_f32 v[92:93], v[92:93], v[128:129]
    v_pk_add_f32 v[94:95], v[94:95], v[128:129]
    v_pk_mul_f32 v[80:81], v[80:81], v[130:131]
    v_pk_mul_f32 v[82:83], v[82:83], v[130:131]
    v_pk_mul_f32 v[84:85], v[84:85], v[130:131]
    v_pk_mul_f32 v[86:87], v[86:87], v[130:131]
    v_pk_mul_f32 v[88:89], v[88:89], v[130:131]
    v_pk_mul_f32 v[90:91], v[90:91], v[130:131]
    v_pk_mul_f32 v[92:93], v[92:93], v[130:131]
    v_pk_mul_f32 v[94:95], v[94:95], v[130:131]
    v_pk_fma_f32 v[80:81], v[80:81], v[64:65], v[48:49]
    v_pk_fma_f32 v[82:83], v[82:83], v[66:67], v[50:51]
    v_pk_fma_f32 v[84:85], v[84:85], v[68:69], v[52:53]
    v_pk_fma_f32 v[86:87], v[86:87], v[70:71], v[54:55]
    v_pk_fma_f32 v[88:89], v[88:89], v[72:73], v[56:57]
    v_pk_fma_f32 v[90:91], v[90:91], v[74:75], v[58:59]
    v_pk_fma_f32 v[92:93], v[92:93], v[76:77], v[60:61]
    v_pk_fma_f32 v[94:95], v[94:95], v[78:79], v[62:63]
    v_cvt_pk_bf16_f32 v136, v80, v81
    v_cvt_pk_bf16_f32 v137, v82, v83
    v_cvt_pk_bf16_f32 v138, v84, v85
    v_cvt_pk_bf16_f32 v139, v86, v87
    v_cvt_pk_bf16_f32 v140, v88, v89
    v_cvt_pk_bf16_f32 v141, v90, v91
    v_cvt_pk_bf16_f32 v142, v92, v93
    v_cvt_pk_bf16_f32 v143, v94, v95
    buffer_store_dwordx4 v[136:139], v18, s[24:27], 0 offen
    buffer_store_dwordx4 v[140:143], v18, s[24:27], 0 offen offset:2048
    s_lshl_b32 s32, s46, 17
    s_add_u32 s32, s32, 25165824
    s_add_u32 s8, s56, s32
    s_addc_u32 s9, s57, 0
    s_mov_b32 s10, 131072
    s_mov_b32 s11, 0x20000
    s_mul_i32 s32, s46, 458752
    s_mul_i32 s33, s47, 7168
    s_add_u32 s32, s32, s33
    s_add_u32 s32, s32, 33554432
    s_add_u32 s16, s56, s32
    s_addc_u32 s17, s57, 0
    s_mov_b32 s18, 458752
    s_mov_b32 s19, 0x20000
    s_mov_b32 s23, 0
    s_and_b32 s34, s2, 7
    s_lshl_b32 s34, s34, 2
    s_bfe_u32 s32, s2, 0x20003
    s_add_u32 s34, s34, s32
    s_lshr_b32 s35, s2, 5
    v_lshrrev_b32 v96, 3, v114
    v_and_b32 v97, 7, v114
    v_bfe_u32 v98, v114, 4, 1
    v_lshlrev_b32 v99, 2, v98
    v_xor_b32 v97, v97, v99
    v_mul_u32_u24 v99, 448, v115
    v_add_u32 v96, v96, v99
    v_lshlrev_b32 v96, 10, v96
    v_lshl_add_u32 v13, v97, 4, v96
    v_add_u32 v14, 7168, v13
    v_add_u32 v15, 14336, v13
    v_add_u32 v16, 21504, v13
    s_lshl_b32 s22, s38, 13
    s_lshl_b32 s32, s35, 7
    s_sub_u32 s33, 1835008, s32
    s_add_u32 s40, s98, s32
    s_addc_u32 s41, s99, 0
    s_mov_b32 s42, s33
    s_mov_b32 s43, 0x20000
    s_mov_b32 s20, 0
    s_mov_b32 s21, 32768
    v_lshrrev_b32 v116, 5, v114
    v_bfe_u32 v97, v114, 2, 2
    v_lshl_add_u32 v96, v116, 3, v97
    v_lshlrev_b32 v96, 7, v96
    v_lshrrev_b32 v97, 1, v97
    v_lshl_add_u32 v96, v97, 6, v96
    v_lshl_add_u32 v96, v98, 4, v96
    v_bfe_u32 v97, v114, 1, 1
    v_lshl_add_u32 v96, v97, 5, v96
    v_and_b32 v97, 1, v114
    v_lshl_add_u32 v96, v97, 3, v96
    v_lshl_add_u32 v17, v115, 13, v96
    v_xor_b32 v18, 64, v17
    v_add_u32 v19, 0x10000, v17
    v_add_u32 v20, 0x10000, v18
    v_add_u32 v21, 0x10000, v19
    v_add_u32 v22, 0x10000, v20
    v_mul_u32_u24 v96, 28672, v115
    v_and_b32 v117, 31, v114
    v_lshl_add_u32 v96, v117, 5, v96
    v_lshl_add_u32 v23, v116, 4, v96
    s_mul_i32 s32, s34, 229376
    s_add_u32 s32, s32, 33554432
    s_add_u32 s12, s56, s32
    s_addc_u32 s13, s57, 0
    s_mov_b32 s14, 229376
    s_mov_b32 s15, 0x20000
    s_lshl_b32 s32, s34, 16
    s_lshl_b32 s33, s35, 11
    s_add_u32 s33, s32, s33
    s_add_u32 s33, s33, 20971520
    s_add_u32 s24, s56, s33
    s_addc_u32 s25, s57, 0
    s_mov_b32 s26, 65536
    s_mov_b32 s27, 0x20000
    s_lshl_b32 s33, s35, 7
    s_add_u32 s32, s32, s33
    s_sub_u32 s33, 2097152, s32
    s_add_u32 s96, s100, s32
    s_addc_u32 s97, s101, 0
    s_mov_b32 s98, s33
    s_mov_b32 s99, 0x20000
    s_mov_b32 s44, 0
    s_mov_b32 s45, 114688
    s_lshr_b32 s30, s34, 1
    s_lshl_b32 s30, s30, 8
    s_add_u32 s30, s30, 12288
    s_lshl_b32 s100, s35, 8
    s_add_u32 s100, s100, 10240
    s_lshl_b32 s32, s46, 8
    s_add_u32 s32, s32, 8192
    s_waitcnt vmcnt(0)
    v_mov_b32 v127, s36
    s_cmp_lg_u32 s3, 0
    s_cbranch_scc1 L_sigl_c
    buffer_wbl2 sc1
    s_waitcnt vmcnt(0)
    s_mov_b64 exec, 1
    buffer_store_dword v127, off, s[52:55], s31 sc1
    s_branch L_sigd_c
L_sigl_c:
    s_mov_b64 exec, 1
    buffer_store_dword v127, off, s[52:55], s31
L_sigd_c:
    s_mov_b64 exec, -1
    s_lshl_b32 s31, s46, 4
    s_add_u32 s31, s31, s47
    s_lshl_b32 s31, s31, 2
    s_add_u32 s31, s31, s38
    s_lshl_b32 s31, s31, 2
    s_add_u32 s31, s31, 12288
    s_mov_b32 s39, 0
L_poll_c:
    buffer_load_dword v126, v124, s[52:55], s32 offen sc1
    s_add_u32 s39, s39, 1
    s_waitcnt vmcnt(0)
    v_cmp_ne_u32 vcc, s36, v126
    s_cmp_ge_u32 s39, 0x40000
    s_cbranch_scc1 L_polled_c
    s_cbranch_vccnz L_poll_c
L_polled_c:
    s_cmp_lg_u32 s3, 0
    s_cbranch_scc1 L_acq_c
    buffer_inv sc1
    s_waitcnt vmcnt(0)
L_acq_c:
    buffer_load_dwordx4 a[0:3], v6, s[8:11], s23 offen offset:0 sc1
    buffer_load_dwordx4 a[4:7], v7, s[8:11], s23 offen offset:0 sc1
    buffer_load_dwordx4 a[8:11], v6, s[8:11], s23 offen offset:1024 sc1
    buffer_load_dwordx4 a[12:15], v7, s[8:11], s23 offen offset:1024 sc1
    s_add_u32 s23, s23, 2048
    buffer_load_dwordx4 a[16:19], v6, s[8:11], s23 offen offset:0 sc1
    buffer_load_dwordx4 a[20:23], v7, s[8:11], s23 offen offset:0 sc1
    buffer_load_dwordx4 a[24:27], v6, s[8:11], s23 offen offset:1024 sc1
    buffer_load_dwordx4 a[28:31], v7, s[8:11], s23 offen offset:1024 sc1
    s_add_u32 s23, s23, 2048
    v_lshrrev_b32 v96, 1, v115
    v_and_b32 v97, 1, v115
    v_lshrrev_b32 v98, 4, v117
    v_lshl_add_u32 v98, v96, 1, v98
    v_lshlrev_b32 v98, 14, v98
    v_lshl_add_u32 v98, v97, 10, v98
    v_lshl_add_u32 v98, v116, 8, v98
    v_and_b32 v99, 15, v114
    v_lshl_add_u32 v28, v99, 4, v98
    v_lshlrev_b32 v98, 7, v97
    v_lshl_add_u32 v29, v116, 4, v98
    v_lshl_add_u32 v98, v96, 5, v117
    v_lshlrev_b32 v98, 10, v98
    v_lshrrev_b32 v30, 1, v29
    v_add_u32 v30, v30, v98
    s_barrier
    ds_read_b64_tr_b16 v[32:33], v1 offset:32768
    ds_read_b64_tr_b16 v[34:35], v1 offset:36352
    buffer_load_dwordx4 a[32:35], v6, s[8:11], s23 offen offset:0 sc1
    ds_read_b64_tr_b16 v[36:37], v1 offset:39936
    ds_read_b64_tr_b16 v[38:39], v1 offset:43520
    ds_read_b64_tr_b16 v[40:41], v1 offset:47104
    ds_read_b64_tr_b16 v[42:43], v1 offset:50688
    ds_read_b64_tr_b16 v[44:45], v1 offset:54272
    buffer_load_dwordx4 a[36:39], v7, s[8:11], s23 offen offset:0 sc1
    ds_read_b64_tr_b16 v[46:47], v1 offset:57856
    ds_read_b64_tr_b16 v[48:49], v1 offset:32800
    ds_read_b64_tr_b16 v[50:51], v1 offset:36384
    ds_read_b64_tr_b16 v[52:53], v1 offset:39968
    buffer_load_dwordx4 a[40:43], v6, s[8:11], s23 offen offset:1024 sc1
    ds_read_b64_tr_b16 v[54:55], v1 offset:43552
    ds_read_b64_tr_b16 v[56:57], v1 offset:47136
    ds_read_b64_tr_b16 v[58:59], v1 offset:50720
    ds_read_b64_tr_b16 v[60:61], v1 offset:54304
    s_waitcnt vmcnt(7) lgkmcnt(11)
    v_mfma_f32_16x16x32_bf16 v[128:131], v[32:35], a[0:3], 0
    ds_read_b64_tr_b16 v[62:63], v1 offset:57888
    v_mfma_f32_16x16x32_bf16 v[128:131], v[36:39], a[8:11], v[128:131]
    ds_read_b64_tr_b16 v[64:65], v1 offset:32832
    ds_read_b64_tr_b16 v[66:67], v1 offset:36416
    v_mfma_f32_16x16x32_bf16 v[136:139], v[36:39], a[12:15], 0
    buffer_load_dwordx4 a[44:47], v7, s[8:11], s23 offen offset:1024 sc1
    ds_read_b64_tr_b16 v[68:69], v1 offset:40000
    s_add_u32 s23, s23, 2048
    v_mfma_f32_16x16x32_bf16 v[136:139], v[32:35], a[4:7], v[136:139]
    ds_read_b64_tr_b16 v[70:71], v1 offset:43584
    s_waitcnt lgkmcnt(12)
    v_mfma_f32_16x16x32_bf16 v[132:135], v[40:43], a[0:3], 0
    ds_read_b64_tr_b16 v[72:73], v1 offset:47168
    v_mfma_f32_16x16x32_bf16 v[132:135], v[44:47], a[8:11], v[132:135]
    ds_read_b64_tr_b16 v[74:75], v1 offset:50752
    s_add_u32 m0, s22, 98304
    v_mfma_f32_16x16x32_bf16 v[140:143], v[44:47], a[12:15], 0
    buffer_load_dwordx4 v13, s[40:43], s20 offen offset:0 lds
    ds_read_b64_tr_b16 v[76:77], v1 offset:54336
    ds_read_b64_tr_b16 v[78:79], v1 offset:57920
    v_mfma_f32_16x16x32_bf16 v[140:143], v[40:43], a[4:7], v[140:143]
    ds_read_b64_tr_b16 v[80:81], v1 offset:32864
    s_waitcnt lgkmcnt(13)
    v_mfma_f32_16x16x32_bf16 v[144:147], v[48:51], a[0:3], 0
    ds_read_b64_tr_b16 v[82:83], v1 offset:36448
    v_mfma_f32_16x16x32_bf16 v[144:147], v[52:55], a[8:11], v[144:147]
    ds_read_b64_tr_b16 v[84:85], v1 offset:40032
    v_mfma_f32_16x16x32_bf16 v[152:155], v[52:55], a[12:15], 0
    buffer_load_dwordx4 v14, s[40:43], s20 offen offset:1024 lds
    ds_read_b64_tr_b16 v[86:87], v1 offset:43616
    v_mfma_f32_16x16x32_bf16 v[152:155], v[48:51], a[4:7], v[152:155]
    ds_read_b64_tr_b16 v[88:89], v1 offset:47200
    ds_read_b64_tr_b16 v[90:91], v1 offset:50784
    s_waitcnt lgkmcnt(14)
    v_mfma_f32_16x16x32_bf16 v[148:151], v[56:59], a[0:3], 0
    ds_read_b64_tr_b16 v[92:93], v1 offset:54368
    v_mfma_f32_16x16x32_bf16 v[148:151], v[60:63], a[8:11], v[148:151]
    ds_read_b64_tr_b16 v[94:95], v1 offset:57952
    v_mfma_f32_16x16x32_bf16 v[156:159], v[60:63], a[12:15], 0
    ds_read_b64_tr_b16 v[32:33], v1 offset:32896
    v_mfma_f32_16x16x32_bf16 v[156:159], v[56:59], a[4:7], v[156:159]
    buffer_load_dwordx4 v15, s[40:43], s20 offen offset:2048 lds
    ds_read_b64_tr_b16 v[34:35], v1 offset:36480
    ds_read_b64_tr_b16 v[36:37], v1 offset:40064
    s_waitcnt lgkmcnt(15)
    v_mfma_f32_16x16x32_bf16 v[160:163], v[64:67], a[0:3], 0
    ds_read_b64_tr_b16 v[38:39], v1 offset:43648
    v_mfma_f32_16x16x32_bf16 v[160:163], v[68:71], a[8:11], v[160:163]
    ds_read_b64_tr_b16 v[40:41], v1 offset:47232
    v_mfma_f32_16x16x32_bf16 v[168:171], v[68:71], a[12:15], 0
    ds_read_b64_tr_b16 v[42:43], v1 offset:50816
    v_mfma_f32_16x16x32_bf16 v[168:171], v[64:67], a[4:7], v[168:171]
    buffer_load_dwordx4 v16, s[40:43], s20 offen offset:3072 lds
    ds_read_b64_tr_b16 v[44:45], v1 offset:54400
    s_waitcnt lgkmcnt(15)
    v_mfma_f32_16x16x32_bf16 v[164:167], v[72:75], a[0:3], 0
    ds_read_b64_tr_b16 v[46:47], v1 offset:57984
    ds_read_b64_tr_b16 v[48:49], v1 offset:32928
    v_mfma_f32_16x16x32_bf16 v[164:167], v[76:79], a[8:11], v[164:167]
    ds_read_b64_tr_b16 v[50:51], v1 offset:36512
    v_mfma_f32_16x16x32_bf16 v[172:175], v[76:79], a[12:15], 0
    ds_read_b64_tr_b16 v[52:53], v1 offset:40096
    s_add_u32 m0, s22, 102400
    v_mfma_f32_16x16x32_bf16 v[172:175], v[72:75], a[4:7], v[172:175]
    buffer_load_dwordx4 v13, s[40:43], s21 offen offset:0 lds
    ds_read_b64_tr_b16 v[54:55], v1 offset:43680
    s_waitcnt lgkmcnt(15)
    v_mfma_f32_16x16x32_bf16 v[176:179], v[80:83], a[0:3], 0
    ds_read_b64_tr_b16 v[56:57], v1 offset:47264
    ds_read_b64_tr_b16 v[58:59], v1 offset:50848
    v_mfma_f32_16x16x32_bf16 v[176:179], v[84:87], a[8:11], v[176:179]
    ds_read_b64_tr_b16 v[60:61], v1 offset:54432
    v_mfma_f32_16x16x32_bf16 v[184:187], v[84:87], a[12:15], 0
    ds_read_b64_tr_b16 v[62:63], v1 offset:58016
    v_mfma_f32_16x16x32_bf16 v[184:187], v[80:83], a[4:7], v[184:187]
    ds_read_b64_tr_b16 v[64:65], v1 offset:32960
    s_waitcnt lgkmcnt(15)
    v_mfma_f32_16x16x32_bf16 v[180:183], v[88:91], a[0:3], 0
    buffer_load_dwordx4 v14, s[40:43], s21 offen offset:1024 lds
    ds_read_b64_tr_b16 v[66:67], v1 offset:36544
    v_mfma_f32_16x16x32_bf16 v[180:183], v[92:95], a[8:11], v[180:183]
    ds_read_b64_tr_b16 v[68:69], v1 offset:40128
    ds_read_b64_tr_b16 v[70:71], v1 offset:43712
    v_mfma_f32_16x16x32_bf16 v[188:191], v[92:95], a[12:15], 0
    ds_read_b64_tr_b16 v[72:73], v1 offset:47296
    v_mfma_f32_16x16x32_bf16 v[188:191], v[88:91], a[4:7], v[188:191]
    ds_read_b64_tr_b16 v[74:75], v1 offset:50880
    s_waitcnt lgkmcnt(15)
    v_mfma_f32_16x16x32_bf16 v[192:195], v[32:35], a[0:3], 0
    buffer_load_dwordx4 v15, s[40:43], s21 offen offset:2048 lds
    ds_read_b64_tr_b16 v[76:77], v1 offset:54464
    v_mfma_f32_16x16x32_bf16 v[192:195], v[36:39], a[8:11], v[192:195]
    ds_read_b64_tr_b16 v[78:79], v1 offset:58048
    v_mfma_f32_16x16x32_bf16 v[200:203], v[36:39], a[12:15], 0
    v_mfma_f32_16x16x32_bf16 v[200:203], v[32:35], a[4:7], v[200:203]
    s_waitcnt lgkmcnt(15)
    v_mfma_f32_16x16x32_bf16 v[196:199], v[40:43], a[0:3], 0
    buffer_load_dwordx4 v16, s[40:43], s21 offen offset:3072 lds
    s_add_u32 s20, s20, 65536
    s_add_u32 s21, s21, 65536
    v_mfma_f32_16x16x32_bf16 v[196:199], v[44:47], a[8:11], v[196:199]
    v_mfma_f32_16x16x32_bf16 v[204:207], v[44:47], a[12:15], 0
    v_mfma_f32_16x16x32_bf16 v[204:207], v[40:43], a[4:7], v[204:207]
    s_waitcnt lgkmcnt(12)
    v_mfma_f32_16x16x32_bf16 v[208:211], v[48:51], a[0:3], 0
    v_mfma_f32_16x16x32_bf16 v[208:211], v[52:55], a[8:11], v[208:211]
    v_mfma_f32_16x16x32_bf16 v[216:219], v[52:55], a[12:15], 0
    v_mfma_f32_16x16x32_bf16 v[216:219], v[48:51], a[4:7], v[216:219]
    s_waitcnt lgkmcnt(0)
    s_barrier
    v_mfma_f32_16x16x32_bf16 v[212:215], v[56:59], a[0:3], 0
    ds_read_b64_tr_b16 v[80:81], v2 offset:0
    ds_read_b64_tr_b16 v[82:83], v2 offset:3584
    v_mfma_f32_16x16x32_bf16 v[212:215], v[60:63], a[8:11], v[212:215]
    buffer_load_dwordx4 a[48:51], v6, s[8:11], s23 offen offset:0 sc1
    ds_read_b64_tr_b16 v[84:85], v2 offset:7168
    v_mfma_f32_16x16x32_bf16 v[220:223], v[60:63], a[12:15], 0
    ds_read_b64_tr_b16 v[86:87], v2 offset:10752
    v_mfma_f32_16x16x32_bf16 v[220:223], v[56:59], a[4:7], v[220:223]
    ds_read_b64_tr_b16 v[88:89], v2 offset:14336
    v_mfma_f32_16x16x32_bf16 v[224:227], v[64:67], a[0:3], 0
    ds_read_b64_tr_b16 v[90:91], v2 offset:17920
    ds_read_b64_tr_b16 v[92:93], v2 offset:21504
    v_mfma_f32_16x16x32_bf16 v[224:227], v[68:71], a[8:11], v[224:227]
    buffer_load_dwordx4 a[52:55], v7, s[8:11], s23 offen offset:0 sc1
    ds_read_b64_tr_b16 v[94:95], v2 offset:25088
    v_mfma_f32_16x16x32_bf16 v[232:235], v[68:71], a[12:15], 0
    ds_read_b64_tr_b16 v[32:33], v2 offset:32
    v_mfma_f32_16x16x32_bf16 v[232:235], v[64:67], a[4:7], v[232:235]
    ds_read_b64_tr_b16 v[34:35], v2 offset:3616
    v_mfma_f32_16x16x32_bf16 v[228:231], v[72:75], a[0:3], 0
    ds_read_b64_tr_b16 v[36:37], v2 offset:7200
    v_mfma_f32_16x16x32_bf16 v[228:231], v[76:79], a[8:11], v[228:231]
    ds_read_b64_tr_b16 v[38:39], v2 offset:10784
    ds_read_b64_tr_b16 v[40:41], v2 offset:14368
    v_mfma_f32_16x16x32_bf16 v[236:239], v[76:79], a[12:15], 0
    buffer_load_dwordx4 a[56:59], v6, s[8:11], s23 offen offset:1024 sc1
    ds_read_b64_tr_b16 v[42:43], v2 offset:17952
    v_mfma_f32_16x16x32_bf16 v[236:239], v[72:75], a[4:7], v[236:239]
    ds_read_b64_tr_b16 v[44:45], v2 offset:21536
    s_waitcnt vmcnt(15) lgkmcnt(11)
    v_mfma_f32_16x16x32_bf16 v[128:131], v[80:83], a[16:19], v[128:131]
    ds_read_b64_tr_b16 v[46:47], v2 offset:25120
    v_mfma_f32_16x16x32_bf16 v[128:131], v[84:87], a[24:27], v[128:131]
    ds_read_b64_tr_b16 v[48:49], v2 offset:64
    ds_read_b64_tr_b16 v[50:51], v2 offset:3648
    v_mfma_f32_16x16x32_bf16 v[136:139], v[84:87], a[28:31], v[136:139]
    ds_read_b64_tr_b16 v[52:53], v2 offset:7232
    v_mfma_f32_16x16x32_bf16 v[136:139], v[80:83], a[20:23], v[136:139]
    buffer_load_dwordx4 a[60:63], v7, s[8:11], s23 offen offset:1024 sc1
    ds_read_b64_tr_b16 v[54:55], v2 offset:10816
    s_add_u32 s23, s23, 2048
    s_waitcnt lgkmcnt(12)
    v_mfma_f32_16x16x32_bf16 v[132:135], v[88:91], a[16:19], v[132:135]
    ds_read_b64_tr_b16 v[56:57], v2 offset:14400
    v_mfma_f32_16x16x32_bf16 v[132:135], v[92:95], a[24:27], v[132:135]
    ds_read_b64_tr_b16 v[58:59], v2 offset:17984
    v_mfma_f32_16x16x32_bf16 v[140:143], v[92:95], a[28:31], v[140:143]
    ds_read_b64_tr_b16 v[60:61], v2 offset:21568
    ds_read_b64_tr_b16 v[62:63], v2 offset:25152
    s_add_u32 m0, s29, 32768
    v_mfma_f32_16x16x32_bf16 v[140:143], v[88:91], a[20:23], v[140:143]
    buffer_load_dwordx4 v4, s[4:7], s28 offen offset:0 sc1 lds
    ds_read_b64_tr_b16 v[64:65], v2 offset:96
    s_waitcnt lgkmcnt(13)
    v_mfma_f32_16x16x32_bf16 v[144:147], v[32:35], a[16:19], v[144:147]
    ds_read_b64_tr_b16 v[66:67], v2 offset:3680
    v_mfma_f32_16x16x32_bf16 v[144:147], v[36:39], a[24:27], v[144:147]
    ds_read_b64_tr_b16 v[68:69], v2 offset:7264
    v_mfma_f32_16x16x32_bf16 v[152:155], v[36:39], a[28:31], v[152:155]
    ds_read_b64_tr_b16 v[70:71], v2 offset:10848
    v_mfma_f32_16x16x32_bf16 v[152:155], v[32:35], a[20:23], v[152:155]
    ds_read_b64_tr_b16 v[72:73], v2 offset:14432
    ds_read_b64_tr_b16 v[74:75], v2 offset:18016
    s_waitcnt lgkmcnt(14)
    v_mfma_f32_16x16x32_bf16 v[148:151], v[40:43], a[16:19], v[148:151]
    buffer_load_dwordx4 v4, s[4:7], s28 offen offset:1024 sc1 lds
    ds_read_b64_tr_b16 v[76:77], v2 offset:21600
    v_mfma_f32_16x16x32_bf16 v[148:151], v[44:47], a[24:27], v[148:151]
    ds_read_b64_tr_b16 v[78:79], v2 offset:25184
    v_mfma_f32_16x16x32_bf16 v[156:159], v[44:47], a[28:31], v[156:159]
    ds_read_b64_tr_b16 v[80:81], v2 offset:128
    v_mfma_f32_16x16x32_bf16 v[156:159], v[40:43], a[20:23], v[156:159]
    ds_read_b64_tr_b16 v[82:83], v2 offset:3712
    ds_read_b64_tr_b16 v[84:85], v2 offset:7296
    s_waitcnt lgkmcnt(15)
    v_mfma_f32_16x16x32_bf16 v[160:163], v[48:51], a[16:19], v[160:163]
    ds_read_b64_tr_b16 v[86:87], v2 offset:10880
    v_mfma_f32_16x16x32_bf16 v[160:163], v[52:55], a[24:27], v[160:163]
    buffer_load_dwordx4 v4, s[4:7], s28 offen offset:2048 sc1 lds
    ds_read_b64_tr_b16 v[88:89], v2 offset:14464
    v_mfma_f32_16x16x32_bf16 v[168:171], v[52:55], a[28:31], v[168:171]
    ds_read_b64_tr_b16 v[90:91], v2 offset:18048
    v_mfma_f32_16x16x32_bf16 v[168:171], v[48:51], a[20:23], v[168:171]
    ds_read_b64_tr_b16 v[92:93], v2 offset:21632
    s_waitcnt lgkmcnt(15)
    v_mfma_f32_16x16x32_bf16 v[164:167], v[56:59], a[16:19], v[164:167]
    ds_read_b64_tr_b16 v[94:95], v2 offset:25216
    ds_read_b64_tr_b16 v[32:33], v2 offset:160
    v_mfma_f32_16x16x32_bf16 v[164:167], v[60:63], a[24:27], v[164:167]
    ds_read_b64_tr_b16 v[34:35], v2 offset:3744
    v_mfma_f32_16x16x32_bf16 v[172:175], v[60:63], a[28:31], v[172:175]
    buffer_load_dwordx4 v4, s[4:7], s28 offen offset:3072 sc1 lds
    ds_read_b64_tr_b16 v[36:37], v2 offset:7328
    v_mfma_f32_16x16x32_bf16 v[172:175], v[56:59], a[20:23], v[172:175]
    ds_read_b64_tr_b16 v[38:39], v2 offset:10912
    s_waitcnt lgkmcnt(15)
    v_mfma_f32_16x16x32_bf16 v[176:179], v[64:67], a[16:19], v[176:179]
    ds_read_b64_tr_b16 v[40:41], v2 offset:14496
    ds_read_b64_tr_b16 v[42:43], v2 offset:18080
    v_mfma_f32_16x16x32_bf16 v[176:179], v[68:71], a[24:27], v[176:179]
    ds_read_b64_tr_b16 v[44:45], v2 offset:21664
    s_add_u32 m0, s29, 36864
    v_mfma_f32_16x16x32_bf16 v[184:187], v[68:71], a[28:31], v[184:187]
    buffer_load_dwordx4 v5, s[4:7], s28 offen offset:0 sc1 lds
    ds_read_b64_tr_b16 v[46:47], v2 offset:25248
    v_mfma_f32_16x16x32_bf16 v[184:187], v[64:67], a[20:23], v[184:187]
    ds_read_b64_tr_b16 v[48:49], v2 offset:192
    s_waitcnt lgkmcnt(15)
    v_mfma_f32_16x16x32_bf16 v[180:183], v[72:75], a[16:19], v[180:183]
    ds_read_b64_tr_b16 v[50:51], v2 offset:3776
    v_mfma_f32_16x16x32_bf16 v[180:183], v[76:79], a[24:27], v[180:183]
    ds_read_b64_tr_b16 v[52:53], v2 offset:7360
    ds_read_b64_tr_b16 v[54:55], v2 offset:10944
    v_mfma_f32_16x16x32_bf16 v[188:191], v[76:79], a[28:31], v[188:191]
    ds_read_b64_tr_b16 v[56:57], v2 offset:14528
    v_mfma_f32_16x16x32_bf16 v[188:191], v[72:75], a[20:23], v[188:191]
    buffer_load_dwordx4 v5, s[4:7], s28 offen offset:1024 sc1 lds
    ds_read_b64_tr_b16 v[58:59], v2 offset:18112
    s_waitcnt lgkmcnt(15)
    v_mfma_f32_16x16x32_bf16 v[192:195], v[80:83], a[16:19], v[192:195]
    ds_read_b64_tr_b16 v[60:61], v2 offset:21696
    v_mfma_f32_16x16x32_bf16 v[192:195], v[84:87], a[24:27], v[192:195]
    ds_read_b64_tr_b16 v[62:63], v2 offset:25280
    v_mfma_f32_16x16x32_bf16 v[200:203], v[84:87], a[28:31], v[200:203]
    v_mfma_f32_16x16x32_bf16 v[200:203], v[80:83], a[20:23], v[200:203]
    s_waitcnt lgkmcnt(15)
    v_mfma_f32_16x16x32_bf16 v[196:199], v[88:91], a[16:19], v[196:199]
    buffer_load_dwordx4 v5, s[4:7], s28 offen offset:2048 sc1 lds
    s_add_u32 s28, s28, 28672
    v_mfma_f32_16x16x32_bf16 v[196:199], v[92:95], a[24:27], v[196:199]
    v_mfma_f32_16x16x32_bf16 v[204:207], v[92:95], a[28:31], v[204:207]
    v_mfma_f32_16x16x32_bf16 v[204:207], v[88:91], a[20:23], v[204:207]
    s_waitcnt lgkmcnt(12)
    v_mfma_f32_16x16x32_bf16 v[208:211], v[32:35], a[16:19], v[208:211]
    v_mfma_f32_16x16x32_bf16 v[208:211], v[36:39], a[24:27], v[208:211]
    v_mfma_f32_16x16x32_bf16 v[216:219], v[36:39], a[28:31], v[216:219]
    v_mfma_f32_16x16x32_bf16 v[216:219], v[32:35], a[20:23], v[216:219]
    s_waitcnt lgkmcnt(0)
    s_barrier
    v_mfma_f32_16x16x32_bf16 v[212:215], v[40:43], a[16:19], v[212:215]
    ds_read_b64_tr_b16 v[64:65], v1 offset:0
    ds_read_b64_tr_b16 v[66:67], v1 offset:3584
    v_mfma_f32_16x16x32_bf16 v[212:215], v[44:47], a[24:27], v[212:215]
    buffer_load_dwordx4 a[64:67], v6, s[8:11], s23 offen offset:0 sc1
    ds_read_b64_tr_b16 v[68:69], v1 offset:7168
    v_mfma_f32_16x16x32_bf16 v[220:223], v[44:47], a[28:31], v[220:223]
    ds_read_b64_tr_b16 v[70:71], v1 offset:10752
    v_mfma_f32_16x16x32_bf16 v[220:223], v[40:43], a[20:23], v[220:223]
    ds_read_b64_tr_b16 v[72:73], v1 offset:14336
    v_mfma_f32_16x16x32_bf16 v[224:227], v[48:51], a[16:19], v[224:227]
    ds_read_b64_tr_b16 v[74:75], v1 offset:17920
    ds_read_b64_tr_b16 v[76:77], v1 offset:21504
    v_mfma_f32_16x16x32_bf16 v[224:227], v[52:55], a[24:27], v[224:227]
    buffer_load_dwordx4 a[68:71], v7, s[8:11], s23 offen offset:0 sc1
    ds_read_b64_tr_b16 v[78:79], v1 offset:25088
    v_mfma_f32_16x16x32_bf16 v[232:235], v[52:55], a[28:31], v[232:235]
    ds_read_b64_tr_b16 v[80:81], v1 offset:32
    v_mfma_f32_16x16x32_bf16 v[232:235], v[48:51], a[20:23], v[232:235]
    ds_read_b64_tr_b16 v[82:83], v1 offset:3616
    v_mfma_f32_16x16x32_bf16 v[228:231], v[56:59], a[16:19], v[228:231]
    ds_read_b64_tr_b16 v[84:85], v1 offset:7200
    v_mfma_f32_16x16x32_bf16 v[228:231], v[60:63], a[24:27], v[228:231]
    ds_read_b64_tr_b16 v[86:87], v1 offset:10784
    ds_read_b64_tr_b16 v[88:89], v1 offset:14368
    v_mfma_f32_16x16x32_bf16 v[236:239], v[60:63], a[28:31], v[236:239]
    buffer_load_dwordx4 a[72:75], v6, s[8:11], s23 offen offset:1024 sc1
    ds_read_b64_tr_b16 v[90:91], v1 offset:17952
    v_mfma_f32_16x16x32_bf16 v[236:239], v[56:59], a[20:23], v[236:239]
    ds_read_b64_tr_b16 v[92:93], v1 offset:21536
    s_waitcnt vmcnt(22) lgkmcnt(11)
    v_mfma_f32_16x16x32_bf16 v[128:131], v[64:67], a[32:35], v[128:131]
    ds_read_b64_tr_b16 v[94:95], v1 offset:25120
    v_mfma_f32_16x16x32_bf16 v[128:131], v[68:71], a[40:43], v[128:131]
    ds_read_b64_tr_b16 v[32:33], v1 offset:64
    ds_read_b64_tr_b16 v[34:35], v1 offset:3648
    v_mfma_f32_16x16x32_bf16 v[136:139], v[68:71], a[44:47], v[136:139]
    ds_read_b64_tr_b16 v[36:37], v1 offset:7232
    v_mfma_f32_16x16x32_bf16 v[136:139], v[64:67], a[36:39], v[136:139]
    buffer_load_dwordx4 a[76:79], v7, s[8:11], s23 offen offset:1024 sc1
    ds_read_b64_tr_b16 v[38:39], v1 offset:10816
    s_add_u32 s23, s23, 2048
    s_waitcnt lgkmcnt(12)
    v_mfma_f32_16x16x32_bf16 v[132:135], v[72:75], a[32:35], v[132:135]
    ds_read_b64_tr_b16 v[40:41], v1 offset:14400
    v_mfma_f32_16x16x32_bf16 v[132:135], v[76:79], a[40:43], v[132:135]
    ds_read_b64_tr_b16 v[42:43], v1 offset:17984
    v_mfma_f32_16x16x32_bf16 v[140:143], v[76:79], a[44:47], v[140:143]
    ds_read_b64_tr_b16 v[44:45], v1 offset:21568
    ds_read_b64_tr_b16 v[46:47], v1 offset:25152
    s_add_u32 m0, s29, 65536
    v_mfma_f32_16x16x32_bf16 v[140:143], v[72:75], a[36:39], v[140:143]
    buffer_load_dwordx4 v4, s[4:7], s28 offen offset:0 sc1 lds
    ds_read_b64_tr_b16 v[48:49], v1 offset:96
    s_waitcnt lgkmcnt(13)
    v_mfma_f32_16x16x32_bf16 v[144:147], v[80:83], a[32:35], v[144:147]
    ds_read_b64_tr_b16 v[50:51], v1 offset:3680
    v_mfma_f32_16x16x32_bf16 v[144:147], v[84:87], a[40:43], v[144:147]
    ds_read_b64_tr_b16 v[52:53], v1 offset:7264
    v_mfma_f32_16x16x32_bf16 v[152:155], v[84:87], a[44:47], v[152:155]
    ds_read_b64_tr_b16 v[54:55], v1 offset:10848
    v_mfma_f32_16x16x32_bf16 v[152:155], v[80:83], a[36:39], v[152:155]
    ds_read_b64_tr_b16 v[56:57], v1 offset:14432
    ds_read_b64_tr_b16 v[58:59], v1 offset:18016
    s_waitcnt lgkmcnt(14)
    v_mfma_f32_16x16x32_bf16 v[148:151], v[88:91], a[32:35], v[148:151]
    buffer_load_dwordx4 v4, s[4:7], s28 offen offset:1024 sc1 lds
    ds_read_b64_tr_b16 v[60:61], v1 offset:21600
    v_mfma_f32_16x16x32_bf16 v[148:151], v[92:95], a[40:43], v[148:151]
    ds_read_b64_tr_b16 v[62:63], v1 offset:25184
    v_mfma_f32_16x16x32_bf16 v[156:159], v[92:95], a[44:47], v[156:159]
    ds_read_b64_tr_b16 v[64:65], v1 offset:128
    v_mfma_f32_16x16x32_bf16 v[156:159], v[88:91], a[36:39], v[156:159]
    ds_read_b64_tr_b16 v[66:67], v1 offset:3712
    ds_read_b64_tr_b16 v[68:69], v1 offset:7296
    s_waitcnt lgkmcnt(15)
    v_mfma_f32_16x16x32_bf16 v[160:163], v[32:35], a[32:35], v[160:163]
    ds_read_b64_tr_b16 v[70:71], v1 offset:10880
    v_mfma_f32_16x16x32_bf16 v[160:163], v[36:39], a[40:43], v[160:163]
    buffer_load_dwordx4 v4, s[4:7], s28 offen offset:2048 sc1 lds
    ds_read_b64_tr_b16 v[72:73], v1 offset:14464
    v_mfma_f32_16x16x32_bf16 v[168:171], v[36:39], a[44:47], v[168:171]
    ds_read_b64_tr_b16 v[74:75], v1 offset:18048
    v_mfma_f32_16x16x32_bf16 v[168:171], v[32:35], a[36:39], v[168:171]
    ds_read_b64_tr_b16 v[76:77], v1 offset:21632
    s_waitcnt lgkmcnt(15)
    v_mfma_f32_16x16x32_bf16 v[164:167], v[40:43], a[32:35], v[164:167]
    ds_read_b64_tr_b16 v[78:79], v1 offset:25216
    ds_read_b64_tr_b16 v[80:81], v1 offset:160
    v_mfma_f32_16x16x32_bf16 v[164:167], v[44:47], a[40:43], v[164:167]
    ds_read_b64_tr_b16 v[82:83], v1 offset:3744
    v_mfma_f32_16x16x32_bf16 v[172:175], v[44:47], a[44:47], v[172:175]
    buffer_load_dwordx4 v4, s[4:7], s28 offen offset:3072 sc1 lds
    ds_read_b64_tr_b16 v[84:85], v1 offset:7328
    v_mfma_f32_16x16x32_bf16 v[172:175], v[40:43], a[36:39], v[172:175]
    ds_read_b64_tr_b16 v[86:87], v1 offset:10912
    s_waitcnt lgkmcnt(15)
    v_mfma_f32_16x16x32_bf16 v[176:179], v[48:51], a[32:35], v[176:179]
    ds_read_b64_tr_b16 v[88:89], v1 offset:14496
    ds_read_b64_tr_b16 v[90:91], v1 offset:18080
    v_mfma_f32_16x16x32_bf16 v[176:179], v[52:55], a[40:43], v[176:179]
    ds_read_b64_tr_b16 v[92:93], v1 offset:21664
    s_add_u32 m0, s29, 69632
    v_mfma_f32_16x16x32_bf16 v[184:187], v[52:55], a[44:47], v[184:187]
    buffer_load_dwordx4 v5, s[4:7], s28 offen offset:0 sc1 lds
    ds_read_b64_tr_b16 v[94:95], v1 offset:25248
    v_mfma_f32_16x16x32_bf16 v[184:187], v[48:51], a[36:39], v[184:187]
    ds_read_b64_tr_b16 v[32:33], v1 offset:192
    s_waitcnt lgkmcnt(15)
    v_mfma_f32_16x16x32_bf16 v[180:183], v[56:59], a[32:35], v[180:183]
    ds_read_b64_tr_b16 v[34:35], v1 offset:3776
    v_mfma_f32_16x16x32_bf16 v[180:183], v[60:63], a[40:43], v[180:183]
    ds_read_b64_tr_b16 v[36:37], v1 offset:7360
    ds_read_b64_tr_b16 v[38:39], v1 offset:10944
    v_mfma_f32_16x16x32_bf16 v[188:191], v[60:63], a[44:47], v[188:191]
    ds_read_b64_tr_b16 v[40:41], v1 offset:14528
    v_mfma_f32_16x16x32_bf16 v[188:191], v[56:59], a[36:39], v[188:191]
    buffer_load_dwordx4 v5, s[4:7], s28 offen offset:1024 sc1 lds
    ds_read_b64_tr_b16 v[42:43], v1 offset:18112
    s_waitcnt lgkmcnt(15)
    v_mfma_f32_16x16x32_bf16 v[192:195], v[64:67], a[32:35], v[192:195]
    ds_read_b64_tr_b16 v[44:45], v1 offset:21696
    v_mfma_f32_16x16x32_bf16 v[192:195], v[68:71], a[40:43], v[192:195]
    ds_read_b64_tr_b16 v[46:47], v1 offset:25280
    v_mfma_f32_16x16x32_bf16 v[200:203], v[68:71], a[44:47], v[200:203]
    v_mfma_f32_16x16x32_bf16 v[200:203], v[64:67], a[36:39], v[200:203]
    s_waitcnt lgkmcnt(15)
    v_mfma_f32_16x16x32_bf16 v[196:199], v[72:75], a[32:35], v[196:199]
    buffer_load_dwordx4 v5, s[4:7], s28 offen offset:2048 sc1 lds
    s_add_u32 s28, s28, 28672
    v_mfma_f32_16x16x32_bf16 v[196:199], v[76:79], a[40:43], v[196:199]
    v_mfma_f32_16x16x32_bf16 v[204:207], v[76:79], a[44:47], v[204:207]
    v_mfma_f32_16x16x32_bf16 v[204:207], v[72:75], a[36:39], v[204:207]
    s_waitcnt lgkmcnt(12)
    v_mfma_f32_16x16x32_bf16 v[208:211], v[80:83], a[32:35], v[208:211]
    v_mfma_f32_16x16x32_bf16 v[208:211], v[84:87], a[40:43], v[208:211]
    v_mfma_f32_16x16x32_bf16 v[216:219], v[84:87], a[44:47], v[216:219]
    v_mfma_f32_16x16x32_bf16 v[216:219], v[80:83], a[36:39], v[216:219]
    s_waitcnt lgkmcnt(0)
    s_barrier
    v_mfma_f32_16x16x32_bf16 v[212:215], v[88:91], a[32:35], v[212:215]
    ds_read_b64_tr_b16 v[48:49], v3 offset:0
    ds_read_b64_tr_b16 v[50:51], v3 offset:3584
    v_mfma_f32_16x16x32_bf16 v[212:215], v[92:95], a[40:43], v[212:215]
    buffer_load_dwordx4 a[80:83], v6, s[8:11], s23 offen offset:0 sc1
    ds_read_b64_tr_b16 v[52:53], v3 offset:7168
    v_mfma_f32_16x16x32_bf16 v[220:223], v[92:95], a[44:47], v[220:223]
    ds_read_b64_tr_b16 v[54:55], v3 offset:10752
    v_mfma_f32_16x16x32_bf16 v[220:223], v[88:91], a[36:39], v[220:223]
    ds_read_b64_tr_b16 v[56:57], v3 offset:14336
    v_mfma_f32_16x16x32_bf16 v[224:227], v[32:35], a[32:35], v[224:227]
    ds_read_b64_tr_b16 v[58:59], v3 offset:17920
    ds_read_b64_tr_b16 v[60:61], v3 offset:21504
    v_mfma_f32_16x16x32_bf16 v[224:227], v[36:39], a[40:43], v[224:227]
    buffer_load_dwordx4 a[84:87], v7, s[8:11], s23 offen offset:0 sc1
    ds_read_b64_tr_b16 v[62:63], v3 offset:25088
    v_mfma_f32_16x16x32_bf16 v[232:235], v[36:39], a[44:47], v[232:235]
    ds_read_b64_tr_b16 v[64:65], v3 offset:32
    v_mfma_f32_16x16x32_bf16 v[232:235], v[32:35], a[36:39], v[232:235]
    ds_read_b64_tr_b16 v[66:67], v3 offset:3616
    v_mfma_f32_16x16x32_bf16 v[228:231], v[40:43], a[32:35], v[228:231]
    ds_read_b64_tr_b16 v[68:69], v3 offset:7200
    v_mfma_f32_16x16x32_bf16 v[228:231], v[44:47], a[40:43], v[228:231]
    ds_read_b64_tr_b16 v[70:71], v3 offset:10784
    ds_read_b64_tr_b16 v[72:73], v3 offset:14368
    v_mfma_f32_16x16x32_bf16 v[236:239], v[44:47], a[44:47], v[236:239]
    buffer_load_dwordx4 a[88:91], v6, s[8:11], s23 offen offset:1024 sc1
    ds_read_b64_tr_b16 v[74:75], v3 offset:17952
    v_mfma_f32_16x16x32_bf16 v[236:239], v[40:43], a[36:39], v[236:239]
    ds_read_b64_tr_b16 v[76:77], v3 offset:21536
    s_waitcnt vmcnt(21) lgkmcnt(11)
    v_mfma_f32_16x16x32_bf16 v[128:131], v[48:51], a[48:51], v[128:131]
    ds_read_b64_tr_b16 v[78:79], v3 offset:25120
    v_mfma_f32_16x16x32_bf16 v[128:131], v[52:55], a[56:59], v[128:131]
    ds_read_b64_tr_b16 v[80:81], v3 offset:64
    ds_read_b64_tr_b16 v[82:83], v3 offset:3648
    v_mfma_f32_16x16x32_bf16 v[136:139], v[52:55], a[60:63], v[136:139]
    ds_read_b64_tr_b16 v[84:85], v3 offset:7232
    v_mfma_f32_16x16x32_bf16 v[136:139], v[48:51], a[52:55], v[136:139]
    buffer_load_dwordx4 a[92:95], v7, s[8:11], s23 offen offset:1024 sc1
    ds_read_b64_tr_b16 v[86:87], v3 offset:10816
    s_add_u32 s23, s23, 2048
    s_waitcnt lgkmcnt(12)
    v_mfma_f32_16x16x32_bf16 v[132:135], v[56:59], a[48:51], v[132:135]
    ds_read_b64_tr_b16 v[88:89], v3 offset:14400
    v_mfma_f32_16x16x32_bf16 v[132:135], v[60:63], a[56:59], v[132:135]
    ds_read_b64_tr_b16 v[90:91], v3 offset:17984
    v_mfma_f32_16x16x32_bf16 v[140:143], v[60:63], a[60:63], v[140:143]
    ds_read_b64_tr_b16 v[92:93], v3 offset:21568
    ds_read_b64_tr_b16 v[94:95], v3 offset:25152
    s_add_u32 m0, s29, 0
    v_mfma_f32_16x16x32_bf16 v[140:143], v[56:59], a[52:55], v[140:143]
    buffer_load_dwordx4 v4, s[4:7], s28 offen offset:0 sc1 lds
    ds_read_b64_tr_b16 v[32:33], v3 offset:96
    s_waitcnt lgkmcnt(13)
    v_mfma_f32_16x16x32_bf16 v[144:147], v[64:67], a[48:51], v[144:147]
    ds_read_b64_tr_b16 v[34:35], v3 offset:3680
    v_mfma_f32_16x16x32_bf16 v[144:147], v[68:71], a[56:59], v[144:147]
    ds_read_b64_tr_b16 v[36:37], v3 offset:7264
    v_mfma_f32_16x16x32_bf16 v[152:155], v[68:71], a[60:63], v[152:155]
    ds_read_b64_tr_b16 v[38:39], v3 offset:10848
    v_mfma_f32_16x16x32_bf16 v[152:155], v[64:67], a[52:55], v[152:155]
    ds_read_b64_tr_b16 v[40:41], v3 offset:14432
    ds_read_b64_tr_b16 v[42:43], v3 offset:18016
    s_waitcnt lgkmcnt(14)
    v_mfma_f32_16x16x32_bf16 v[148:151], v[72:75], a[48:51], v[148:151]
    buffer_load_dwordx4 v4, s[4:7], s28 offen offset:1024 sc1 lds
    ds_read_b64_tr_b16 v[44:45], v3 offset:21600
    v_mfma_f32_16x16x32_bf16 v[148:151], v[76:79], a[56:59], v[148:151]
    ds_read_b64_tr_b16 v[46:47], v3 offset:25184
    v_mfma_f32_16x16x32_bf16 v[156:159], v[76:79], a[60:63], v[156:159]
    ds_read_b64_tr_b16 v[48:49], v3 offset:128
    v_mfma_f32_16x16x32_bf16 v[156:159], v[72:75], a[52:55], v[156:159]
    ds_read_b64_tr_b16 v[50:51], v3 offset:3712
    ds_read_b64_tr_b16 v[52:53], v3 offset:7296
    s_waitcnt lgkmcnt(15)
    v_mfma_f32_16x16x32_bf16 v[160:163], v[80:83], a[48:51], v[160:163]
    ds_read_b64_tr_b16 v[54:55], v3 offset:10880
    v_mfma_f32_16x16x32_bf16 v[160:163], v[84:87], a[56:59], v[160:163]
    buffer_load_dwordx4 v4, s[4:7], s28 offen offset:2048 sc1 lds
    ds_read_b64_tr_b16 v[56:57], v3 offset:14464
    v_mfma_f32_16x16x32_bf16 v[168:171], v[84:87], a[60:63], v[168:171]
    ds_read_b64_tr_b16 v[58:59], v3 offset:18048
    v_mfma_f32_16x16x32_bf16 v[168:171], v[80:83], a[52:55], v[168:171]
    ds_read_b64_tr_b16 v[60:61], v3 offset:21632
    s_waitcnt lgkmcnt(15)
    v_mfma_f32_16x16x32_bf16 v[164:167], v[88:91], a[48:51], v[164:167]
    ds_read_b64_tr_b16 v[62:63], v3 offset:25216
    ds_read_b64_tr_b16 v[64:65], v3 offset:160
    v_mfma_f32_16x16x32_bf16 v[164:167], v[92:95], a[56:59], v[164:167]
    ds_read_b64_tr_b16 v[66:67], v3 offset:3744
    v_mfma_f32_16x16x32_bf16 v[172:175], v[92:95], a[60:63], v[172:175]
    buffer_load_dwordx4 v4, s[4:7], s28 offen offset:3072 sc1 lds
    ds_read_b64_tr_b16 v[68:69], v3 offset:7328
    v_mfma_f32_16x16x32_bf16 v[172:175], v[88:91], a[52:55], v[172:175]
    ds_read_b64_tr_b16 v[70:71], v3 offset:10912
    s_waitcnt lgkmcnt(15)
    v_mfma_f32_16x16x32_bf16 v[176:179], v[32:35], a[48:51], v[176:179]
    ds_read_b64_tr_b16 v[72:73], v3 offset:14496
    ds_read_b64_tr_b16 v[74:75], v3 offset:18080
    v_mfma_f32_16x16x32_bf16 v[176:179], v[36:39], a[56:59], v[176:179]
    ds_read_b64_tr_b16 v[76:77], v3 offset:21664
    s_add_u32 m0, s29, 4096
    v_mfma_f32_16x16x32_bf16 v[184:187], v[36:39], a[60:63], v[184:187]
    buffer_load_dwordx4 v5, s[4:7], s28 offen offset:0 sc1 lds
    ds_read_b64_tr_b16 v[78:79], v3 offset:25248
    v_mfma_f32_16x16x32_bf16 v[184:187], v[32:35], a[52:55], v[184:187]
    ds_read_b64_tr_b16 v[80:81], v3 offset:192
    s_waitcnt lgkmcnt(15)
    v_mfma_f32_16x16x32_bf16 v[180:183], v[40:43], a[48:51], v[180:183]
    ds_read_b64_tr_b16 v[82:83], v3 offset:3776
    v_mfma_f32_16x16x32_bf16 v[180:183], v[44:47], a[56:59], v[180:183]
    ds_read_b64_tr_b16 v[84:85], v3 offset:7360
    ds_read_b64_tr_b16 v[86:87], v3 offset:10944
    v_mfma_f32_16x16x32_bf16 v[188:191], v[44:47], a[60:63], v[188:191]
    ds_read_b64_tr_b16 v[88:89], v3 offset:14528
    v_mfma_f32_16x16x32_bf16 v[188:191], v[40:43], a[52:55], v[188:191]
    buffer_load_dwordx4 v5, s[4:7], s28 offen offset:1024 sc1 lds
    ds_read_b64_tr_b16 v[90:91], v3 offset:18112
    s_waitcnt lgkmcnt(15)
    v_mfma_f32_16x16x32_bf16 v[192:195], v[48:51], a[48:51], v[192:195]
    ds_read_b64_tr_b16 v[92:93], v3 offset:21696
    v_mfma_f32_16x16x32_bf16 v[192:195], v[52:55], a[56:59], v[192:195]
    ds_read_b64_tr_b16 v[94:95], v3 offset:25280
    v_mfma_f32_16x16x32_bf16 v[200:203], v[52:55], a[60:63], v[200:203]
    v_mfma_f32_16x16x32_bf16 v[200:203], v[48:51], a[52:55], v[200:203]
    s_waitcnt lgkmcnt(15)
    v_mfma_f32_16x16x32_bf16 v[196:199], v[56:59], a[48:51], v[196:199]
    buffer_load_dwordx4 v5, s[4:7], s28 offen offset:2048 sc1 lds
    s_add_u32 s28, s28, 28672
    v_mfma_f32_16x16x32_bf16 v[196:199], v[60:63], a[56:59], v[196:199]
    v_mfma_f32_16x16x32_bf16 v[204:207], v[60:63], a[60:63], v[204:207]
    v_mfma_f32_16x16x32_bf16 v[204:207], v[56:59], a[52:55], v[204:207]
    s_waitcnt lgkmcnt(12)
    v_mfma_f32_16x16x32_bf16 v[208:211], v[64:67], a[48:51], v[208:211]
    v_mfma_f32_16x16x32_bf16 v[208:211], v[68:71], a[56:59], v[208:211]
    v_mfma_f32_16x16x32_bf16 v[216:219], v[68:71], a[60:63], v[216:219]
    v_mfma_f32_16x16x32_bf16 v[216:219], v[64:67], a[52:55], v[216:219]
    s_waitcnt lgkmcnt(0)
    s_waitcnt vmcnt(22)
    s_barrier
    v_mfma_f32_16x16x32_bf16 v[212:215], v[72:75], a[48:51], v[212:215]
    ds_read_b64_tr_b16 v[32:33], v1 offset:32768
    ds_read_b64_tr_b16 v[34:35], v1 offset:36352
    v_mfma_f32_16x16x32_bf16 v[212:215], v[76:79], a[56:59], v[212:215]
    buffer_load_dwordx4 a[96:99], v6, s[8:11], s23 offen offset:0 sc1
    ds_read_b64_tr_b16 v[36:37], v1 offset:39936
    v_mfma_f32_16x16x32_bf16 v[220:223], v[76:79], a[60:63], v[220:223]
    ds_read_b64_tr_b16 v[38:39], v1 offset:43520
    v_mfma_f32_16x16x32_bf16 v[220:223], v[72:75], a[52:55], v[220:223]
    ds_read_b64_tr_b16 v[40:41], v1 offset:47104
    v_mfma_f32_16x16x32_bf16 v[224:227], v[80:83], a[48:51], v[224:227]
    ds_read_b64_tr_b16 v[42:43], v1 offset:50688
    ds_read_b64_tr_b16 v[44:45], v1 offset:54272
    v_mfma_f32_16x16x32_bf16 v[224:227], v[84:87], a[56:59], v[224:227]
    buffer_load_dwordx4 a[100:103], v7, s[8:11], s23 offen offset:0 sc1
    ds_read_b64_tr_b16 v[46:47], v1 offset:57856
    v_mfma_f32_16x16x32_bf16 v[232:235], v[84:87], a[60:63], v[232:235]
    ds_read_b64_tr_b16 v[48:49], v1 offset:32800
    v_mfma_f32_16x16x32_bf16 v[232:235], v[80:83], a[52:55], v[232:235]
    ds_read_b64_tr_b16 v[50:51], v1 offset:36384
    v_mfma_f32_16x16x32_bf16 v[228:231], v[88:91], a[48:51], v[228:231]
    ds_read_b64_tr_b16 v[52:53], v1 offset:39968
    v_mfma_f32_16x16x32_bf16 v[228:231], v[92:95], a[56:59], v[228:231]
    ds_read_b64_tr_b16 v[54:55], v1 offset:43552
    ds_read_b64_tr_b16 v[56:57], v1 offset:47136
    v_mfma_f32_16x16x32_bf16 v[236:239], v[92:95], a[60:63], v[236:239]
    buffer_load_dwordx4 a[104:107], v6, s[8:11], s23 offen offset:1024 sc1
    ds_read_b64_tr_b16 v[58:59], v1 offset:50720
    v_mfma_f32_16x16x32_bf16 v[236:239], v[88:91], a[52:55], v[236:239]
    ds_read_b64_tr_b16 v[60:61], v1 offset:54304
    s_waitcnt vmcnt(21) lgkmcnt(11)
    v_mfma_f32_16x16x32_bf16 v[128:131], v[32:35], a[64:67], v[128:131]
    ds_read_b64_tr_b16 v[62:63], v1 offset:57888
    v_mfma_f32_16x16x32_bf16 v[128:131], v[36:39], a[72:75], v[128:131]
    ds_read_b64_tr_b16 v[64:65], v1 offset:32832
    ds_read_b64_tr_b16 v[66:67], v1 offset:36416
    v_mfma_f32_16x16x32_bf16 v[136:139], v[36:39], a[76:79], v[136:139]
    ds_read_b64_tr_b16 v[68:69], v1 offset:40000
    v_mfma_f32_16x16x32_bf16 v[136:139], v[32:35], a[68:71], v[136:139]
    buffer_load_dwordx4 a[108:111], v7, s[8:11], s23 offen offset:1024 sc1
    ds_read_b64_tr_b16 v[70:71], v1 offset:43584
    s_add_u32 s23, s23, 2048
    s_waitcnt lgkmcnt(12)
    v_mfma_f32_16x16x32_bf16 v[132:135], v[40:43], a[64:67], v[132:135]
    ds_read_b64_tr_b16 v[72:73], v1 offset:47168
    v_mfma_f32_16x16x32_bf16 v[132:135], v[44:47], a[72:75], v[132:135]
    ds_read_b64_tr_b16 v[74:75], v1 offset:50752
    v_mfma_f32_16x16x32_bf16 v[140:143], v[44:47], a[76:79], v[140:143]
    ds_read_b64_tr_b16 v[76:77], v1 offset:54336
    ds_read_b64_tr_b16 v[78:79], v1 offset:57920
    s_add_u32 m0, s29, 131072
    v_mfma_f32_16x16x32_bf16 v[140:143], v[40:43], a[68:71], v[140:143]
    buffer_load_dwordx4 v4, s[4:7], s28 offen offset:0 sc1 lds
    ds_read_b64_tr_b16 v[80:81], v1 offset:32864
    s_waitcnt lgkmcnt(13)
    v_mfma_f32_16x16x32_bf16 v[144:147], v[48:51], a[64:67], v[144:147]
    ds_read_b64_tr_b16 v[82:83], v1 offset:36448
    v_mfma_f32_16x16x32_bf16 v[144:147], v[52:55], a[72:75], v[144:147]
    ds_read_b64_tr_b16 v[84:85], v1 offset:40032
    v_mfma_f32_16x16x32_bf16 v[152:155], v[52:55], a[76:79], v[152:155]
    ds_read_b64_tr_b16 v[86:87], v1 offset:43616
    v_mfma_f32_16x16x32_bf16 v[152:155], v[48:51], a[68:71], v[152:155]
    ds_read_b64_tr_b16 v[88:89], v1 offset:47200
    ds_read_b64_tr_b16 v[90:91], v1 offset:50784
    s_waitcnt lgkmcnt(14)
    v_mfma_f32_16x16x32_bf16 v[148:151], v[56:59], a[64:67], v[148:151]
    buffer_load_dwordx4 v4, s[4:7], s28 offen offset:1024 sc1 lds
    ds_read_b64_tr_b16 v[92:93], v1 offset:54368
    v_mfma_f32_16x16x32_bf16 v[148:151], v[60:63], a[72:75], v[148:151]
    ds_read_b64_tr_b16 v[94:95], v1 offset:57952
    v_mfma_f32_16x16x32_bf16 v[156:159], v[60:63], a[76:79], v[156:159]
    ds_read_b64_tr_b16 v[32:33], v1 offset:32896
    v_mfma_f32_16x16x32_bf16 v[156:159], v[56:59], a[68:71], v[156:159]
    ds_read_b64_tr_b16 v[34:35], v1 offset:36480
    ds_read_b64_tr_b16 v[36:37], v1 offset:40064
    s_waitcnt lgkmcnt(15)
    v_mfma_f32_16x16x32_bf16 v[160:163], v[64:67], a[64:67], v[160:163]
    ds_read_b64_tr_b16 v[38:39], v1 offset:43648
    v_mfma_f32_16x16x32_bf16 v[160:163], v[68:71], a[72:75], v[160:163]
    buffer_load_dwordx4 v4, s[4:7], s28 offen offset:2048 sc1 lds
    ds_read_b64_tr_b16 v[40:41], v1 offset:47232
    v_mfma_f32_16x16x32_bf16 v[168:171], v[68:71], a[76:79], v[168:171]
    ds_read_b64_tr_b16 v[42:43], v1 offset:50816
    v_mfma_f32_16x16x32_bf16 v[168:171], v[64:67], a[68:71], v[168:171]
    ds_read_b64_tr_b16 v[44:45], v1 offset:54400
    s_waitcnt lgkmcnt(15)
    v_mfma_f32_16x16x32_bf16 v[164:167], v[72:75], a[64:67], v[164:167]
    ds_read_b64_tr_b16 v[46:47], v1 offset:57984
    ds_read_b64_tr_b16 v[48:49], v1 offset:32928
    v_mfma_f32_16x16x32_bf16 v[164:167], v[76:79], a[72:75], v[164:167]
    ds_read_b64_tr_b16 v[50:51], v1 offset:36512
    v_mfma_f32_16x16x32_bf16 v[172:175], v[76:79], a[76:79], v[172:175]
    buffer_load_dwordx4 v4, s[4:7], s28 offen offset:3072 sc1 lds
    ds_read_b64_tr_b16 v[52:53], v1 offset:40096
    v_mfma_f32_16x16x32_bf16 v[172:175], v[72:75], a[68:71], v[172:175]
    ds_read_b64_tr_b16 v[54:55], v1 offset:43680
    s_waitcnt lgkmcnt(15)
    v_mfma_f32_16x16x32_bf16 v[176:179], v[80:83], a[64:67], v[176:179]
    ds_read_b64_tr_b16 v[56:57], v1 offset:47264
    ds_read_b64_tr_b16 v[58:59], v1 offset:50848
    v_mfma_f32_16x16x32_bf16 v[176:179], v[84:87], a[72:75], v[176:179]
    ds_read_b64_tr_b16 v[60:61], v1 offset:54432
    s_add_u32 m0, s29, 135168
    v_mfma_f32_16x16x32_bf16 v[184:187], v[84:87], a[76:79], v[184:187]
    buffer_load_dwordx4 v5, s[4:7], s28 offen offset:0 sc1 lds
    ds_read_b64_tr_b16 v[62:63], v1 offset:58016
    v_mfma_f32_16x16x32_bf16 v[184:187], v[80:83], a[68:71], v[184:187]
    ds_read_b64_tr_b16 v[64:65], v1 offset:32960
    s_waitcnt lgkmcnt(15)
    v_mfma_f32_16x16x32_bf16 v[180:183], v[88:91], a[64:67], v[180:183]
    ds_read_b64_tr_b16 v[66:67], v1 offset:36544
    v_mfma_f32_16x16x32_bf16 v[180:183], v[92:95], a[72:75], v[180:183]
    ds_read_b64_tr_b16 v[68:69], v1 offset:40128
    ds_read_b64_tr_b16 v[70:71], v1 offset:43712
    v_mfma_f32_16x16x32_bf16 v[188:191], v[92:95], a[76:79], v[188:191]
    ds_read_b64_tr_b16 v[72:73], v1 offset:47296
    v_mfma_f32_16x16x32_bf16 v[188:191], v[88:91], a[68:71], v[188:191]
    buffer_load_dwordx4 v5, s[4:7], s28 offen offset:1024 sc1 lds
    ds_read_b64_tr_b16 v[74:75], v1 offset:50880
    s_waitcnt lgkmcnt(15)
    v_mfma_f32_16x16x32_bf16 v[192:195], v[32:35], a[64:67], v[192:195]
    ds_read_b64_tr_b16 v[76:77], v1 offset:54464
    v_mfma_f32_16x16x32_bf16 v[192:195], v[36:39], a[72:75], v[192:195]
    ds_read_b64_tr_b16 v[78:79], v1 offset:58048
    v_mfma_f32_16x16x32_bf16 v[200:203], v[36:39], a[76:79], v[200:203]
    v_mfma_f32_16x16x32_bf16 v[200:203], v[32:35], a[68:71], v[200:203]
    s_waitcnt lgkmcnt(15)
    v_mfma_f32_16x16x32_bf16 v[196:199], v[40:43], a[64:67], v[196:199]
    buffer_load_dwordx4 v5, s[4:7], s28 offen offset:2048 sc1 lds
    s_add_u32 s28, s28, 28672
    v_mfma_f32_16x16x32_bf16 v[196:199], v[44:47], a[72:75], v[196:199]
    v_mfma_f32_16x16x32_bf16 v[204:207], v[44:47], a[76:79], v[204:207]
    v_mfma_f32_16x16x32_bf16 v[204:207], v[40:43], a[68:71], v[204:207]
    s_waitcnt lgkmcnt(12)
    v_mfma_f32_16x16x32_bf16 v[208:211], v[48:51], a[64:67], v[208:211]
    v_mfma_f32_16x16x32_bf16 v[208:211], v[52:55], a[72:75], v[208:211]
    v_mfma_f32_16x16x32_bf16 v[216:219], v[52:55], a[76:79], v[216:219]
    v_mfma_f32_16x16x32_bf16 v[216:219], v[48:51], a[68:71], v[216:219]
    s_waitcnt lgkmcnt(0)
    s_waitcnt vmcnt(22)
    s_barrier
    v_mfma_f32_16x16x32_bf16 v[212:215], v[56:59], a[64:67], v[212:215]
    ds_read_b64_tr_b16 v[80:81], v2 offset:0
    ds_read_b64_tr_b16 v[82:83], v2 offset:3584
    v_mfma_f32_16x16x32_bf16 v[212:215], v[60:63], a[72:75], v[212:215]
    buffer_load_dwordx4 a[112:115], v6, s[8:11], s23 offen offset:0 sc1
    ds_read_b64_tr_b16 v[84:85], v2 offset:7168
    v_mfma_f32_16x16x32_bf16 v[220:223], v[60:63], a[76:79], v[220:223]
    ds_read_b64_tr_b16 v[86:87], v2 offset:10752
    v_mfma_f32_16x16x32_bf16 v[220:223], v[56:59], a[68:71], v[220:223]
    ds_read_b64_tr_b16 v[88:89], v2 offset:14336
    v_mfma_f32_16x16x32_bf16 v[224:227], v[64:67], a[64:67], v[224:227]
    ds_read_b64_tr_b16 v[90:91], v2 offset:17920
    ds_read_b64_tr_b16 v[92:93], v2 offset:21504
    v_mfma_f32_16x16x32_bf16 v[224:227], v[68:71], a[72:75], v[224:227]
    buffer_load_dwordx4 a[116:119], v7, s[8:11], s23 offen offset:0 sc1
    ds_read_b64_tr_b16 v[94:95], v2 offset:25088
    v_mfma_f32_16x16x32_bf16 v[232:235], v[68:71], a[76:79], v[232:235]
    ds_read_b64_tr_b16 v[32:33], v2 offset:32
    v_mfma_f32_16x16x32_bf16 v[232:235], v[64:67], a[68:71], v[232:235]
    ds_read_b64_tr_b16 v[34:35], v2 offset:3616
    v_mfma_f32_16x16x32_bf16 v[228:231], v[72:75], a[64:67], v[228:231]
    ds_read_b64_tr_b16 v[36:37], v2 offset:7200
    v_mfma_f32_16x16x32_bf16 v[228:231], v[76:79], a[72:75], v[228:231]
    buffer_load_dwordx4 a[120:123], v6, s[8:11], s23 offen offset:1024 sc1
    ds_read_b64_tr_b16 v[38:39], v2 offset:10784
    ds_read_b64_tr_b16 v[40:41], v2 offset:14368
    v_mfma_f32_16x16x32_bf16 v[236:239], v[76:79], a[76:79], v[236:239]
    ds_read_b64_tr_b16 v[42:43], v2 offset:17952
    v_mfma_f32_16x16x32_bf16 v[236:239], v[72:75], a[68:71], v[236:239]
    ds_read_b64_tr_b16 v[44:45], v2 offset:21536
    s_waitcnt vmcnt(21) lgkmcnt(11)
    v_mfma_f32_16x16x32_bf16 v[128:131], v[80:83], a[80:83], v[128:131]
    ds_read_b64_tr_b16 v[46:47], v2 offset:25120
    v_mfma_f32_16x16x32_bf16 v[128:131], v[84:87], a[88:91], v[128:131]
    ds_read_b64_tr_b16 v[48:49], v2 offset:64
    ds_read_b64_tr_b16 v[50:51], v2 offset:3648
    v_mfma_f32_16x16x32_bf16 v[136:139], v[84:87], a[92:95], v[136:139]
    buffer_load_dwordx4 a[124:127], v7, s[8:11], s23 offen offset:1024 sc1
    ds_read_b64_tr_b16 v[52:53], v2 offset:7232
    s_add_u32 s23, s23, 2048
    v_mfma_f32_16x16x32_bf16 v[136:139], v[80:83], a[84:87], v[136:139]
    ds_read_b64_tr_b16 v[54:55], v2 offset:10816
    s_waitcnt lgkmcnt(12)
    v_mfma_f32_16x16x32_bf16 v[132:135], v[88:91], a[80:83], v[132:135]
    ds_read_b64_tr_b16 v[56:57], v2 offset:14400
    v_mfma_f32_16x16x32_bf16 v[132:135], v[92:95], a[88:91], v[132:135]
    ds_read_b64_tr_b16 v[58:59], v2 offset:17984
    s_add_u32 m0, s22, 32768
    v_mfma_f32_16x16x32_bf16 v[140:143], v[92:95], a[92:95], v[140:143]
    buffer_load_dwordx4 v13, s[40:43], s20 offen offset:0 lds
    ds_read_b64_tr_b16 v[60:61], v2 offset:21568
    ds_read_b64_tr_b16 v[62:63], v2 offset:25152
    v_mfma_f32_16x16x32_bf16 v[140:143], v[88:91], a[84:87], v[140:143]
    ds_read_b64_tr_b16 v[64:65], v2 offset:96
    s_waitcnt lgkmcnt(13)
    v_mfma_f32_16x16x32_bf16 v[144:147], v[32:35], a[80:83], v[144:147]
    ds_read_b64_tr_b16 v[66:67], v2 offset:3680
    v_mfma_f32_16x16x32_bf16 v[144:147], v[36:39], a[88:91], v[144:147]
    ds_read_b64_tr_b16 v[68:69], v2 offset:7264
    v_mfma_f32_16x16x32_bf16 v[152:155], v[36:39], a[92:95], v[152:155]
    buffer_load_dwordx4 v14, s[40:43], s20 offen offset:1024 lds
    ds_read_b64_tr_b16 v[70:71], v2 offset:10848
    v_mfma_f32_16x16x32_bf16 v[152:155], v[32:35], a[84:87], v[152:155]
    ds_read_b64_tr_b16 v[72:73], v2 offset:14432
    ds_read_b64_tr_b16 v[74:75], v2 offset:18016
    s_waitcnt lgkmcnt(14)
    v_mfma_f32_16x16x32_bf16 v[148:151], v[40:43], a[80:83], v[148:151]
    ds_read_b64_tr_b16 v[76:77], v2 offset:21600
    v_mfma_f32_16x16x32_bf16 v[148:151], v[44:47], a[88:91], v[148:151]
    ds_read_b64_tr_b16 v[78:79], v2 offset:25184
    v_mfma_f32_16x16x32_bf16 v[156:159], v[44:47], a[92:95], v[156:159]
    ds_read_b64_tr_b16 v[80:81], v2 offset:128
    v_mfma_f32_16x16x32_bf16 v[156:159], v[40:43], a[84:87], v[156:159]
    buffer_load_dwordx4 v15, s[40:43], s20 offen offset:2048 lds
    ds_read_b64_tr_b16 v[82:83], v2 offset:3712
    ds_read_b64_tr_b16 v[84:85], v2 offset:7296
    s_waitcnt lgkmcnt(15)
    v_mfma_f32_16x16x32_bf16 v[160:163], v[48:51], a[80:83], v[160:163]
    ds_read_b64_tr_b16 v[86:87], v2 offset:10880
    v_mfma_f32_16x16x32_bf16 v[160:163], v[52:55], a[88:91], v[160:163]
    ds_read_b64_tr_b16 v[88:89], v2 offset:14464
    v_mfma_f32_16x16x32_bf16 v[168:171], v[52:55], a[92:95], v[168:171]
    ds_read_b64_tr_b16 v[90:91], v2 offset:18048
    v_mfma_f32_16x16x32_bf16 v[168:171], v[48:51], a[84:87], v[168:171]
    buffer_load_dwordx4 v16, s[40:43], s20 offen offset:3072 lds
    ds_read_b64_tr_b16 v[92:93], v2 offset:21632
    s_waitcnt lgkmcnt(15)
    v_mfma_f32_16x16x32_bf16 v[164:167], v[56:59], a[80:83], v[164:167]
    ds_read_b64_tr_b16 v[94:95], v2 offset:25216
    ds_read_b64_tr_b16 v[32:33], v2 offset:160
    v_mfma_f32_16x16x32_bf16 v[164:167], v[60:63], a[88:91], v[164:167]
    ds_read_b64_tr_b16 v[34:35], v2 offset:3744
    v_mfma_f32_16x16x32_bf16 v[172:175], v[60:63], a[92:95], v[172:175]
    ds_read_b64_tr_b16 v[36:37], v2 offset:7328
    s_add_u32 m0, s22, 36864
    v_mfma_f32_16x16x32_bf16 v[172:175], v[56:59], a[84:87], v[172:175]
    buffer_load_dwordx4 v13, s[40:43], s21 offen offset:0 lds
    ds_read_b64_tr_b16 v[38:39], v2 offset:10912
    s_waitcnt lgkmcnt(15)
    v_mfma_f32_16x16x32_bf16 v[176:179], v[64:67], a[80:83], v[176:179]
    ds_read_b64_tr_b16 v[40:41], v2 offset:14496
    ds_read_b64_tr_b16 v[42:43], v2 offset:18080
    v_mfma_f32_16x16x32_bf16 v[176:179], v[68:71], a[88:91], v[176:179]
    ds_read_b64_tr_b16 v[44:45], v2 offset:21664
    v_mfma_f32_16x16x32_bf16 v[184:187], v[68:71], a[92:95], v[184:187]
    ds_read_b64_tr_b16 v[46:47], v2 offset:25248
    v_mfma_f32_16x16x32_bf16 v[184:187], v[64:67], a[84:87], v[184:187]
    ds_read_b64_tr_b16 v[48:49], v2 offset:192
    s_waitcnt lgkmcnt(15)
    v_mfma_f32_16x16x32_bf16 v[180:183], v[72:75], a[80:83], v[180:183]
    buffer_load_dwordx4 v14, s[40:43], s21 offen offset:1024 lds
    ds_read_b64_tr_b16 v[50:51], v2 offset:3776
    v_mfma_f32_16x16x32_bf16 v[180:183], v[76:79], a[88:91], v[180:183]
    ds_read_b64_tr_b16 v[52:53], v2 offset:7360
    ds_read_b64_tr_b16 v[54:55], v2 offset:10944
    v_mfma_f32_16x16x32_bf16 v[188:191], v[76:79], a[92:95], v[188:191]
    ds_read_b64_tr_b16 v[56:57], v2 offset:14528
    v_mfma_f32_16x16x32_bf16 v[188:191], v[72:75], a[84:87], v[188:191]
    ds_read_b64_tr_b16 v[58:59], v2 offset:18112
    s_waitcnt lgkmcnt(15)
    v_mfma_f32_16x16x32_bf16 v[192:195], v[80:83], a[80:83], v[192:195]
    buffer_load_dwordx4 v15, s[40:43], s21 offen offset:2048 lds
    ds_read_b64_tr_b16 v[60:61], v2 offset:21696
    v_mfma_f32_16x16x32_bf16 v[192:195], v[84:87], a[88:91], v[192:195]
    ds_read_b64_tr_b16 v[62:63], v2 offset:25280
    v_mfma_f32_16x16x32_bf16 v[200:203], v[84:87], a[92:95], v[200:203]
    v_mfma_f32_16x16x32_bf16 v[200:203], v[80:83], a[84:87], v[200:203]
    s_waitcnt lgkmcnt(15)
    v_mfma_f32_16x16x32_bf16 v[196:199], v[88:91], a[80:83], v[196:199]
    buffer_load_dwordx4 v16, s[40:43], s21 offen offset:3072 lds
    s_add_u32 s20, s20, 65536
    s_add_u32 s21, s21, 65536
    v_mfma_f32_16x16x32_bf16 v[196:199], v[92:95], a[88:91], v[196:199]
    v_mfma_f32_16x16x32_bf16 v[204:207], v[92:95], a[92:95], v[204:207]
    v_mfma_f32_16x16x32_bf16 v[204:207], v[88:91], a[84:87], v[204:207]
    s_waitcnt lgkmcnt(12)
    v_mfma_f32_16x16x32_bf16 v[208:211], v[32:35], a[80:83], v[208:211]
    v_mfma_f32_16x16x32_bf16 v[208:211], v[36:39], a[88:91], v[208:211]
    v_mfma_f32_16x16x32_bf16 v[216:219], v[36:39], a[92:95], v[216:219]
    v_mfma_f32_16x16x32_bf16 v[216:219], v[32:35], a[84:87], v[216:219]
    s_waitcnt lgkmcnt(0)
    s_waitcnt vmcnt(23)
    s_barrier
    v_mfma_f32_16x16x32_bf16 v[212:215], v[40:43], a[80:83], v[212:215]
    ds_read_b64_tr_b16 v[64:65], v1 offset:0
    ds_read_b64_tr_b16 v[66:67], v1 offset:3584
    s_add_u32 m0, s22, 65536
    v_mfma_f32_16x16x32_bf16 v[212:215], v[44:47], a[88:91], v[212:215]
    buffer_load_dwordx4 v13, s[40:43], s20 offen offset:0 lds
    ds_read_b64_tr_b16 v[68:69], v1 offset:7168
    v_mfma_f32_16x16x32_bf16 v[220:223], v[44:47], a[92:95], v[220:223]
    ds_read_b64_tr_b16 v[70:71], v1 offset:10752
    v_mfma_f32_16x16x32_bf16 v[220:223], v[40:43], a[84:87], v[220:223]
    ds_read_b64_tr_b16 v[72:73], v1 offset:14336
    v_mfma_f32_16x16x32_bf16 v[224:227], v[48:51], a[80:83], v[224:227]
    ds_read_b64_tr_b16 v[74:75], v1 offset:17920
    ds_read_b64_tr_b16 v[76:77], v1 offset:21504
    v_mfma_f32_16x16x32_bf16 v[224:227], v[52:55], a[88:91], v[224:227]
    ds_read_b64_tr_b16 v[78:79], v1 offset:25088
    v_mfma_f32_16x16x32_bf16 v[232:235], v[52:55], a[92:95], v[232:235]
    ds_read_b64_tr_b16 v[80:81], v1 offset:32
    v_mfma_f32_16x16x32_bf16 v[232:235], v[48:51], a[84:87], v[232:235]
    buffer_load_dwordx4 v14, s[40:43], s20 offen offset:1024 lds
    ds_read_b64_tr_b16 v[82:83], v1 offset:3616
    v_mfma_f32_16x16x32_bf16 v[228:231], v[56:59], a[80:83], v[228:231]
    ds_read_b64_tr_b16 v[84:85], v1 offset:7200
    v_mfma_f32_16x16x32_bf16 v[228:231], v[60:63], a[88:91], v[228:231]
    ds_read_b64_tr_b16 v[86:87], v1 offset:10784
    ds_read_b64_tr_b16 v[88:89], v1 offset:14368
    v_mfma_f32_16x16x32_bf16 v[236:239], v[60:63], a[92:95], v[236:239]
    ds_read_b64_tr_b16 v[90:91], v1 offset:17952
    v_mfma_f32_16x16x32_bf16 v[236:239], v[56:59], a[84:87], v[236:239]
    ds_read_b64_tr_b16 v[92:93], v1 offset:21536
    s_waitcnt vmcnt(21) lgkmcnt(11)
    v_mfma_f32_16x16x32_bf16 v[128:131], v[64:67], a[96:99], v[128:131]
    ds_read_b64_tr_b16 v[94:95], v1 offset:25120
    v_mfma_f32_16x16x32_bf16 v[128:131], v[68:71], a[104:107], v[128:131]
    buffer_load_dwordx4 v15, s[40:43], s20 offen offset:2048 lds
    ds_read_b64_tr_b16 v[32:33], v1 offset:64
    ds_read_b64_tr_b16 v[34:35], v1 offset:3648
    v_mfma_f32_16x16x32_bf16 v[136:139], v[68:71], a[108:111], v[136:139]
    ds_read_b64_tr_b16 v[36:37], v1 offset:7232
    v_mfma_f32_16x16x32_bf16 v[136:139], v[64:67], a[100:103], v[136:139]
    ds_read_b64_tr_b16 v[38:39], v1 offset:10816
    s_waitcnt lgkmcnt(12)
    v_mfma_f32_16x16x32_bf16 v[132:135], v[72:75], a[96:99], v[132:135]
    ds_read_b64_tr_b16 v[40:41], v1 offset:14400
    v_mfma_f32_16x16x32_bf16 v[132:135], v[76:79], a[104:107], v[132:135]
    ds_read_b64_tr_b16 v[42:43], v1 offset:17984
    v_mfma_f32_16x16x32_bf16 v[140:143], v[76:79], a[108:111], v[140:143]
    ds_read_b64_tr_b16 v[44:45], v1 offset:21568
    ds_read_b64_tr_b16 v[46:47], v1 offset:25152
    v_mfma_f32_16x16x32_bf16 v[140:143], v[72:75], a[100:103], v[140:143]
    buffer_load_dwordx4 v16, s[40:43], s20 offen offset:3072 lds
    ds_read_b64_tr_b16 v[48:49], v1 offset:96
    s_waitcnt lgkmcnt(13)
    v_mfma_f32_16x16x32_bf16 v[144:147], v[80:83], a[96:99], v[144:147]
    ds_read_b64_tr_b16 v[50:51], v1 offset:3680
    v_mfma_f32_16x16x32_bf16 v[144:147], v[84:87], a[104:107], v[144:147]
    ds_read_b64_tr_b16 v[52:53], v1 offset:7264
    v_mfma_f32_16x16x32_bf16 v[152:155], v[84:87], a[108:111], v[152:155]
    ds_read_b64_tr_b16 v[54:55], v1 offset:10848
    v_mfma_f32_16x16x32_bf16 v[152:155], v[80:83], a[100:103], v[152:155]
    ds_read_b64_tr_b16 v[56:57], v1 offset:14432
    ds_read_b64_tr_b16 v[58:59], v1 offset:18016
    s_waitcnt lgkmcnt(14)
    v_mfma_f32_16x16x32_bf16 v[148:151], v[88:91], a[96:99], v[148:151]
    ds_read_b64_tr_b16 v[60:61], v1 offset:21600
    s_add_u32 m0, s22, 69632
    v_mfma_f32_16x16x32_bf16 v[148:151], v[92:95], a[104:107], v[148:151]
    buffer_load_dwordx4 v13, s[40:43], s21 offen offset:0 lds
    ds_read_b64_tr_b16 v[62:63], v1 offset:25184
    v_mfma_f32_16x16x32_bf16 v[156:159], v[92:95], a[108:111], v[156:159]
    ds_read_b64_tr_b16 v[64:65], v1 offset:128
    v_mfma_f32_16x16x32_bf16 v[156:159], v[88:91], a[100:103], v[156:159]
    ds_read_b64_tr_b16 v[66:67], v1 offset:3712
    ds_read_b64_tr_b16 v[68:69], v1 offset:7296
    s_waitcnt lgkmcnt(15)
    v_mfma_f32_16x16x32_bf16 v[160:163], v[32:35], a[96:99], v[160:163]
    ds_read_b64_tr_b16 v[70:71], v1 offset:10880
    v_mfma_f32_16x16x32_bf16 v[160:163], v[36:39], a[104:107], v[160:163]
    ds_read_b64_tr_b16 v[72:73], v1 offset:14464
    v_mfma_f32_16x16x32_bf16 v[168:171], v[36:39], a[108:111], v[168:171]
    ds_read_b64_tr_b16 v[74:75], v1 offset:18048
    v_mfma_f32_16x16x32_bf16 v[168:171], v[32:35], a[100:103], v[168:171]
    buffer_load_dwordx4 v14, s[40:43], s21 offen offset:1024 lds
    ds_read_b64_tr_b16 v[76:77], v1 offset:21632
    s_waitcnt lgkmcnt(15)
    v_mfma_f32_16x16x32_bf16 v[164:167], v[40:43], a[96:99], v[164:167]
    ds_read_b64_tr_b16 v[78:79], v1 offset:25216
    ds_read_b64_tr_b16 v[80:81], v1 offset:160
    v_mfma_f32_16x16x32_bf16 v[164:167], v[44:47], a[104:107], v[164:167]
    ds_read_b64_tr_b16 v[82:83], v1 offset:3744
    v_mfma_f32_16x16x32_bf16 v[172:175], v[44:47], a[108:111], v[172:175]
    ds_read_b64_tr_b16 v[84:85], v1 offset:7328
    v_mfma_f32_16x16x32_bf16 v[172:175], v[40:43], a[100:103], v[172:175]
    ds_read_b64_tr_b16 v[86:87], v1 offset:10912
    s_waitcnt lgkmcnt(15)
    v_mfma_f32_16x16x32_bf16 v[176:179], v[48:51], a[96:99], v[176:179]
    ds_read_b64_tr_b16 v[88:89], v1 offset:14496
    ds_read_b64_tr_b16 v[90:91], v1 offset:18080
    v_mfma_f32_16x16x32_bf16 v[176:179], v[52:55], a[104:107], v[176:179]
    buffer_load_dwordx4 v15, s[40:43], s21 offen offset:2048 lds
    ds_read_b64_tr_b16 v[92:93], v1 offset:21664
    v_mfma_f32_16x16x32_bf16 v[184:187], v[52:55], a[108:111], v[184:187]
    ds_read_b64_tr_b16 v[94:95], v1 offset:25248
    v_mfma_f32_16x16x32_bf16 v[184:187], v[48:51], a[100:103], v[184:187]
    ds_read_b64_tr_b16 v[32:33], v1 offset:192
    s_waitcnt lgkmcnt(15)
    v_mfma_f32_16x16x32_bf16 v[180:183], v[56:59], a[96:99], v[180:183]
    ds_read_b64_tr_b16 v[34:35], v1 offset:3776
    v_mfma_f32_16x16x32_bf16 v[180:183], v[60:63], a[104:107], v[180:183]
    ds_read_b64_tr_b16 v[36:37], v1 offset:7360
    ds_read_b64_tr_b16 v[38:39], v1 offset:10944
    v_mfma_f32_16x16x32_bf16 v[188:191], v[60:63], a[108:111], v[188:191]
    ds_read_b64_tr_b16 v[40:41], v1 offset:14528
    v_mfma_f32_16x16x32_bf16 v[188:191], v[56:59], a[100:103], v[188:191]
    buffer_load_dwordx4 v16, s[40:43], s21 offen offset:3072 lds
    ds_read_b64_tr_b16 v[42:43], v1 offset:18112
    s_add_u32 s20, s20, 65536
    s_add_u32 s21, s21, 65536
    s_waitcnt lgkmcnt(15)
    v_mfma_f32_16x16x32_bf16 v[192:195], v[64:67], a[96:99], v[192:195]
    ds_read_b64_tr_b16 v[44:45], v1 offset:21696
    v_mfma_f32_16x16x32_bf16 v[192:195], v[68:71], a[104:107], v[192:195]
    ds_read_b64_tr_b16 v[46:47], v1 offset:25280
    v_mfma_f32_16x16x32_bf16 v[200:203], v[68:71], a[108:111], v[200:203]
    v_mfma_f32_16x16x32_bf16 v[200:203], v[64:67], a[100:103], v[200:203]
    s_waitcnt lgkmcnt(15)
    v_mfma_f32_16x16x32_bf16 v[196:199], v[72:75], a[96:99], v[196:199]
    v_mfma_f32_16x16x32_bf16 v[196:199], v[76:79], a[104:107], v[196:199]
    v_mfma_f32_16x16x32_bf16 v[204:207], v[76:79], a[108:111], v[204:207]
    v_mfma_f32_16x16x32_bf16 v[204:207], v[72:75], a[100:103], v[204:207]
    s_waitcnt lgkmcnt(12)
    v_mfma_f32_16x16x32_bf16 v[208:211], v[80:83], a[96:99], v[208:211]
    v_mfma_f32_16x16x32_bf16 v[208:211], v[84:87], a[104:107], v[208:211]
    v_mfma_f32_16x16x32_bf16 v[216:219], v[84:87], a[108:111], v[216:219]
    v_mfma_f32_16x16x32_bf16 v[216:219], v[80:83], a[100:103], v[216:219]
    s_waitcnt lgkmcnt(0)
    s_waitcnt vmcnt(20)
    s_barrier
    v_mfma_f32_16x16x32_bf16 v[212:215], v[88:91], a[96:99], v[212:215]
    ds_read_b64_tr_b16 v[48:49], v3 offset:0
    ds_read_b64_tr_b16 v[50:51], v3 offset:3584
    s_add_u32 m0, s22, 0
    v_mfma_f32_16x16x32_bf16 v[212:215], v[92:95], a[104:107], v[212:215]
    buffer_load_dwordx4 v13, s[40:43], s20 offen offset:0 lds
    ds_read_b64_tr_b16 v[52:53], v3 offset:7168
    v_mfma_f32_16x16x32_bf16 v[220:223], v[92:95], a[108:111], v[220:223]
    ds_read_b64_tr_b16 v[54:55], v3 offset:10752
    v_mfma_f32_16x16x32_bf16 v[220:223], v[88:91], a[100:103], v[220:223]
    ds_read_b64_tr_b16 v[56:57], v3 offset:14336
    v_mfma_f32_16x16x32_bf16 v[224:227], v[32:35], a[96:99], v[224:227]
    ds_read_b64_tr_b16 v[58:59], v3 offset:17920
    ds_read_b64_tr_b16 v[60:61], v3 offset:21504
    v_mfma_f32_16x16x32_bf16 v[224:227], v[36:39], a[104:107], v[224:227]
    ds_read_b64_tr_b16 v[62:63], v3 offset:25088
    v_mfma_f32_16x16x32_bf16 v[232:235], v[36:39], a[108:111], v[232:235]
    ds_read_b64_tr_b16 v[64:65], v3 offset:32
    v_mfma_f32_16x16x32_bf16 v[232:235], v[32:35], a[100:103], v[232:235]
    buffer_load_dwordx4 v14, s[40:43], s20 offen offset:1024 lds
    ds_read_b64_tr_b16 v[66:67], v3 offset:3616
    v_mfma_f32_16x16x32_bf16 v[228:231], v[40:43], a[96:99], v[228:231]
    ds_read_b64_tr_b16 v[68:69], v3 offset:7200
    v_mfma_f32_16x16x32_bf16 v[228:231], v[44:47], a[104:107], v[228:231]
    ds_read_b64_tr_b16 v[70:71], v3 offset:10784
    ds_read_b64_tr_b16 v[72:73], v3 offset:14368
    v_mfma_f32_16x16x32_bf16 v[236:239], v[44:47], a[108:111], v[236:239]
    ds_read_b64_tr_b16 v[74:75], v3 offset:17952
    v_mfma_f32_16x16x32_bf16 v[236:239], v[40:43], a[100:103], v[236:239]
    ds_read_b64_tr_b16 v[76:77], v3 offset:21536
    s_waitcnt vmcnt(18) lgkmcnt(11)
    v_mfma_f32_16x16x32_bf16 v[128:131], v[48:51], a[112:115], v[128:131]
    ds_read_b64_tr_b16 v[78:79], v3 offset:25120
    v_mfma_f32_16x16x32_bf16 v[128:131], v[52:55], a[120:123], v[128:131]
    buffer_load_dwordx4 v15, s[40:43], s20 offen offset:2048 lds
    ds_read_b64_tr_b16 v[80:81], v3 offset:64
    ds_read_b64_tr_b16 v[82:83], v3 offset:3648
    v_mfma_f32_16x16x32_bf16 v[136:139], v[52:55], a[124:127], v[136:139]
    ds_read_b64_tr_b16 v[84:85], v3 offset:7232
    v_mfma_f32_16x16x32_bf16 v[136:139], v[48:51], a[116:119], v[136:139]
    ds_read_b64_tr_b16 v[86:87], v3 offset:10816
    s_waitcnt lgkmcnt(12)
    v_mfma_f32_16x16x32_bf16 v[132:135], v[56:59], a[112:115], v[132:135]
    ds_read_b64_tr_b16 v[88:89], v3 offset:14400
    v_mfma_f32_16x16x32_bf16 v[132:135], v[60:63], a[120:123], v[132:135]
    ds_read_b64_tr_b16 v[90:91], v3 offset:17984
    v_mfma_f32_16x16x32_bf16 v[140:143], v[60:63], a[124:127], v[140:143]
    ds_read_b64_tr_b16 v[92:93], v3 offset:21568
    ds_read_b64_tr_b16 v[94:95], v3 offset:25152
    v_mfma_f32_16x16x32_bf16 v[140:143], v[56:59], a[116:119], v[140:143]
    buffer_load_dwordx4 v16, s[40:43], s20 offen offset:3072 lds
    ds_read_b64_tr_b16 v[32:33], v3 offset:96
    s_waitcnt lgkmcnt(13)
    v_mfma_f32_16x16x32_bf16 v[144:147], v[64:67], a[112:115], v[144:147]
    ds_read_b64_tr_b16 v[34:35], v3 offset:3680
    v_mfma_f32_16x16x32_bf16 v[144:147], v[68:71], a[120:123], v[144:147]
    ds_read_b64_tr_b16 v[36:37], v3 offset:7264
    v_mfma_f32_16x16x32_bf16 v[152:155], v[68:71], a[124:127], v[152:155]
    ds_read_b64_tr_b16 v[38:39], v3 offset:10848
    v_mfma_f32_16x16x32_bf16 v[152:155], v[64:67], a[116:119], v[152:155]
    ds_read_b64_tr_b16 v[40:41], v3 offset:14432
    ds_read_b64_tr_b16 v[42:43], v3 offset:18016
    s_waitcnt lgkmcnt(14)
    v_mfma_f32_16x16x32_bf16 v[148:151], v[72:75], a[112:115], v[148:151]
    ds_read_b64_tr_b16 v[44:45], v3 offset:21600
    s_add_u32 m0, s22, 4096
    v_mfma_f32_16x16x32_bf16 v[148:151], v[76:79], a[120:123], v[148:151]
    buffer_load_dwordx4 v13, s[40:43], s21 offen offset:0 lds
    ds_read_b64_tr_b16 v[46:47], v3 offset:25184
    v_mfma_f32_16x16x32_bf16 v[156:159], v[76:79], a[124:127], v[156:159]
    ds_read_b64_tr_b16 v[48:49], v3 offset:128
    v_mfma_f32_16x16x32_bf16 v[156:159], v[72:75], a[116:119], v[156:159]
    ds_read_b64_tr_b16 v[50:51], v3 offset:3712
    ds_read_b64_tr_b16 v[52:53], v3 offset:7296
    s_waitcnt lgkmcnt(15)
    v_mfma_f32_16x16x32_bf16 v[160:163], v[80:83], a[112:115], v[160:163]
    ds_read_b64_tr_b16 v[54:55], v3 offset:10880
    v_mfma_f32_16x16x32_bf16 v[160:163], v[84:87], a[120:123], v[160:163]
    ds_read_b64_tr_b16 v[56:57], v3 offset:14464
    v_mfma_f32_16x16x32_bf16 v[168:171], v[84:87], a[124:127], v[168:171]
    ds_read_b64_tr_b16 v[58:59], v3 offset:18048
    v_mfma_f32_16x16x32_bf16 v[168:171], v[80:83], a[116:119], v[168:171]
    buffer_load_dwordx4 v14, s[40:43], s21 offen offset:1024 lds
    ds_read_b64_tr_b16 v[60:61], v3 offset:21632
    s_waitcnt lgkmcnt(15)
    v_mfma_f32_16x16x32_bf16 v[164:167], v[88:91], a[112:115], v[164:167]
    ds_read_b64_tr_b16 v[62:63], v3 offset:25216
    ds_read_b64_tr_b16 v[64:65], v3 offset:160
    v_mfma_f32_16x16x32_bf16 v[164:167], v[92:95], a[120:123], v[164:167]
    ds_read_b64_tr_b16 v[66:67], v3 offset:3744
    v_mfma_f32_16x16x32_bf16 v[172:175], v[92:95], a[124:127], v[172:175]
    ds_read_b64_tr_b16 v[68:69], v3 offset:7328
    v_mfma_f32_16x16x32_bf16 v[172:175], v[88:91], a[116:119], v[172:175]
    ds_read_b64_tr_b16 v[70:71], v3 offset:10912
    s_waitcnt lgkmcnt(15)
    v_mfma_f32_16x16x32_bf16 v[176:179], v[32:35], a[112:115], v[176:179]
    ds_read_b64_tr_b16 v[72:73], v3 offset:14496
    ds_read_b64_tr_b16 v[74:75], v3 offset:18080
    v_mfma_f32_16x16x32_bf16 v[176:179], v[36:39], a[120:123], v[176:179]
    buffer_load_dwordx4 v15, s[40:43], s21 offen offset:2048 lds
    ds_read_b64_tr_b16 v[76:77], v3 offset:21664
    v_mfma_f32_16x16x32_bf16 v[184:187], v[36:39], a[124:127], v[184:187]
    ds_read_b64_tr_b16 v[78:79], v3 offset:25248
    v_mfma_f32_16x16x32_bf16 v[184:187], v[32:35], a[116:119], v[184:187]
    ds_read_b64_tr_b16 v[80:81], v3 offset:192
    s_waitcnt lgkmcnt(15)
    v_mfma_f32_16x16x32_bf16 v[180:183], v[40:43], a[112:115], v[180:183]
    ds_read_b64_tr_b16 v[82:83], v3 offset:3776
    v_mfma_f32_16x16x32_bf16 v[180:183], v[44:47], a[120:123], v[180:183]
    ds_read_b64_tr_b16 v[84:85], v3 offset:7360
    ds_read_b64_tr_b16 v[86:87], v3 offset:10944
    v_mfma_f32_16x16x32_bf16 v[188:191], v[44:47], a[124:127], v[188:191]
    ds_read_b64_tr_b16 v[88:89], v3 offset:14528
    v_mfma_f32_16x16x32_bf16 v[188:191], v[40:43], a[116:119], v[188:191]
    buffer_load_dwordx4 v16, s[40:43], s21 offen offset:3072 lds
    ds_read_b64_tr_b16 v[90:91], v3 offset:18112
    s_add_u32 s20, s20, 65536
    s_add_u32 s21, s21, 65536
    s_waitcnt lgkmcnt(15)
    v_mfma_f32_16x16x32_bf16 v[192:195], v[48:51], a[112:115], v[192:195]
    ds_read_b64_tr_b16 v[92:93], v3 offset:21696
    v_mfma_f32_16x16x32_bf16 v[192:195], v[52:55], a[120:123], v[192:195]
    ds_read_b64_tr_b16 v[94:95], v3 offset:25280
    v_mfma_f32_16x16x32_bf16 v[200:203], v[52:55], a[124:127], v[200:203]
    v_mfma_f32_16x16x32_bf16 v[200:203], v[48:51], a[116:119], v[200:203]
    s_waitcnt lgkmcnt(15)
    v_mfma_f32_16x16x32_bf16 v[196:199], v[56:59], a[112:115], v[196:199]
    v_mfma_f32_16x16x32_bf16 v[196:199], v[60:63], a[120:123], v[196:199]
    v_mfma_f32_16x16x32_bf16 v[204:207], v[60:63], a[124:127], v[204:207]
    v_mfma_f32_16x16x32_bf16 v[204:207], v[56:59], a[116:119], v[204:207]
    s_waitcnt lgkmcnt(12)
    v_mfma_f32_16x16x32_bf16 v[208:211], v[64:67], a[112:115], v[208:211]
    v_mfma_f32_16x16x32_bf16 v[208:211], v[68:71], a[120:123], v[208:211]
    v_mfma_f32_16x16x32_bf16 v[216:219], v[68:71], a[124:127], v[216:219]
    v_mfma_f32_16x16x32_bf16 v[216:219], v[64:67], a[116:119], v[216:219]
    s_waitcnt lgkmcnt(8)
    v_mfma_f32_16x16x32_bf16 v[212:215], v[72:75], a[112:115], v[212:215]
    v_mfma_f32_16x16x32_bf16 v[212:215], v[76:79], a[120:123], v[212:215]
    v_mfma_f32_16x16x32_bf16 v[220:223], v[76:79], a[124:127], v[220:223]
    v_mfma_f32_16x16x32_bf16 v[220:223], v[72:75], a[116:119], v[220:223]
    s_waitcnt lgkmcnt(4)
    v_mfma_f32_16x16x32_bf16 v[224:227], v[80:83], a[112:115], v[224:227]
    v_mfma_f32_16x16x32_bf16 v[224:227], v[84:87], a[120:123], v[224:227]
    v_mfma_f32_16x16x32_bf16 v[232:235], v[84:87], a[124:127], v[232:235]
    v_mfma_f32_16x16x32_bf16 v[232:235], v[80:83], a[116:119], v[232:235]
    s_waitcnt lgkmcnt(0)
    v_mfma_f32_16x16x32_bf16 v[228:231], v[88:91], a[112:115], v[228:231]
    v_mfma_f32_16x16x32_bf16 v[228:231], v[92:95], a[120:123], v[228:231]
    v_mfma_f32_16x16x32_bf16 v[236:239], v[92:95], a[124:127], v[236:239]
    v_mfma_f32_16x16x32_bf16 v[236:239], v[88:91], a[116:119], v[236:239]
    v_pk_mul_f32 v[128:129], v[128:129], v[132:133]
    v_pk_mul_f32 v[130:131], v[130:131], v[134:135]
    v_cvt_pk_bf16_f32 v132, v128, v129
    v_cvt_pk_bf16_f32 v133, v130, v131
    buffer_store_dwordx2 v[132:133], v8, s[16:19], 0 offen offset:0
    v_pk_mul_f32 v[136:137], v[136:137], v[140:141]
    v_pk_mul_f32 v[138:139], v[138:139], v[142:143]
    v_cvt_pk_bf16_f32 v140, v136, v137
    v_cvt_pk_bf16_f32 v141, v138, v139
    buffer_store_dwordx2 v[140:141], v8, s[16:19], 0 offen offset:512
    v_pk_mul_f32 v[144:145], v[144:145], v[148:149]
    v_pk_mul_f32 v[146:147], v[146:147], v[150:151]
    v_cvt_pk_bf16_f32 v148, v144, v145
    v_cvt_pk_bf16_f32 v149, v146, v147
    buffer_store_dwordx2 v[148:149], v8, s[16:19], 0 offen offset:1024
    v_pk_mul_f32 v[152:153], v[152:153], v[156:157]
    v_pk_mul_f32 v[154:155], v[154:155], v[158:159]
    v_cvt_pk_bf16_f32 v156, v152, v153
    v_cvt_pk_bf16_f32 v157, v154, v155
    buffer_store_dwordx2 v[156:157], v8, s[16:19], 0 offen offset:1536
    v_pk_mul_f32 v[160:161], v[160:161], v[164:165]
    v_pk_mul_f32 v[162:163], v[162:163], v[166:167]
    v_cvt_pk_bf16_f32 v164, v160, v161
    v_cvt_pk_bf16_f32 v165, v162, v163
    buffer_store_dwordx2 v[164:165], v8, s[16:19], 0 offen offset:2048
    v_pk_mul_f32 v[168:169], v[168:169], v[172:173]
    v_pk_mul_f32 v[170:171], v[170:171], v[174:175]
    v_cvt_pk_bf16_f32 v172, v168, v169
    v_cvt_pk_bf16_f32 v173, v170, v171
    buffer_store_dwordx2 v[172:173], v8, s[16:19], 0 offen offset:2560
    v_pk_mul_f32 v[176:177], v[176:177], v[180:181]
    v_pk_mul_f32 v[178:179], v[178:179], v[182:183]
    v_cvt_pk_bf16_f32 v180, v176, v177
    v_cvt_pk_bf16_f32 v181, v178, v179
    buffer_store_dwordx2 v[180:181], v8, s[16:19], 0 offen offset:3072
    v_pk_mul_f32 v[184:185], v[184:185], v[188:189]
    v_pk_mul_f32 v[186:187], v[186:187], v[190:191]
    v_cvt_pk_bf16_f32 v188, v184, v185
    v_cvt_pk_bf16_f32 v189, v186, v187
    buffer_store_dwordx2 v[188:189], v8, s[16:19], 0 offen offset:3584
    v_pk_mul_f32 v[192:193], v[192:193], v[196:197]
    v_pk_mul_f32 v[194:195], v[194:195], v[198:199]
    v_cvt_pk_bf16_f32 v196, v192, v193
    v_cvt_pk_bf16_f32 v197, v194, v195
    buffer_store_dwordx2 v[196:197], v9, s[16:19], 0 offen offset:0
    v_pk_mul_f32 v[200:201], v[200:201], v[204:205]
    v_pk_mul_f32 v[202:203], v[202:203], v[206:207]
    v_cvt_pk_bf16_f32 v204, v200, v201
    v_cvt_pk_bf16_f32 v205, v202, v203
    buffer_store_dwordx2 v[204:205], v9, s[16:19], 0 offen offset:512
    v_pk_mul_f32 v[208:209], v[208:209], v[212:213]
    v_pk_mul_f32 v[210:211], v[210:211], v[214:215]
    v_cvt_pk_bf16_f32 v212, v208, v209
    v_cvt_pk_bf16_f32 v213, v210, v211
    buffer_store_dwordx2 v[212:213], v9, s[16:19], 0 offen offset:1024
    v_pk_mul_f32 v[216:217], v[216:217], v[220:221]
    v_pk_mul_f32 v[218:219], v[218:219], v[222:223]
    v_cvt_pk_bf16_f32 v220, v216, v217
    v_cvt_pk_bf16_f32 v221, v218, v219
    buffer_store_dwordx2 v[220:221], v9, s[16:19], 0 offen offset:1536
    v_pk_mul_f32 v[224:225], v[224:225], v[228:229]
    v_pk_mul_f32 v[226:227], v[226:227], v[230:231]
    v_cvt_pk_bf16_f32 v228, v224, v225
    v_cvt_pk_bf16_f32 v229, v226, v227
    buffer_store_dwordx2 v[228:229], v9, s[16:19], 0 offen offset:2048
    v_pk_mul_f32 v[232:233], v[232:233], v[236:237]
    v_pk_mul_f32 v[234:235], v[234:235], v[238:239]
    v_cvt_pk_bf16_f32 v236, v232, v233
    v_cvt_pk_bf16_f32 v237, v234, v235
    buffer_store_dwordx2 v[236:237], v9, s[16:19], 0 offen offset:2560
    s_barrier
    s_add_u32 m0, s22, 131072
    s_nop 0
    buffer_load_dwordx4 v13, s[40:43], s20 offen offset:0 lds
    buffer_load_dwordx4 v14, s[40:43], s20 offen offset:1024 lds
    buffer_load_dwordx4 v15, s[40:43], s20 offen offset:2048 lds
    buffer_load_dwordx4 v16, s[40:43], s20 offen offset:3072 lds
    s_add_u32 m0, s22, 135168
    s_nop 0
    buffer_load_dwordx4 v13, s[40:43], s21 offen offset:0 lds
    buffer_load_dwordx4 v14, s[40:43], s21 offen offset:1024 lds
    buffer_load_dwordx4 v15, s[40:43], s21 offen offset:2048 lds
    buffer_load_dwordx4 v16, s[40:43], s21 offen offset:3072 lds
    s_add_u32 s20, s20, 65536
    s_add_u32 s21, s21, 65536
    s_waitcnt vmcnt(8)
    v_mov_b32 v127, s36
    s_cmp_lg_u32 s3, 0
    s_cbranch_scc1 L_sigl_d
    buffer_wbl2 sc1
    s_waitcnt vmcnt(0)
    s_mov_b64 exec, 1
    buffer_store_dword v127, off, s[52:55], s31 sc1
    s_branch L_sigd_d
L_sigl_d:
    s_mov_b64 exec, 1
    buffer_store_dword v127, off, s[52:55], s31
L_sigd_d:
    s_mov_b64 exec, -1
    s_mov_b32 s39, 0
L_poll_d:
    buffer_load_dword v126, v124, s[52:55], s30 offen sc1
    s_add_u32 s39, s39, 1
    s_waitcnt vmcnt(0)
    v_cmp_ne_u32 vcc, s36, v126
    s_cmp_ge_u32 s39, 0x40000
    s_cbranch_scc1 L_polled_d
    s_cbranch_vccnz L_poll_d
L_polled_d:
    s_cmp_lg_u32 s3, 0
    s_cbranch_scc1 L_acq_d
    buffer_inv sc1
    s_waitcnt vmcnt(0)
L_acq_d:
    buffer_load_dwordx4 a[0:3], v23, s[12:15], s44 offen offset:0 sc1
    buffer_load_dwordx4 a[4:7], v23, s[12:15], s45 offen offset:0 sc1
    buffer_load_dwordx4 a[8:11], v23, s[12:15], s44 offen offset:1024 sc1
    buffer_load_dwordx4 a[12:15], v23, s[12:15], s45 offen offset:1024 sc1
    buffer_load_dwordx4 a[16:19], v23, s[12:15], s44 offen offset:2048 sc1
    buffer_load_dwordx4 a[20:23], v23, s[12:15], s45 offen offset:2048 sc1
    buffer_load_dwordx4 a[24:27], v23, s[12:15], s44 offen offset:3072 sc1
    buffer_load_dwordx4 a[28:31], v23, s[12:15], s45 offen offset:3072 sc1
    s_add_u32 s44, s44, 4096
    s_add_u32 s45, s45, 4096
    buffer_load_dwordx4 a[32:35], v23, s[12:15], s44 offen offset:0 sc1
    buffer_load_dwordx4 a[36:39], v23, s[12:15], s45 offen offset:0 sc1
    buffer_load_dwordx4 a[40:43], v23, s[12:15], s44 offen offset:1024 sc1
    buffer_load_dwordx4 a[44:47], v23, s[12:15], s45 offen offset:1024 sc1
    buffer_load_dwordx4 a[48:51], v23, s[12:15], s44 offen offset:2048 sc1
    buffer_load_dwordx4 a[52:55], v23, s[12:15], s45 offen offset:2048 sc1
    buffer_load_dwordx4 a[56:59], v23, s[12:15], s44 offen offset:3072 sc1
    buffer_load_dwordx4 a[60:63], v23, s[12:15], s45 offen offset:3072 sc1
    s_add_u32 s44, s44, 4096
    s_add_u32 s45, s45, 4096
    buffer_load_dwordx4 a[64:67], v23, s[12:15], s44 offen offset:0 sc1
    buffer_load_dwordx4 a[68:71], v23, s[12:15], s45 offen offset:0 sc1
    buffer_load_dwordx4 a[72:75], v23, s[12:15], s44 offen offset:1024 sc1
    buffer_load_dwordx4 a[76:79], v23, s[12:15], s45 offen offset:1024 sc1
    buffer_load_dwordx4 a[80:83], v23, s[12:15], s44 offen offset:2048 sc1
    buffer_load_dwordx4 a[84:87], v23, s[12:15], s45 offen offset:2048 sc1
    buffer_load_dwordx4 a[88:91], v23, s[12:15], s44 offen offset:3072 sc1
    buffer_load_dwordx4 a[92:95], v23, s[12:15], s45 offen offset:3072 sc1
    s_add_u32 s44, s44, 4096
    s_add_u32 s45, s45, 4096
    buffer_load_dwordx4 a[96:99], v23, s[12:15], s44 offen offset:0 sc1
    buffer_load_dwordx4 a[100:103], v23, s[12:15], s45 offen offset:0 sc1
    buffer_load_dwordx4 a[104:107], v23, s[12:15], s44 offen offset:1024 sc1
    buffer_load_dwordx4 a[108:111], v23, s[12:15], s45 offen offset:1024 sc1
    buffer_load_dwordx4 a[112:115], v23, s[12:15], s44 offen offset:2048 sc1
    buffer_load_dwordx4 a[116:119], v23, s[12:15], s45 offen offset:2048 sc1
    buffer_load_dwordx4 a[120:123], v23, s[12:15], s44 offen offset:3072 sc1
    buffer_load_dwordx4 a[124:127], v23, s[12:15], s45 offen offset:3072 sc1
    s_add_u32 s44, s44, 4096
    s_add_u32 s45, s45, 4096
    ds_read_b64_tr_b16 v[192:193], v19 offset:32768
    ds_read_b64_tr_b16 v[194:195], v19 offset:33280
    ds_read_b64_tr_b16 v[196:197], v20 offset:32768
    ds_read_b64_tr_b16 v[198:199], v20 offset:33280
    ds_read_b64_tr_b16 v[200:201], v19 offset:34816
    ds_read_b64_tr_b16 v[202:203], v19 offset:35328
    ds_read_b64_tr_b16 v[204:205], v20 offset:34816
    ds_read_b64_tr_b16 v[206:207], v20 offset:35328
    s_waitcnt vmcnt(30) lgkmcnt(4)
    v_mfma_f32_32x32x16_bf16 v[128:143], v[192:195], a[0:3], 0
    ds_read_b64_tr_b16 v[208:209], v19 offset:36864
    v_mfma_f32_32x32x16_bf16 v[160:175], v[192:195], a[4:7], 0
    ds_read_b64_tr_b16 v[210:211], v19 offset:37376
    v_mfma_f32_32x32x16_bf16 v[176:191], v[196:199], a[4:7], 0
    ds_read_b64_tr_b16 v[212:213], v20 offset:36864
    v_mfma_f32_32x32x16_bf16 v[144:159], v[196:199], a[0:3], 0
    ds_read_b64_tr_b16 v[214:215], v20 offset:37376
    s_waitcnt vmcnt(28) lgkmcnt(4)
    v_mfma_f32_32x32x16_bf16 v[128:143], v[200:203], a[8:11], v[128:143]
    ds_read_b64_tr_b16 v[216:217], v19 offset:38912
    v_mfma_f32_32x32x16_bf16 v[160:175], v[200:203], a[12:15], v[160:175]
    ds_read_b64_tr_b16 v[218:219], v19 offset:39424
    v_mfma_f32_32x32x16_bf16 v[176:191], v[204:207], a[12:15], v[176:191]
    ds_read_b64_tr_b16 v[220:221], v20 offset:38912
    v_mfma_f32_32x32x16_bf16 v[144:159], v[204:207], a[8:11], v[144:159]
    ds_read_b64_tr_b16 v[222:223], v20 offset:39424
    s_waitcnt vmcnt(26) lgkmcnt(4)
    v_mfma_f32_32x32x16_bf16 v[128:143], v[208:211], a[16:19], v[128:143]
    ds_read_b64_tr_b16 v[192:193], v17 offset:32768
    v_mfma_f32_32x32x16_bf16 v[160:175], v[208:211], a[20:23], v[160:175]
    ds_read_b64_tr_b16 v[194:195], v17 offset:33280
    v_mfma_f32_32x32x16_bf16 v[176:191], v[212:215], a[20:23], v[176:191]
    ds_read_b64_tr_b16 v[196:197], v18 offset:32768
    v_mfma_f32_32x32x16_bf16 v[144:159], v[212:215], a[16:19], v[144:159]
    ds_read_b64_tr_b16 v[198:199], v18 offset:33280
    s_waitcnt vmcnt(24) lgkmcnt(4)
    v_mfma_f32_32x32x16_bf16 v[128:143], v[216:219], a[24:27], v[128:143]
    ds_read_b64_tr_b16 v[200:201], v17 offset:34816
    v_mfma_f32_32x32x16_bf16 v[160:175], v[216:219], a[28:31], v[160:175]
    ds_read_b64_tr_b16 v[202:203], v17 offset:35328
    v_mfma_f32_32x32x16_bf16 v[176:191], v[220:223], a[28:31], v[176:191]
    ds_read_b64_tr_b16 v[204:205], v18 offset:34816
    v_mfma_f32_32x32x16_bf16 v[144:159], v[220:223], a[24:27], v[144:159]
    ds_read_b64_tr_b16 v[206:207], v18 offset:35328
    s_waitcnt vmcnt(22) lgkmcnt(4)
    v_mfma_f32_32x32x16_bf16 v[128:143], v[192:195], a[32:35], v[128:143]
    buffer_load_dwordx4 a[0:3], v23, s[12:15], s44 offen offset:0 sc1
    ds_read_b64_tr_b16 v[208:209], v17 offset:36864
    v_mfma_f32_32x32x16_bf16 v[160:175], v[192:195], a[36:39], v[160:175]
    buffer_load_dwordx4 a[4:7], v23, s[12:15], s45 offen offset:0 sc1
    ds_read_b64_tr_b16 v[210:211], v17 offset:37376
    v_mfma_f32_32x32x16_bf16 v[176:191], v[196:199], a[36:39], v[176:191]
    buffer_load_dwordx4 a[8:11], v23, s[12:15], s44 offen offset:1024 sc1
    ds_read_b64_tr_b16 v[212:213], v18 offset:36864
    v_mfma_f32_32x32x16_bf16 v[144:159], v[196:199], a[32:35], v[144:159]
    buffer_load_dwordx4 a[12:15], v23, s[12:15], s45 offen offset:1024 sc1
    ds_read_b64_tr_b16 v[214:215], v18 offset:37376
    s_waitcnt vmcnt(24) lgkmcnt(4)
    v_mfma_f32_32x32x16_bf16 v[128:143], v[200:203], a[40:43], v[128:143]
    buffer_load_dwordx4 a[16:19], v23, s[12:15], s44 offen offset:2048 sc1
    ds_read_b64_tr_b16 v[216:217], v17 offset:38912
    v_mfma_f32_32x32x16_bf16 v[160:175], v[200:203], a[44:47], v[160:175]
    buffer_load_dwordx4 a[20:23], v23, s[12:15], s45 offen offset:2048 sc1
    ds_read_b64_tr_b16 v[218:219], v17 offset:39424
    v_mfma_f32_32x32x16_bf16 v[176:191], v[204:207], a[44:47], v[176:191]
    buffer_load_dwordx4 a[24:27], v23, s[12:15], s44 offen offset:3072 sc1
    ds_read_b64_tr_b16 v[220:221], v18 offset:38912
    v_mfma_f32_32x32x16_bf16 v[144:159], v[204:207], a[40:43], v[144:159]
    buffer_load_dwordx4 a[28:31], v23, s[12:15], s45 offen offset:3072 sc1
    ds_read_b64_tr_b16 v[222:223], v18 offset:39424
    s_add_u32 s44, s44, 4096
    s_add_u32 s45, s45, 4096
    s_add_u32 m0, s22, 98304
    s_waitcnt vmcnt(26) lgkmcnt(4)
    v_mfma_f32_32x32x16_bf16 v[128:143], v[208:211], a[48:51], v[128:143]
    buffer_load_dwordx4 v13, s[40:43], s20 offen offset:0 lds
    ds_read_b64_tr_b16 v[192:193], v19 offset:0
    v_mfma_f32_32x32x16_bf16 v[160:175], v[208:211], a[52:55], v[160:175]
    buffer_load_dwordx4 v14, s[40:43], s20 offen offset:1024 lds
    ds_read_b64_tr_b16 v[194:195], v19 offset:512
    v_mfma_f32_32x32x16_bf16 v[176:191], v[212:215], a[52:55], v[176:191]
    buffer_load_dwordx4 v15, s[40:43], s20 offen offset:2048 lds
    ds_read_b64_tr_b16 v[196:197], v20 offset:0
    v_mfma_f32_32x32x16_bf16 v[144:159], v[212:215], a[48:51], v[144:159]
    buffer_load_dwordx4 v16, s[40:43], s20 offen offset:3072 lds
    ds_read_b64_tr_b16 v[198:199], v20 offset:512
    s_add_u32 m0, s22, 102400
    s_waitcnt vmcnt(28) lgkmcnt(4)
    v_mfma_f32_32x32x16_bf16 v[128:143], v[216:219], a[56:59], v[128:143]
    buffer_load_dwordx4 v13, s[40:43], s21 offen offset:0 lds
    ds_read_b64_tr_b16 v[200:201], v19 offset:2048
    v_mfma_f32_32x32x16_bf16 v[160:175], v[216:219], a[60:63], v[160:175]
    buffer_load_dwordx4 v14, s[40:43], s21 offen offset:1024 lds
    ds_read_b64_tr_b16 v[202:203], v19 offset:2560
    v_mfma_f32_32x32x16_bf16 v[176:191], v[220:223], a[60:63], v[176:191]
    buffer_load_dwordx4 v15, s[40:43], s21 offen offset:2048 lds
    ds_read_b64_tr_b16 v[204:205], v20 offset:2048
    v_mfma_f32_32x32x16_bf16 v[144:159], v[220:223], a[56:59], v[144:159]
    buffer_load_dwordx4 v16, s[40:43], s21 offen offset:3072 lds
    ds_read_b64_tr_b16 v[206:207], v20 offset:2560
    s_add_u32 s20, s20, 65536
    s_add_u32 s21, s21, 65536
    s_waitcnt vmcnt(30) lgkmcnt(4)
    v_mfma_f32_32x32x16_bf16 v[128:143], v[192:195], a[64:67], v[128:143]
    buffer_load_dwordx4 a[32:35], v23, s[12:15], s44 offen offset:0 sc1
    ds_read_b64_tr_b16 v[208:209], v19 offset:4096
    v_mfma_f32_32x32x16_bf16 v[160:175], v[192:195], a[68:71], v[160:175]
    buffer_load_dwordx4 a[36:39], v23, s[12:15], s45 offen offset:0 sc1
    ds_read_b64_tr_b16 v[210:211], v19 offset:4608
    v_mfma_f32_32x32x16_bf16 v[176:191], v[196:199], a[68:71], v[176:191]
    buffer_load_dwordx4 a[40:43], v23, s[12:15], s44 offen offset:1024 sc1
    ds_read_b64_tr_b16 v[212:213], v20 offset:4096
    v_mfma_f32_32x32x16_bf16 v[144:159], v[196:199], a[64:67], v[144:159]
    buffer_load_dwordx4 a[44:47], v23, s[12:15], s45 offen offset:1024 sc1
    ds_read_b64_tr_b16 v[214:215], v20 offset:4608
    s_waitcnt vmcnt(32) lgkmcnt(4)
    v_mfma_f32_32x32x16_bf16 v[128:143], v[200:203], a[72:75], v[128:143]
    buffer_load_dwordx4 a[48:51], v23, s[12:15], s44 offen offset:2048 sc1
    ds_read_b64_tr_b16 v[216:217], v19 offset:6144
    v_mfma_f32_32x32x16_bf16 v[160:175], v[200:203], a[76:79], v[160:175]
    buffer_load_dwordx4 a[52:55], v23, s[12:15], s45 offen offset:2048 sc1
    ds_read_b64_tr_b16 v[218:219], v19 offset:6656
    v_mfma_f32_32x32x16_bf16 v[176:191], v[204:207], a[76:79], v[176:191]
    buffer_load_dwordx4 a[56:59], v23, s[12:15], s44 offen offset:3072 sc1
    ds_read_b64_tr_b16 v[220:221], v20 offset:6144
    v_mfma_f32_32x32x16_bf16 v[144:159], v[204:207], a[72:75], v[144:159]
    buffer_load_dwordx4 a[60:63], v23, s[12:15], s45 offen offset:3072 sc1
    ds_read_b64_tr_b16 v[222:223], v20 offset:6656
    s_add_u32 s44, s44, 4096
    s_add_u32 s45, s45, 4096
    s_add_u32 m0, s22, 32768
    s_waitcnt vmcnt(34) lgkmcnt(4)
    v_mfma_f32_32x32x16_bf16 v[128:143], v[208:211], a[80:83], v[128:143]
    buffer_load_dwordx4 v13, s[40:43], s20 offen offset:0 lds
    ds_read_b64_tr_b16 v[192:193], v17 offset:0
    v_mfma_f32_32x32x16_bf16 v[160:175], v[208:211], a[84:87], v[160:175]
    buffer_load_dwordx4 v14, s[40:43], s20 offen offset:1024 lds
    ds_read_b64_tr_b16 v[194:195], v17 offset:512
    v_mfma_f32_32x32x16_bf16 v[176:191], v[212:215], a[84:87], v[176:191]
    buffer_load_dwordx4 v15, s[40:43], s20 offen offset:2048 lds
    ds_read_b64_tr_b16 v[196:197], v18 offset:0
    v_mfma_f32_32x32x16_bf16 v[144:159], v[212:215], a[80:83], v[144:159]
    buffer_load_dwordx4 v16, s[40:43], s20 offen offset:3072 lds
    ds_read_b64_tr_b16 v[198:199], v18 offset:512
    s_add_u32 m0, s22, 36864
    s_waitcnt vmcnt(36) lgkmcnt(4)
    v_mfma_f32_32x32x16_bf16 v[128:143], v[216:219], a[88:91], v[128:143]
    buffer_load_dwordx4 v13, s[40:43], s21 offen offset:0 lds
    ds_read_b64_tr_b16 v[200:201], v17 offset:2048
    v_mfma_f32_32x32x16_bf16 v[160:175], v[216:219], a[92:95], v[160:175]
    buffer_load_dwordx4 v14, s[40:43], s21 offen offset:1024 lds
    ds_read_b64_tr_b16 v[202:203], v17 offset:2560
    v_mfma_f32_32x32x16_bf16 v[176:191], v[220:223], a[92:95], v[176:191]
    buffer_load_dwordx4 v15, s[40:43], s21 offen offset:2048 lds
    ds_read_b64_tr_b16 v[204:205], v18 offset:2048
    v_mfma_f32_32x32x16_bf16 v[144:159], v[220:223], a[88:91], v[144:159]
    buffer_load_dwordx4 v16, s[40:43], s21 offen offset:3072 lds
    ds_read_b64_tr_b16 v[206:207], v18 offset:2560
    s_add_u32 s20, s20, 65536
    s_add_u32 s21, s21, 65536
    s_waitcnt vmcnt(38) lgkmcnt(4)
    v_mfma_f32_32x32x16_bf16 v[128:143], v[192:195], a[96:99], v[128:143]
    buffer_load_dwordx4 a[64:67], v23, s[12:15], s44 offen offset:0 sc1
    ds_read_b64_tr_b16 v[208:209], v17 offset:4096
    v_mfma_f32_32x32x16_bf16 v[160:175], v[192:195], a[100:103], v[160:175]
    ds_read_b64_tr_b16 v[210:211], v17 offset:4608
    v_mfma_f32_32x32x16_bf16 v[176:191], v[196:199], a[100:103], v[176:191]
    buffer_load_dwordx4 a[68:71], v23, s[12:15], s45 offen offset:0 sc1
    ds_read_b64_tr_b16 v[212:213], v18 offset:4096
    v_mfma_f32_32x32x16_bf16 v[144:159], v[196:199], a[96:99], v[144:159]
    ds_read_b64_tr_b16 v[214:215], v18 offset:4608
    s_waitcnt vmcnt(38) lgkmcnt(4)
    v_mfma_f32_32x32x16_bf16 v[128:143], v[200:203], a[104:107], v[128:143]
    buffer_load_dwordx4 a[72:75], v23, s[12:15], s44 offen offset:1024 sc1
    ds_read_b64_tr_b16 v[216:217], v17 offset:6144
    v_mfma_f32_32x32x16_bf16 v[160:175], v[200:203], a[108:111], v[160:175]
    ds_read_b64_tr_b16 v[218:219], v17 offset:6656
    v_mfma_f32_32x32x16_bf16 v[176:191], v[204:207], a[108:111], v[176:191]
    buffer_load_dwordx4 a[76:79], v23, s[12:15], s45 offen offset:1024 sc1
    ds_read_b64_tr_b16 v[220:221], v18 offset:6144
    v_mfma_f32_32x32x16_bf16 v[144:159], v[204:207], a[104:107], v[144:159]
    ds_read_b64_tr_b16 v[222:223], v18 offset:6656
    s_waitcnt vmcnt(38) lgkmcnt(4)
    v_mfma_f32_32x32x16_bf16 v[128:143], v[208:211], a[112:115], v[128:143]
    buffer_load_dwordx4 a[80:83], v23, s[12:15], s44 offen offset:2048 sc1
    ds_read_b64_tr_b16 v[192:193], v21 offset:0
    v_mfma_f32_32x32x16_bf16 v[160:175], v[208:211], a[116:119], v[160:175]
    ds_read_b64_tr_b16 v[194:195], v21 offset:512
    v_mfma_f32_32x32x16_bf16 v[176:191], v[212:215], a[116:119], v[176:191]
    buffer_load_dwordx4 a[84:87], v23, s[12:15], s45 offen offset:2048 sc1
    ds_read_b64_tr_b16 v[196:197], v22 offset:0
    v_mfma_f32_32x32x16_bf16 v[144:159], v[212:215], a[112:115], v[144:159]
    ds_read_b64_tr_b16 v[198:199], v22 offset:512
    s_waitcnt vmcnt(38) lgkmcnt(4)
    v_mfma_f32_32x32x16_bf16 v[128:143], v[216:219], a[120:123], v[128:143]
    buffer_load_dwordx4 a[88:91], v23, s[12:15], s44 offen offset:3072 sc1
    ds_read_b64_tr_b16 v[200:201], v21 offset:2048
    v_mfma_f32_32x32x16_bf16 v[160:175], v[216:219], a[124:127], v[160:175]
    ds_read_b64_tr_b16 v[202:203], v21 offset:2560
    v_mfma_f32_32x32x16_bf16 v[176:191], v[220:223], a[124:127], v[176:191]
    buffer_load_dwordx4 a[92:95], v23, s[12:15], s45 offen offset:3072 sc1
    ds_read_b64_tr_b16 v[204:205], v22 offset:2048
    s_add_u32 s44, s44, 4096
    s_add_u32 s45, s45, 4096
    v_mfma_f32_32x32x16_bf16 v[144:159], v[220:223], a[120:123], v[144:159]
    ds_read_b64_tr_b16 v[206:207], v22 offset:2560
    s_waitcnt vmcnt(38) lgkmcnt(4)
    v_mfma_f32_32x32x16_bf16 v[128:143], v[192:195], a[0:3], v[128:143]
    buffer_load_dwordx4 v[32:35], v28, s[24:27], 0 offen offset:0 sc1
    ds_read_b64_tr_b16 v[208:209], v21 offset:4096
    v_mfma_f32_32x32x16_bf16 v[160:175], v[192:195], a[4:7], v[160:175]
    buffer_load_dwordx4 v[36:39], v28, s[24:27], 0 offen offset:512 sc1
    ds_read_b64_tr_b16 v[210:211], v21 offset:4608
    v_mfma_f32_32x32x16_bf16 v[176:191], v[196:199], a[4:7], v[176:191]
    buffer_load_dwordx4 v[40:43], v29, s[48:51], s100 offen offset:0 sc1
    ds_read_b64_tr_b16 v[212:213], v22 offset:4096
    v_mfma_f32_32x32x16_bf16 v[144:159], v[196:199], a[0:3], v[144:159]
    buffer_load_dwordx4 v[44:47], v29, s[48:51], s100 offen offset:64 sc1
    ds_read_b64_tr_b16 v[214:215], v22 offset:4608
    s_waitcnt vmcnt(40) lgkmcnt(4)
    v_mfma_f32_32x32x16_bf16 v[128:143], v[200:203], a[8:11], v[128:143]
    buffer_load_dwordx4 v[48:51], v29, s[48:51], s100 offen offset:32 sc1
    ds_read_b64_tr_b16 v[216:217], v21 offset:6144
    v_mfma_f32_32x32x16_bf16 v[160:175], v[200:203], a[12:15], v[160:175]
    buffer_load_dwordx4 v[52:55], v29, s[48:51], s100 offen offset:96 sc1
    ds_read_b64_tr_b16 v[218:219], v21 offset:6656
    v_mfma_f32_32x32x16_bf16 v[176:191], v[204:207], a[12:15], v[176:191]
    ds_read_b64_tr_b16 v[220:221], v22 offset:6144
    v_mfma_f32_32x32x16_bf16 v[144:159], v[204:207], a[8:11], v[144:159]
    ds_read_b64_tr_b16 v[222:223], v22 offset:6656
    s_waitcnt vmcnt(40) lgkmcnt(4)
    v_mfma_f32_32x32x16_bf16 v[128:143], v[208:211], a[16:19], v[128:143]
    s_waitcnt vmcnt(30)
    ds_read_b64_tr_b16 v[192:193], v19 offset:32768
    v_mfma_f32_32x32x16_bf16 v[160:175], v[208:211], a[20:23], v[160:175]
    ds_read_b64_tr_b16 v[194:195], v19 offset:33280
    v_mfma_f32_32x32x16_bf16 v[176:191], v[212:215], a[20:23], v[176:191]
    ds_read_b64_tr_b16 v[196:197], v20 offset:32768
    v_mfma_f32_32x32x16_bf16 v[144:159], v[212:215], a[16:19], v[144:159]
    ds_read_b64_tr_b16 v[198:199], v20 offset:33280
    s_waitcnt lgkmcnt(4)
    v_mfma_f32_32x32x16_bf16 v[128:143], v[216:219], a[24:27], v[128:143]
    ds_read_b64_tr_b16 v[200:201], v19 offset:34816
    v_mfma_f32_32x32x16_bf16 v[160:175], v[216:219], a[28:31], v[160:175]
    ds_read_b64_tr_b16 v[202:203], v19 offset:35328
    v_mfma_f32_32x32x16_bf16 v[176:191], v[220:223], a[28:31], v[176:191]
    ds_read_b64_tr_b16 v[204:205], v20 offset:34816
    v_mfma_f32_32x32x16_bf16 v[144:159], v[220:223], a[24:27], v[144:159]
    ds_read_b64_tr_b16 v[206:207], v20 offset:35328
    s_waitcnt vmcnt(28) lgkmcnt(4)
    v_mfma_f32_32x32x16_bf16 v[128:143], v[192:195], a[32:35], v[128:143]
    ds_read_b64_tr_b16 v[208:209], v19 offset:36864
    v_mfma_f32_32x32x16_bf16 v[160:175], v[192:195], a[36:39], v[160:175]
    ds_read_b64_tr_b16 v[210:211], v19 offset:37376
    v_mfma_f32_32x32x16_bf16 v[176:191], v[196:199], a[36:39], v[176:191]
    ds_read_b64_tr_b16 v[212:213], v20 offset:36864
    v_mfma_f32_32x32x16_bf16 v[144:159], v[196:199], a[32:35], v[144:159]
    ds_read_b64_tr_b16 v[214:215], v20 offset:37376
    s_waitcnt vmcnt(26) lgkmcnt(4)
    v_mfma_f32_32x32x16_bf16 v[128:143], v[200:203], a[40:43], v[128:143]
    ds_read_b64_tr_b16 v[216:217], v19 offset:38912
    v_mfma_f32_32x32x16_bf16 v[160:175], v[200:203], a[44:47], v[160:175]
    ds_read_b64_tr_b16 v[218:219], v19 offset:39424
    v_mfma_f32_32x32x16_bf16 v[176:191], v[204:207], a[44:47], v[176:191]
    ds_read_b64_tr_b16 v[220:221], v20 offset:38912
    v_mfma_f32_32x32x16_bf16 v[144:159], v[204:207], a[40:43], v[144:159]
    ds_read_b64_tr_b16 v[222:223], v20 offset:39424
    s_waitcnt vmcnt(24) lgkmcnt(4)
    v_mfma_f32_32x32x16_bf16 v[128:143], v[208:211], a[48:51], v[128:143]
    s_waitcnt vmcnt(14)
    ds_read_b64_tr_b16 v[192:193], v17 offset:32768
    v_mfma_f32_32x32x16_bf16 v[160:175], v[208:211], a[52:55], v[160:175]
    ds_read_b64_tr_b16 v[194:195], v17 offset:33280
    v_mfma_f32_32x32x16_bf16 v[176:191], v[212:215], a[52:55], v[176:191]
    ds_read_b64_tr_b16 v[196:197], v18 offset:32768
    v_mfma_f32_32x32x16_bf16 v[144:159], v[212:215], a[48:51], v[144:159]
    ds_read_b64_tr_b16 v[198:199], v18 offset:33280
    s_waitcnt lgkmcnt(4)
    v_mfma_f32_32x32x16_bf16 v[128:143], v[216:219], a[56:59], v[128:143]
    ds_read_b64_tr_b16 v[200:201], v17 offset:34816
    v_mfma_f32_32x32x16_bf16 v[160:175], v[216:219], a[60:63], v[160:175]
    ds_read_b64_tr_b16 v[202:203], v17 offset:35328
    v_mfma_f32_32x32x16_bf16 v[176:191], v[220:223], a[60:63], v[176:191]
    ds_read_b64_tr_b16 v[204:205], v18 offset:34816
    v_mfma_f32_32x32x16_bf16 v[144:159], v[220:223], a[56:59], v[144:159]
    ds_read_b64_tr_b16 v[206:207], v18 offset:35328
    s_waitcnt vmcnt(12) lgkmcnt(4)
    v_mfma_f32_32x32x16_bf16 v[128:143], v[192:195], a[64:67], v[128:143]
    ds_read_b64_tr_b16 v[208:209], v17 offset:36864
    v_mfma_f32_32x32x16_bf16 v[160:175], v[192:195], a[68:71], v[160:175]
    ds_read_b64_tr_b16 v[210:211], v17 offset:37376
    v_mfma_f32_32x32x16_bf16 v[176:191], v[196:199], a[68:71], v[176:191]
    ds_read_b64_tr_b16 v[212:213], v18 offset:36864
    v_mfma_f32_32x32x16_bf16 v[144:159], v[196:199], a[64:67], v[144:159]
    ds_read_b64_tr_b16 v[214:215], v18 offset:37376
    s_waitcnt vmcnt(10) lgkmcnt(4)
    v_mfma_f32_32x32x16_bf16 v[128:143], v[200:203], a[72:75], v[128:143]
    ds_read_b64_tr_b16 v[216:217], v17 offset:38912
    v_mfma_f32_32x32x16_bf16 v[160:175], v[200:203], a[76:79], v[160:175]
    ds_read_b64_tr_b16 v[218:219], v17 offset:39424
    v_mfma_f32_32x32x16_bf16 v[176:191], v[204:207], a[76:79], v[176:191]
    ds_read_b64_tr_b16 v[220:221], v18 offset:38912
    v_mfma_f32_32x32x16_bf16 v[144:159], v[204:207], a[72:75], v[144:159]
    ds_read_b64_tr_b16 v[222:223], v18 offset:39424
    s_waitcnt vmcnt(8) lgkmcnt(4)
    v_mfma_f32_32x32x16_bf16 v[128:143], v[208:211], a[80:83], v[128:143]
    v_mfma_f32_32x32x16_bf16 v[160:175], v[208:211], a[84:87], v[160:175]
    v_mfma_f32_32x32x16_bf16 v[176:191], v[212:215], a[84:87], v[176:191]
    v_mfma_f32_32x32x16_bf16 v[144:159], v[212:215], a[80:83], v[144:159]
    s_waitcnt vmcnt(6) lgkmcnt(0)
    v_mfma_f32_32x32x16_bf16 v[128:143], v[216:219], a[88:91], v[128:143]
    v_mfma_f32_32x32x16_bf16 v[160:175], v[216:219], a[92:95], v[160:175]
    v_mfma_f32_32x32x16_bf16 v[176:191], v[220:223], a[92:95], v[176:191]
    v_mfma_f32_32x32x16_bf16 v[144:159], v[220:223], a[88:91], v[144:159]
    v_lshlrev_b32 v1, 4, v114
    v_lshl_add_u32 v2, v115, 13, v1
    v_add_u32 v3, 0x10000, v2
    v_and_b32 v4, 1, v115
    v_lshl_add_u32 v4, v4, 12, v1
    v_lshrrev_b32 v5, 1, v115
    v_lshl_add_u32 v4, v5, 16, v4
    s_nop 1
    ds_write_b128 v2, v[128:131] offset:0
    ds_write_b128 v2, v[132:135] offset:1024
    ds_write_b128 v2, v[136:139] offset:2048
    ds_write_b128 v2, v[140:143] offset:3072
    ds_write_b128 v3, v[160:163] offset:0
    ds_write_b128 v3, v[164:167] offset:1024
    ds_write_b128 v3, v[168:171] offset:2048
    ds_write_b128 v3, v[172:175] offset:3072
    ds_write_b128 v3, v[176:179] offset:4096
    ds_write_b128 v3, v[180:183] offset:5120
    ds_write_b128 v3, v[184:187] offset:6144
    ds_write_b128 v3, v[188:191] offset:7168
    ds_write_b128 v2, v[144:147] offset:4096
    ds_write_b128 v2, v[148:151] offset:5120
    ds_write_b128 v2, v[152:155] offset:6144
    ds_write_b128 v2, v[156:159] offset:7168
    s_waitcnt vmcnt(0)
    v_lshlrev_b32 v56, 16, v32
    v_and_b32 v57, 0xffff0000, v32
    v_lshlrev_b32 v58, 16, v33
    v_and_b32 v59, 0xffff0000, v33
    v_lshlrev_b32 v60, 16, v34
    v_and_b32 v61, 0xffff0000, v34
    v_lshlrev_b32 v62, 16, v35
    v_and_b32 v63, 0xffff0000, v35
    v_lshlrev_b32 v64, 16, v36
    v_and_b32 v65, 0xffff0000, v36
    v_lshlrev_b32 v66, 16, v37
    v_and_b32 v67, 0xffff0000, v37
    v_lshlrev_b32 v68, 16, v38
    v_and_b32 v69, 0xffff0000, v38
    v_lshlrev_b32 v70, 16, v39
    v_and_b32 v71, 0xffff0000, v39
    s_waitcnt lgkmcnt(0)
    s_barrier
    ds_read_b128 v[128:131], v4 offset:0
    ds_read_b128 v[132:135], v4 offset:1024
    ds_read_b128 v[136:139], v4 offset:2048
    ds_read_b128 v[140:143], v4 offset:3072
    ds_read_b128 v[144:147], v4 offset:8192
    ds_read_b128 v[148:151], v4 offset:9216
    ds_read_b128 v[152:155], v4 offset:10240
    ds_read_b128 v[156:159], v4 offset:11264
    ds_read_b128 v[160:163], v4 offset:16384
    ds_read_b128 v[164:167], v4 offset:17408
    ds_read_b128 v[168:171], v4 offset:18432
    ds_read_b128 v[172:175], v4 offset:19456
    ds_read_b128 v[176:179], v4 offset:24576
    ds_read_b128 v[180:183], v4 offset:25600
    ds_read_b128 v[184:187], v4 offset:26624
    ds_read_b128 v[188:191], v4 offset:27648
    s_waitcnt lgkmcnt(8)
    v_pk_add_f32 v[128:129], v[128:129], v[144:145]
    v_pk_add_f32 v[130:131], v[130:131], v[146:147]
    v_pk_add_f32 v[132:133], v[132:133], v[148:149]
    v_pk_add_f32 v[134:135], v[134:135], v[150:151]
    v_pk_add_f32 v[136:137], v[136:137], v[152:153]
    v_pk_add_f32 v[138:139], v[138:139], v[154:155]
    v_pk_add_f32 v[140:141], v[140:141], v[156:157]
    v_pk_add_f32 v[142:143], v[142:143], v[158:159]
    s_waitcnt lgkmcnt(0)
    v_pk_add_f32 v[160:161], v[160:161], v[176:177]
    v_pk_add_f32 v[162:163], v[162:163], v[178:179]
    v_pk_add_f32 v[164:165], v[164:165], v[180:181]
    v_pk_add_f32 v[166:167], v[166:167], v[182:183]
    v_pk_add_f32 v[168:169], v[168:169], v[184:185]
    v_pk_add_f32 v[170:171], v[170:171], v[186:187]
    v_pk_add_f32 v[172:173], v[172:173], v[188:189]
    v_pk_add_f32 v[174:175], v[174:175], v[190:191]
    v_pk_add_f32 v[128:129], v[128:129], v[160:161]
    v_pk_add_f32 v[130:131], v[130:131], v[162:163]
    v_pk_add_f32 v[132:133], v[132:133], v[164:165]
    v_pk_add_f32 v[134:135], v[134:135], v[166:167]
    v_pk_add_f32 v[136:137], v[136:137], v[168:169]
    v_pk_add_f32 v[138:139], v[138:139], v[170:171]
    v_pk_add_f32 v[140:141], v[140:141], v[172:173]
    v_pk_add_f32 v[142:143], v[142:143], v[174:175]
    v_pk_fma_f32 v[56:57], v[40:41], v[128:129], v[56:57]
    v_pk_fma_f32 v[58:59], v[42:43], v[130:131], v[58:59]
    v_cvt_pk_bf16_f32 v32, v56, v57
    v_cvt_pk_bf16_f32 v33, v58, v59
    buffer_store_dwordx2 v[32:33], v30, s[96:99], 0 offen offset:0
    v_pk_fma_f32 v[60:61], v[44:45], v[132:133], v[60:61]
    v_pk_fma_f32 v[62:63], v[46:47], v[134:135], v[62:63]
    v_cvt_pk_bf16_f32 v34, v60, v61
    v_cvt_pk_bf16_f32 v35, v62, v63
    buffer_store_dwordx2 v[34:35], v30, s[96:99], 0 offen offset:32
    v_pk_fma_f32 v[64:65], v[48:49], v[136:137], v[64:65]
    v_pk_fma_f32 v[66:67], v[50:51], v[138:139], v[66:67]
    v_cvt_pk_bf16_f32 v36, v64, v65
    v_cvt_pk_bf16_f32 v37, v66, v67
    buffer_store_dwordx2 v[36:37], v30, s[96:99], 0 offen offset:16
    v_pk_fma_f32 v[68:69], v[52:53], v[140:141], v[68:69]
    v_pk_fma_f32 v[70:71], v[54:55], v[142:143], v[70:71]
    v_cvt_pk_bf16_f32 v38, v68, v69
    v_cvt_pk_bf16_f32 v39, v70, v71
    buffer_store_dwordx2 v[38:39], v30, s[96:99], 0 offen offset:48
L_big_end:
    s_endpgm
L_attn_fallback:
    s_mov_b32 s28, 1
    s_mov_b32 s24, 0
    s_mov_b32 s27, 0
    v_mov_b32 v240, 0xff800000
    v_mov_b32 v241, 0xff800000
    v_mov_b32 v242, 0xff800000
    v_mov_b32 v243, 0xff800000
    s_waitcnt vmcnt(0) lgkmcnt(0)
L_attn_maxloop:
    s_barrier
    s_add_u32 m0, s26, 0
    s_nop 0
    buffer_load_dwordx4 v13, s[4:7], s24 offen offset:0 nt lds
    buffer_load_dwordx4 v14, s[4:7], s24 offen offset:1024 nt lds
    buffer_load_dwordx4 v15, s[4:7], s24 offen offset:2048 nt lds
    buffer_load_dwordx4 v16, s[4:7], s24 offen offset:3072 nt lds
    s_add_u32 s24, s24, 16384
    s_waitcnt vmcnt(0) lgkmcnt(0)
    s_barrier
    ds_read_b128 a[128:131], v1 offset:0
    ds_read_b128 a[132:135], v2 offset:0
    ds_read_b128 a[136:139], v3 offset:0
    ds_read_b128 a[140:143], v4 offset:0
    ds_read_b128 a[144:147], v1 offset:4096
    ds_read_b128 a[148:151], v2 offset:4096
    ds_read_b128 a[152:155], v3 offset:4096
    ds_read_b128 a[156:159], v4 offset:4096
    s_waitcnt lgkmcnt(0)
    v_mfma_f32_16x16x32_bf16 v[128:131], a[128:131], v[32:35], 0
    v_mfma_f32_16x16x32_bf16 v[132:135], a[128:131], v[48:51], 0
    v_mfma_f32_16x16x32_bf16 v[136:139], a[128:131], v[64:67], 0
    v_mfma_f32_16x16x32_bf16 v[140:143], a[128:131], v[80:83], 0
    v_mfma_f32_16x16x32_bf16 v[128:131], a[132:135], v[36:39], v[128:131]
    v_mfma_f32_16x16x32_bf16 v[132:135], a[132:135], v[52:55], v[132:135]
    v_mfma_f32_16x16x32_bf16 v[136:139], a[132:135], v[68:71], v[136:139]
    v_mfma_f32_16x16x32_bf16 v[140:143], a[132:135], v[84:87], v[140:143]
    v_mfma_f32_16x16x32_bf16 v[128:131], a[136:139], v[40:43], v[128:131]
    v_mfma_f32_16x16x32_bf16 v[132:135], a[136:139], v[56:59], v[132:135]
    v_mfma_f32_16x16x32_bf16 v[136:139], a[136:139], v[72:75], v[136:139]
    v_mfma_f32_16x16x32_bf16 v[140:143], a[136:139], v[88:91], v[140:143]
    v_mfma_f32_16x16x32_bf16 v[128:131], a[140:143], v[44:47], v[128:131]
    v_mfma_f32_16x16x32_bf16 v[132:135], a[140:143], v[60:63], v[132:135]
    v_mfma_f32_16x16x32_bf16 v[136:139], a[140:143], v[76:79], v[136:139]
    v_mfma_f32_16x16x32_bf16 v[140:143], a[140:143], v[92:95], v[140:143]
    v_mfma_f32_16x16x32_bf16 v[144:147], a[144:147], v[32:35], 0
    v_mfma_f32_16x16x32_bf16 v[148:151], a[144:147], v[48:51], 0
    v_mfma_f32_16x16x32_bf16 v[152:155], a[144:147], v[64:67], 0
    v_mfma_f32_16x16x32_bf16 v[156:159], a[144:147], v[80:83], 0
    v_mfma_f32_16x16x32_bf16 v[144:147], a[148:151], v[36:39], v[144:147]
    v_mfma_f32_16x16x32_bf16 v[148:151], a[148:151], v[52:55], v[148:151]
    v_mfma_f32_16x16x32_bf16 v[152:155], a[148:151], v[68:71], v[152:155]
    v_mfma_f32_16x16x32_bf16 v[156:159], a[148:151], v[84:87], v[156:159]
    v_mfma_f32_16x16x32_bf16 v[144:147], a[152:155], v[40:43], v[144:147]
    v_mfma_f32_16x16x32_bf16 v[148:151], a[152:155], v[56:59], v[148:151]
    v_mfma_f32_16x16x32_bf16 v[152:155], a[152:155], v[72:75], v[152:155]
    v_mfma_f32_16x16x32_bf16 v[156:159], a[152:155], v[88:91], v[156:159]
    v_mfma_f32_16x16x32_bf16 v[144:147], a[156:159], v[44:47], v[144:147]
    v_mfma_f32_16x16x32_bf16 v[148:151], a[156:159], v[60:63], v[148:151]
    v_mfma_f32_16x16x32_bf16 v[152:155], a[156:159], v[76:79], v[152:155]
    v_mfma_f32_16x16x32_bf16 v[156:159], a[156:159], v[92:95], v[156:159]
    s_nop 7
    ds_read_b128 a[128:131], v1 offset:8192
    ds_read_b128 a[132:135], v2 offset:8192
    ds_read_b128 a[136:139], v3 offset:8192
    ds_read_b128 a[140:143], v4 offset:8192
    ds_read_b128 a[144:147], v1 offset:12288
    ds_read_b128 a[148:151], v2 offset:12288
    ds_read_b128 a[152:155], v3 offset:12288
    ds_read_b128 a[156:159], v4 offset:12288
    s_waitcnt lgkmcnt(0)
    v_mfma_f32_16x16x32_bf16 v[160:163], a[128:131], v[32:35], 0
    v_mfma_f32_16x16x32_bf16 v[164:167], a[128:131], v[48:51], 0
    v_mfma_f32_16x16x32_bf16 v[168:171], a[128:131], v[64:67], 0
    v_mfma_f32_16x16x32_bf16 v[172:175], a[128:131], v[80:83], 0
    v_mfma_f32_16x16x32_bf16 v[160:163], a[132:135], v[36:39], v[160:163]
    v_mfma_f32_16x16x32_bf16 v[164:167], a[132:135], v[52:55], v[164:167]
    v_mfma_f32_16x16x32_bf16 v[168:171], a[132:135], v[68:71], v[168:171]
    v_mfma_f32_16x16x32_bf16 v[172:175], a[132:135], v[84:87], v[172:175]
    v_mfma_f32_16x16x32_bf16 v[160:163], a[136:139], v[40:43], v[160:163]
    v_mfma_f32_16x16x32_bf16 v[164:167], a[136:139], v[56:59], v[164:167]
    v_mfma_f32_16x16x32_bf16 v[168:171], a[136:139], v[72:75], v[168:171]
    v_mfma_f32_16x16x32_bf16 v[172:175], a[136:139], v[88:91], v[172:175]
    v_mfma_f32_16x16x32_bf16 v[160:163], a[140:143], v[44:47], v[160:163]
    v_mfma_f32_16x16x32_bf16 v[164:167], a[140:143], v[60:63], v[164:167]
    v_mfma_f32_16x16x32_bf16 v[168:171], a[140:143], v[76:79], v[168:171]
    v_mfma_f32_16x16x32_bf16 v[172:175], a[140:143], v[92:95], v[172:175]
    v_mfma_f32_16x16x32_bf16 v[176:179], a[144:147], v[32:35], 0
    v_mfma_f32_16x16x32_bf16 v[180:183], a[144:147], v[48:51], 0
    v_mfma_f32_16x16x32_bf16 v[184:187], a[144:147], v[64:67], 0
    v_mfma_f32_16x16x32_bf16 v[188:191], a[144:147], v[80:83], 0
    v_mfma_f32_16x16x32_bf16 v[176:179], a[148:151], v[36:39], v[176:179]
    v_mfma_f32_16x16x32_bf16 v[180:183], a[148:151], v[52:55], v[180:183]
    v_mfma_f32_16x16x32_bf16 v[184:187], a[148:151], v[68:71], v[184:187]
    v_mfma_f32_16x16x32_bf16 v[188:191], a[148:151], v[84:87], v[188:191]
    v_mfma_f32_16x16x32_bf16 v[176:179], a[152:155], v[40:43], v[176:179]
    v_mfma_f32_16x16x32_bf16 v[180:183], a[152:155], v[56:59], v[180:183]
    v_mfma_f32_16x16x32_bf16 v[184:187], a[152:155], v[72:75], v[184:187]
    v_mfma_f32_16x16x32_bf16 v[188:191], a[152:155], v[88:91], v[188:191]
    v_mfma_f32_16x16x32_bf16 v[176:179], a[156:159], v[44:47], v[176:179]
    v_mfma_f32_16x16x32_bf16 v[180:183], a[156:159], v[60:63], v[180:183]
    v_mfma_f32_16x16x32_bf16 v[184:187], a[156:159], v[76:79], v[184:187]
    v_mfma_f32_16x16x32_bf16 v[188:191], a[156:159], v[92:95], v[188:191]
    s_nop 7
    v_max3_f32 v240, v240, v128, v129
    v_max3_f32 v240, v240, v130, v131
    v_max3_f32 v241, v241, v132, v133
    v_max3_f32 v241, v241, v134, v135
    v_max3_f32 v242, v242, v136, v137
    v_max3_f32 v242, v242, v138, v139
    v_max3_f32 v243, v243, v140, v141
    v_max3_f32 v243, v243, v142, v143
    v_max3_f32 v240, v240, v144, v145
    v_max3_f32 v240, v240, v146, v147
    v_max3_f32 v241, v241, v148, v149
    v_max3_f32 v241, v241, v150, v151
    v_max3_f32 v242, v242, v152, v153
    v_max3_f32 v242, v242, v154, v155
    v_max3_f32 v243, v243, v156, v157
    v_max3_f32 v243, v243, v158, v159
    v_max3_f32 v240, v240, v160, v161
    v_max3_f32 v240, v240, v162, v163
    v_max3_f32 v241, v241, v164, v165
    v_max3_f32 v241, v241, v166, v167
    v_max3_f32 v242, v242, v168, v169
    v_max3_f32 v242, v242, v170, v171
    v_max3_f32 v243, v243, v172, v173
    v_max3_f32 v243, v243, v174, v175
    v_max3_f32 v240, v240, v176, v177
    v_max3_f32 v240, v240, v178, v179
    v_max3_f32 v241, v241, v180, v181
    v_max3_f32 v241, v241, v182, v183
    v_max3_f32 v242, v242, v184, v185
    v_max3_f32 v242, v242, v186, v187
    v_max3_f32 v243, v243, v188, v189
    v_max3_f32 v243, v243, v190, v191
    s_add_u32 s27, s27, 1
    s_cmp_lt_u32 s27, 32
    s_cbranch_scc1 L_attn_maxloop
    v_mov_b32 v244, v240
    v_mov_b32 v245, v241
    v_mov_b32 v246, v242
    v_mov_b32 v247, v243
    v_permlane16_swap_b32 v240, v244
    v_permlane16_swap_b32 v241, v245
    v_permlane16_swap_b32 v242, v246
    v_permlane16_swap_b32 v243, v247
    v_max_f32 v240, v240, v244
    v_max_f32 v241, v241, v245
    v_max_f32 v242, v242, v246
    v_max_f32 v243, v243, v247
    v_mov_b32 v244, v240
    v_mov_b32 v245, v241
    v_mov_b32 v246, v242
    v_mov_b32 v247, v243
    v_permlane32_swap_b32 v240, v244
    v_permlane32_swap_b32 v241, v245
    v_permlane32_swap_b32 v242, v246
    v_permlane32_swap_b32 v243, v247
    v_max_f32 v240, v240, v244
    v_max_f32 v241, v241, v245
    v_max_f32 v242, v242, v246
    v_max_f32 v243, v243, v247
    v_accvgpr_write_b32 a250, v240
    v_accvgpr_write_b32 a251, v241
    v_accvgpr_write_b32 a252, v242
    v_accvgpr_write_b32 a253, v243
    s_mov_b32 s24, 0
    s_mov_b32 s25, 0
    s_and_b32 s44, s46, 7
    s_lshl_b32 s44, s44, 17
    s_barrier
    s_add_u32 m0, s26, 0
    s_nop 0
    buffer_load_dwordx4 v13, s[4:7], s24 offen offset:0 nt lds
    buffer_load_dwordx4 v14, s[4:7], s24 offen offset:1024 nt lds
    buffer_load_dwordx4 v15, s[4:7], s24 offen offset:2048 nt lds
    buffer_load_dwordx4 v16, s[4:7], s24 offen offset:3072 nt lds
    s_add_u32 s24, s24, 16384
    s_add_u32 m0, s26, 16384
    s_nop 0
    buffer_load_dwordx4 v13, s[4:7], s24 offen offset:0 nt lds
    buffer_load_dwordx4 v14, s[4:7], s24 offen offset:1024 nt lds
    buffer_load_dwordx4 v15, s[4:7], s24 offen offset:2048 nt lds
    buffer_load_dwordx4 v16, s[4:7], s24 offen offset:3072 nt lds
    s_add_u32 s24, s24, 16384
    s_add_u32 m0, s26, 32768
    s_nop 0
    buffer_load_dwordx4 v13, s[4:7], s24 offen offset:0 nt lds
    buffer_load_dwordx4 v14, s[4:7], s24 offen offset:1024 nt lds
    buffer_load_dwordx4 v15, s[4:7], s24 offen offset:2048 nt lds
    buffer_load_dwordx4 v16, s[4:7], s24 offen offset:3072 nt lds
    s_add_u32 s24, s24, 16384
    s_add_u32 m0, s26, 49152
    s_nop 0
    buffer_load_dwordx4 v13, s[4:7], s24 offen offset:0 nt lds
    buffer_load_dwordx4 v14, s[4:7], s24 offen offset:1024 nt lds
    buffer_load_dwordx4 v15, s[4:7], s24 offen offset:2048 nt lds
    buffer_load_dwordx4 v16, s[4:7], s24 offen offset:3072 nt lds
    s_add_u32 s24, s24, 16384
    s_add_u32 m0, s26, 65536
    s_nop 0
    buffer_load_dwordx4 v17, s[8:11], s25 offen offset:0 nt lds
    buffer_load_dwordx4 v18, s[8:11], s25 offen offset:1024 nt lds
    buffer_load_dwordx4 v17, s[8:11], s25 offen offset:2048 nt lds
    buffer_load_dwordx4 v18, s[8:11], s25 offen offset:3072 nt lds
    s_add_u32 s25, s25, 16384
    s_add_u32 m0, s26, 81920
    s_nop 0
    buffer_load_dwordx4 v17, s[8:11], s25 offen offset:0 nt lds
    buffer_load_dwordx4 v18, s[8:11], s25 offen offset:1024 nt lds
    buffer_load_dwordx4 v17, s[8:11], s25 offen offset:2048 nt lds
    buffer_load_dwordx4 v18, s[8:11], s25 offen offset:3072 nt lds
    s_add_u32 s25, s25, 16384
    s_waitcnt vmcnt(0) lgkmcnt(0)
    s_barrier
    ds_read_b128 a[128:131], v1 offset:0
    ds_read_b128 a[132:135], v2 offset:0
    ds_read_b128 a[136:139], v3 offset:0
    ds_read_b128 a[140:143], v4 offset:0
    ds_read_b128 a[144:147], v1 offset:4096
    ds_read_b128 a[148:151], v2 offset:4096
    ds_read_b128 a[152:155], v3 offset:4096
    ds_read_b128 a[156:159], v4 offset:4096
    s_waitcnt vmcnt(0) lgkmcnt(0)
    s_branch L_attn_first
L_code_end:
.section .rodata,"a"
.p2align 6
.amdhsa_kernel adaLN_cond__mha_block_cached__glu_gated_bilinear__prompt_kernel
  .amdhsa_next_free_vgpr 512
  .amdhsa_next_free_sgpr 102
  .amdhsa_accum_offset 256
  .amdhsa_group_segment_fixed_size 0
  .amdhsa_kernarg_size 112
  .amdhsa_user_sgpr_count 2
  .amdhsa_user_sgpr_kernarg_segment_ptr 1
  .amdhsa_system_sgpr_workgroup_id_x 1
.end_amdhsa_kernel
```
